```python
import torch

def _softmax(x, axis=-1):
    return torch.softmax(x, dim=axis)

def _gelu(x):
    return torch.nn.functional.gelu(x, approximate='tanh')

def _silu(x):
    return torch.nn.functional.silu(x)

def _sigmoid(x):
    return torch.sigmoid(x)

def _layernorm(x, axis=-1, eps=1e-05):
    m = x.mean(dim=axis, keepdim=True)
    v = x.var(dim=axis, keepdim=True, unbiased=False)
    return (x - m) / torch.sqrt(v + eps)

def _scatter_add(tgt, idx, src, axis=0):
    return tgt.clone().index_add_(axis, idx, src)

def _segment_sum(src, seg, n):
    out = torch.zeros((n,) + src.shape[1:], dtype=src.dtype)
    return out.index_add_(0, seg, src)

def _pad(x, pw):
    flat = tuple((v for pair in reversed(pw) for v in pair))
    return torch.nn.functional.pad(x, flat)
kernel_name = 'standalone__kv_cache_quant_pre_rope_vs_post_rope__prompt'

def setup_inputs():

    _w = lambda a: (lambda t: t.to(torch.bfloat16) if t.is_floating_point() else t)(torch.as_tensor(a))
    B, Sq, Skv = (1, 2048, 2048)
    H, Dh0 = (32, 128)
    G = 32 if 32 > 0 else Dh0
    G = max(2, G // 2 * 2)
    Dh = max(G, Dh0 // G * G)
    Skv = max(Skv, Sq)
    ng = Dh // G
    bits = 4 if 4 > 1 else 4
    bits = max(2, min(8, bits))
    qmax = (1 << bits) - 1
    half = Dh // 2
    inv = 1.0 / 10000.0 ** (torch.arange(half) / max(1, half))
    ang_k = torch.arange(Skv)[:, None] * inv[None, :]
    ang_q = torch.arange(Skv - Sq, Skv)[:, None] * inv[None, :]
    kc = torch.cat([torch.cos(ang_k), torch.cos(ang_k)], dim=-1)
    ks = torch.cat([torch.sin(ang_k), torch.sin(ang_k)], dim=-1)
    qc = torch.cat([torch.cos(ang_q), torch.cos(ang_q)], dim=-1)
    qs = torch.cat([torch.sin(ang_q), torch.sin(ang_q)], dim=-1)
    qk_i = torch.randint(0, qmax + 1, (B, H, Skv, Dh)).to(torch.int32)
    qv_i = torch.randint(0, qmax + 1, (B, H, Skv, Dh)).to(torch.int32)
    ksc = torch.abs((lambda *s: torch.randn(*s, dtype=torch.bfloat16) * 0.2)(B, H, Skv, ng)) * 0.1 + 0.01
    kzp = torch.full((B, H, Skv, ng), qmax / 2.0)
    vsc = torch.abs((lambda *s: torch.randn(*s, dtype=torch.bfloat16) * 0.2)(B, H, Skv, ng)) * 0.1 + 0.01
    vzp = torch.full((B, H, Skv, ng), qmax / 2.0)
    return {'q': _w((lambda *s: torch.randn(*s, dtype=torch.bfloat16) * 6.4)(B, H, Sq, Dh) * 0.5), 'qk': _w(qk_i), 'k_scales': _w(ksc), 'k_zeros': _w(kzp), 'qv': _w(qv_i), 'v_scales': _w(vsc), 'v_zeros': _w(vzp), 'q_cos': _w(qc), 'q_sin': _w(qs), 'k_cos': _w(kc), 'k_sin': _w(ks)}

def reference(q, qk, k_scales, k_zeros, qv, v_scales, v_zeros, q_cos, q_sin, k_cos, k_sin):
    B, H, Sq, Dh = q.shape
    ng = k_scales.shape[-1]
    G = Dh // ng
    half = Dh // 2
    ks = (lambda x, n, axis: torch.repeat_interleave(x, n, dim=axis))(k_scales, G, axis=-1)
    kz = (lambda x, n, axis: torch.repeat_interleave(x, n, dim=axis))(k_zeros, G, axis=-1)
    k = ((lambda x, dt: x.to(dt))(qk, q.dtype) - kz) * ks
    vs = (lambda x, n, axis: torch.repeat_interleave(x, n, dim=axis))(v_scales, G, axis=-1)
    vz = (lambda x, n, axis: torch.repeat_interleave(x, n, dim=axis))(v_zeros, G, axis=-1)
    v = ((lambda x, dt: x.to(dt))(qv, q.dtype) - vz) * vs
    k1 = k[..., :half].clone()
    k2 = k[..., half:].clone()
    krh = torch.concatenate([-k2, k1], axis=-1)
    kr = k * k_cos[None, None, :, :] + krh * k_sin[None, None, :, :]
    q1 = q[..., :half].clone()
    q2 = q[..., half:].clone()
    qrh = torch.concatenate([-q2, q1], axis=-1)
    qr = q * q_cos[None, None, :, :] + qrh * q_sin[None, None, :, :]
    logits = torch.einsum('bhqd,bhkd->bhqk', qr, kr) * float(Dh) ** (-0.5)
    attn = _softmax(logits, axis=-1)
    out = torch.einsum('bhqk,bhkd->bhqd', attn, v)
    return out
```

```asm
; @launch grid=(256,1,1) block=(256,1,1) lds=133184
.amdgcn_target "amdgcn-amd-amdhsa--gfx950"
.text
.globl standalone__kv_cache_quant_pre_rope_vs_post_rope__prompt_kernel
.p2align 8
.type standalone__kv_cache_quant_pre_rope_vs_post_rope__prompt_kernel,@function
standalone__kv_cache_quant_pre_rope_vs_post_rope__prompt_kernel:
    s_cmp_ge_u32 s2, 256
    s_cbranch_scc1 L_done
    s_load_dwordx2 s[44:45], s[0:1], 0
    s_load_dwordx2 s[12:13], s[0:1], 8
    s_load_dwordx2 s[16:17], s[0:1], 16
    s_load_dwordx2 s[20:21], s[0:1], 24
    s_load_dwordx2 s[24:25], s[0:1], 32
    s_load_dwordx2 s[28:29], s[0:1], 40
    s_load_dwordx2 s[32:33], s[0:1], 48
    s_load_dwordx2 s[48:49], s[0:1], 56
    s_load_dwordx2 s[52:53], s[0:1], 64
    s_load_dwordx2 s[36:37], s[0:1], 72
    s_load_dwordx2 s[40:41], s[0:1], 80
    s_load_dwordx2 s[56:57], s[0:1], 88
    s_load_dwordx2 s[8:9], s[0:1], 96
    s_load_dwordx2 s[4:5], s[0:1], 104
    s_memrealtime s[96:97]
    s_and_b32 s80, s2, 7
    s_lshr_b32 s81, s2, 3
    s_lshr_b32 s60, s80, 1
    s_mul_i32 s60, s60, 8
    s_and_b32 s82, s81, 7
    s_add_u32 s60, s60, s82
    s_and_b32 s61, s80, 1
    s_mul_i32 s61, s61, 4
    s_lshr_b32 s82, s81, 3
    s_add_u32 s61, s61, s82
    v_lshrrev_b32 v1, 6, v0
    v_and_b32 v0, 63, v0
    v_readfirstlane_b32 s62, v1
    v_lshlrev_b32 v1, 4, v0
    v_add_u32 v2, 0x10000, v1
    v_lshrrev_b32 v8, 2, v0
    v_add_u32 v8, s61, v8
    v_and_b32 v8, 7, v8
    v_lshlrev_b32 v8, 3, v8
    v_mov_b32 v4, 0
    v_mov_b32 v5, 0
    v_lshrrev_b32 v22, 3, v0
    v_and_b32 v23, 7, v0
    v_and_b32 v24, 4, v22
    v_add_u32 v24, v24, v22
    v_lshlrev_b32 v162, 9, v24
    v_lshl_add_u32 v162, v23, 4, v162
    v_lshrrev_b32 v163, 1, v162
    v_lshlrev_b32 v164, 3, v24
    v_lshrrev_b32 v24, 5, v0
    v_lshlrev_b32 v167, 12, v24
    v_and_b32 v171, 31, v0
    v_lshl_add_u32 v167, v171, 4, v167
    v_lshlrev_b32 v168, 1, v0
    s_lshl_b32 s65, s62, 13
    v_add_u32 v3, s65, v1
    v_add_u32 v9, 0x1000, v3
    s_lshl_b32 s79, s61, 16
    s_lshl_b32 s80, s62, 14
    s_add_u32 s79, s79, s80
    s_lshl_b32 s78, s60, 19
    s_add_u32 s78, s78, s79
    s_mov_b32 s66, 0x53800000
    s_mov_b32 s87, 0x3e0293ee
    s_mov_b32 s67, 0
    s_mov_b32 s89, 0
    s_lshl_b32 s80, s61, 8
    s_lshl_b32 s81, s62, 4
    s_add_u32 s80, s80, s81
    s_lshl_b32 s73, s80, 8
    s_lshl_b32 s81, s60, 11
    s_add_u32 s81, s81, s80
    s_lshl_b32 s71, s81, 9
    s_lshl_b32 s74, s81, 3
    s_lshl_b32 s80, s61, 17
    s_lshr_b32 s81, s62, 1
    s_lshl_b32 s81, s81, 14
    s_add_u32 s80, s80, s81
    s_and_b32 s81, s62, 1
    s_lshl_b32 s75, s81, 7
    s_add_u32 s75, s75, s80
    s_add_u32 s76, s75, 4096
    s_lshl_b32 s77, s81, 9
    s_add_u32 s77, s77, s80
    s_add_u32 s77, s77, 8192
    s_add_u32 s72, s77, 4096
    s_lshl_b32 s86, s62, 9
    s_add_u32 s86, s86, 131072
    s_mov_b32 s85, 0
    s_mov_b32 s88, 0
    s_mov_b32 s69, 0
    s_mov_b32 s70, 32768
    s_waitcnt lgkmcnt(0)
    s_lshl_b32 s80, s60, 9
    s_add_u32 s80, s80, 0x2000000
    s_add_u32 s98, s4, s80
    s_addc_u32 s99, s5, 0
    s_lshl_b32 s80, s60, 20
    s_add_u32 s4, s4, s80
    s_addc_u32 s5, s5, 0
    s_and_b32 s45, s45, 0xffff
    s_mov_b32 s46, 0x1000000
    s_mov_b32 s47, 0x20000
    s_and_b32 s13, s13, 0xffff
    s_mov_b32 s14, 0x2000000
    s_mov_b32 s15, 0x20000
    s_and_b32 s17, s17, 0xffff
    s_mov_b32 s18, 0x80000
    s_mov_b32 s19, 0x20000
    s_and_b32 s21, s21, 0xffff
    s_mov_b32 s22, 0x80000
    s_mov_b32 s23, 0x20000
    s_and_b32 s25, s25, 0xffff
    s_mov_b32 s26, 0x2000000
    s_mov_b32 s27, 0x20000
    s_and_b32 s29, s29, 0xffff
    s_mov_b32 s30, 0x80000
    s_mov_b32 s31, 0x20000
    s_and_b32 s33, s33, 0xffff
    s_mov_b32 s34, 0x80000
    s_mov_b32 s35, 0x20000
    s_and_b32 s49, s49, 0xffff
    s_mov_b32 s50, 0x80000
    s_mov_b32 s51, 0x20000
    s_and_b32 s53, s53, 0xffff
    s_mov_b32 s54, 0x80000
    s_mov_b32 s55, 0x20000
    s_and_b32 s37, s37, 0xffff
    s_mov_b32 s38, 0x80000
    s_mov_b32 s39, 0x20000
    s_and_b32 s41, s41, 0xffff
    s_mov_b32 s42, 0x80000
    s_mov_b32 s43, 0x20000
    s_and_b32 s57, s57, 0xffff
    s_mov_b32 s58, 0x1000000
    s_mov_b32 s59, 0x20000
    s_and_b32 s9, s9, 0xffff
    s_mov_b32 s10, 0x100
    s_mov_b32 s11, 0x20000
    s_and_b32 s5, s5, 0xffff
    s_mov_b32 s6, 0x100000
    s_mov_b32 s7, 0x20000
    s_cmp_lg_u32 s62, 0
    s_cbranch_scc1 L_nononce
    s_or_b32 s96, s96, 1
    v_mov_b32 v6, s96
    v_mov_b32 v7, s97
    v_mov_b32 v10, s96
    v_mov_b32 v11, s97
    v_mov_b32 v12, 0
    v_mov_b32 v13, 0
    s_lshl_b32 s80, s60, 3
    v_mov_b32 v22, s80
    s_mov_b64 exec, 1
    buffer_atomic_cmpswap_x2 v[10:13], v22, s[8:11], 0 offen sc0 sc1
    s_mov_b64 exec, -1
L_nononce:
    s_mov_b32 s8, s98
    s_and_b32 s9, s99, 0xffff
    s_mov_b32 s10, 512
    s_mov_b32 s11, 0x20000
    s_getpc_b64 s[92:93]
L_pf:
    s_and_b32 s93, s93, 0xffff
    s_mov_b32 s94, L_done-L_pf
    s_mov_b32 s95, 0x20000
    s_lshr_b32 s80, s2, 3
    s_lshl_b32 s80, s80, 2
    s_add_u32 s80, s80, s62
    s_and_b32 s80, s80, 63
    s_lshl_b32 s80, s80, 10
    buffer_load_dwordx4 v[28:31], v1, s[92:95], s80 offen
    buffer_load_dwordx4 v[176:179], v162, s[12:15], s71 offen offset:0 nt
    buffer_load_dwordx4 v[180:183], v162, s[12:15], s71 offen offset:128 nt
    buffer_load_dwordx4 v[184:187], v162, s[12:15], s71 offen offset:256 nt
    buffer_load_dwordx4 v[188:191], v162, s[12:15], s71 offen offset:384 nt
    buffer_load_dwordx2 v[240:241], v164, s[16:19], s74 offen offset:0
    buffer_load_dwordx2 v[242:243], v164, s[20:23], s74 offen offset:0
    buffer_load_dwordx2 v[208:209], v163, s[36:39], s73 offen offset:0
    buffer_load_dwordx2 v[210:211], v163, s[36:39], s73 offen offset:64
    buffer_load_dwordx2 v[212:213], v163, s[36:39], s73 offen offset:128
    buffer_load_dwordx2 v[214:215], v163, s[36:39], s73 offen offset:192
    buffer_load_dwordx2 v[216:217], v163, s[40:43], s73 offen offset:0
    buffer_load_dwordx2 v[218:219], v163, s[40:43], s73 offen offset:64
    buffer_load_dwordx2 v[220:221], v163, s[40:43], s73 offen offset:128
    buffer_load_dwordx2 v[222:223], v163, s[40:43], s73 offen offset:192
    buffer_load_dwordx4 v[192:195], v162, s[12:15], s71 offen offset:2048 nt
    buffer_load_dwordx4 v[196:199], v162, s[12:15], s71 offen offset:2176 nt
    buffer_load_dwordx4 v[200:203], v162, s[12:15], s71 offen offset:2304 nt
    buffer_load_dwordx4 v[204:207], v162, s[12:15], s71 offen offset:2432 nt
    buffer_load_dwordx2 v[244:245], v164, s[16:19], s74 offen offset:32
    buffer_load_dwordx2 v[246:247], v164, s[20:23], s74 offen offset:32
    buffer_load_dwordx2 v[224:225], v163, s[36:39], s73 offen offset:1024
    buffer_load_dwordx2 v[226:227], v163, s[36:39], s73 offen offset:1088
    buffer_load_dwordx2 v[228:229], v163, s[36:39], s73 offen offset:1152
    buffer_load_dwordx2 v[230:231], v163, s[36:39], s73 offen offset:1216
    buffer_load_dwordx2 v[232:233], v163, s[40:43], s73 offen offset:1024
    buffer_load_dwordx2 v[234:235], v163, s[40:43], s73 offen offset:1088
    buffer_load_dwordx2 v[236:237], v163, s[40:43], s73 offen offset:1152
    buffer_load_dwordx2 v[238:239], v163, s[40:43], s73 offen offset:1216
    buffer_load_ushort v64, v168, s[28:31], s74 offen
    buffer_load_ushort v65, v168, s[32:35], s74 offen
    buffer_load_dwordx4 v[32:35], v167, s[24:27], s71 offen offset:0 nt
    buffer_load_dwordx4 v[36:39], v167, s[24:27], s71 offen offset:512 nt
    buffer_load_dwordx4 v[40:43], v167, s[24:27], s71 offen offset:1024 nt
    buffer_load_dwordx4 v[44:47], v167, s[24:27], s71 offen offset:1536 nt
    buffer_load_dwordx4 v[48:51], v167, s[24:27], s71 offen offset:2048 nt
    buffer_load_dwordx4 v[52:55], v167, s[24:27], s71 offen offset:2560 nt
    buffer_load_dwordx4 v[56:59], v167, s[24:27], s71 offen offset:3072 nt
    buffer_load_dwordx4 v[60:63], v167, s[24:27], s71 offen offset:3584 nt
    v_lshrrev_b32 v22, 3, v0
    v_and_b32 v25, 3, v0
    v_bfe_u32 v24, v0, 2, 1
    v_lshlrev_b32 v165, 11, v24
    v_lshl_add_u32 v165, v25, 8, v165
    v_lshl_add_u32 v165, v22, 4, v165
    v_lshrrev_b32 v24, 2, v0
    v_lshl_add_u32 v169, v25, 4, v24
    v_lshlrev_b32 v169, 3, v169
    v_add_u32 v169, s86, v169
    v_lshrrev_b32 v24, 5, v0
    v_lshrrev_b32 v23, 3, v171
    v_lshlrev_b32 v170, 7, v23
    v_lshl_add_u32 v170, v24, 6, v170
    v_add_u32 v170, s86, v170
    v_lshrrev_b32 v23, 4, v171
    v_and_b32 v171, 15, v171
    v_lshlrev_b32 v171, 4, v171
    v_lshl_add_u32 v171, v23, 10, v171
    v_lshl_add_u32 v171, v24, 8, v171
    s_and_b32 s80, s75, 0x7fff
    v_add_u32 v19, s80, v165
    s_and_b32 s80, s77, 0x7fff
    v_add_u32 v20, s80, v171
    v_lshrrev_b32 v22, 3, v0
    v_and_b32 v23, 7, v0
    v_lshlrev_b32 v14, 8, v22
    v_lshl_add_u32 v14, v23, 4, v14
    v_add_u32 v15, 4096, v14
    v_add_u32 v16, 8192, v14
    v_add_u32 v17, 12288, v14
    v_and_b32 v24, 3, v23
    v_lshlrev_b32 v24, 1, v24
    v_lshrrev_b32 v25, 2, v23
    v_lshlrev_b32 v18, 3, v25
    v_lshl_add_u32 v18, v24, 8, v18
    v_xor_b32 v24, v22, v24
    v_lshl_add_u32 v18, v24, 4, v18
    s_lshl_b32 s82, s62, 14
    s_add_u32 s82, s82, 65536
    v_add_u32 v18, s82, v18
    v_xor_b32 v21, 0x110, v18
    v_mov_b32 v22, 0
    v_mov_b32 v23, 0
    v_mov_b32 v24, 0
    v_mov_b32 v25, 0
    s_nop 1
    v_mfma_f32_16x16x32_bf16 a[0:3], v[22:25], v[22:25], 0
    v_mfma_f32_16x16x32_bf16 a[4:7], v[22:25], v[22:25], 0
    v_mfma_f32_16x16x32_bf16 a[8:11], v[22:25], v[22:25], 0
    v_mfma_f32_16x16x32_bf16 a[12:15], v[22:25], v[22:25], 0
    v_mfma_f32_16x16x32_bf16 a[16:19], v[22:25], v[22:25], 0
    v_mfma_f32_16x16x32_bf16 a[20:23], v[22:25], v[22:25], 0
    v_mfma_f32_16x16x32_bf16 a[24:27], v[22:25], v[22:25], 0
    v_mfma_f32_16x16x32_bf16 a[28:31], v[22:25], v[22:25], 0
    v_mfma_f32_16x16x32_bf16 a[32:35], v[22:25], v[22:25], 0
    v_mfma_f32_16x16x32_bf16 a[36:39], v[22:25], v[22:25], 0
    v_mfma_f32_16x16x32_bf16 a[40:43], v[22:25], v[22:25], 0
    v_mfma_f32_16x16x32_bf16 a[44:47], v[22:25], v[22:25], 0
    v_mfma_f32_16x16x32_bf16 a[48:51], v[22:25], v[22:25], 0
    v_mfma_f32_16x16x32_bf16 a[52:55], v[22:25], v[22:25], 0
    v_mfma_f32_16x16x32_bf16 a[56:59], v[22:25], v[22:25], 0
    v_mfma_f32_16x16x32_bf16 a[60:63], v[22:25], v[22:25], 0
    v_mfma_f32_16x16x32_bf16 a[64:67], v[22:25], v[22:25], 0
    v_mfma_f32_16x16x32_bf16 a[68:71], v[22:25], v[22:25], 0
    v_mfma_f32_16x16x32_bf16 a[72:75], v[22:25], v[22:25], 0
    v_mfma_f32_16x16x32_bf16 a[76:79], v[22:25], v[22:25], 0
    v_mfma_f32_16x16x32_bf16 a[80:83], v[22:25], v[22:25], 0
    v_mfma_f32_16x16x32_bf16 a[84:87], v[22:25], v[22:25], 0
    v_mfma_f32_16x16x32_bf16 a[88:91], v[22:25], v[22:25], 0
    v_mfma_f32_16x16x32_bf16 a[92:95], v[22:25], v[22:25], 0
    v_mfma_f32_16x16x32_bf16 a[96:99], v[22:25], v[22:25], 0
    v_mfma_f32_16x16x32_bf16 a[100:103], v[22:25], v[22:25], 0
    v_mfma_f32_16x16x32_bf16 a[104:107], v[22:25], v[22:25], 0
    v_mfma_f32_16x16x32_bf16 a[108:111], v[22:25], v[22:25], 0
    v_mfma_f32_16x16x32_bf16 a[112:115], v[22:25], v[22:25], 0
    v_mfma_f32_16x16x32_bf16 a[116:119], v[22:25], v[22:25], 0
    v_mfma_f32_16x16x32_bf16 a[120:123], v[22:25], v[22:25], 0
    v_mfma_f32_16x16x32_bf16 a[124:127], v[22:25], v[22:25], 0
    buffer_load_dwordx4 v[66:69], v14, s[44:47], s78 offen offset:0
    s_waitcnt vmcnt(33)
    v_lshlrev_b32 v28, 16, v240
    v_and_b32 v240, 0xffff0000, v240
    v_lshlrev_b32 v29, 16, v241
    v_and_b32 v241, 0xffff0000, v241
    v_lshlrev_b32 v30, 16, v242
    v_and_b32 v242, 0xffff0000, v242
    v_lshlrev_b32 v31, 16, v243
    v_and_b32 v243, 0xffff0000, v243
    v_mul_f32 v28, s87, v28
    v_mul_f32 v240, s87, v240
    v_mul_f32 v29, s87, v29
    v_mul_f32 v241, s87, v241
    v_mul_f32_e64 v30, -v30, v28
    v_mul_f32_e64 v242, -v242, v240
    v_mul_f32_e64 v31, -v31, v29
    buffer_load_dwordx4 v[70:73], v14, s[44:47], s78 offen offset:128
    v_mul_f32_e64 v243, -v243, v241
    v_cvt_f32_i32 v176, v176
    v_cvt_f32_i32 v177, v177
    v_cvt_f32_i32 v184, v184
    v_cvt_f32_i32 v185, v185
    v_pk_fma_f32 v[176:177], v[176:177], v[28:29], v[30:31] op_sel:[0,0,0] op_sel_hi:[1,0,0]
    v_pk_fma_f32 v[184:185], v[184:185], v[28:29], v[30:31] op_sel:[0,1,1] op_sel_hi:[1,1,1]
    s_waitcnt vmcnt(26)
    v_lshlrev_b32 v248, 16, v208
    v_and_b32 v249, 0xffff0000, v208
    v_lshlrev_b32 v250, 16, v216
    v_and_b32 v251, 0xffff0000, v216
    v_lshlrev_b32 v252, 16, v212
    v_and_b32 v253, 0xffff0000, v212
    v_lshlrev_b32 v254, 16, v220
    v_and_b32 v255, 0xffff0000, v220
    buffer_load_dwordx4 v[74:77], v14, s[48:51], s79 offen offset:0
    v_pk_mul_f32 v[248:249], v[176:177], v[248:249]
    v_pk_mul_f32 v[252:253], v[184:185], v[252:253]
    v_pk_fma_f32 v[248:249], v[184:185], v[250:251], v[248:249] neg_lo:[1,0,0] neg_hi:[1,0,0]
    v_pk_fma_f32 v[252:253], v[176:177], v[254:255], v[252:253]
    v_cvt_pk_bf16_f32 v208, v248, v249
    v_cvt_pk_bf16_f32 v212, v252, v253
    v_cvt_f32_i32 v178, v178
    v_cvt_f32_i32 v179, v179
    v_cvt_f32_i32 v186, v186
    v_cvt_f32_i32 v187, v187
    v_pk_fma_f32 v[178:179], v[178:179], v[28:29], v[30:31] op_sel:[0,0,0] op_sel_hi:[1,0,0]
    v_pk_fma_f32 v[186:187], v[186:187], v[28:29], v[30:31] op_sel:[0,1,1] op_sel_hi:[1,1,1]
    v_lshlrev_b32 v248, 16, v209
    v_and_b32 v249, 0xffff0000, v209
    v_lshlrev_b32 v250, 16, v217
    v_and_b32 v251, 0xffff0000, v217
    buffer_load_dwordx4 v[78:81], v14, s[48:51], s79 offen offset:128
    v_lshlrev_b32 v252, 16, v213
    v_and_b32 v253, 0xffff0000, v213
    v_lshlrev_b32 v254, 16, v221
    v_and_b32 v255, 0xffff0000, v221
    v_pk_mul_f32 v[248:249], v[178:179], v[248:249]
    v_pk_mul_f32 v[252:253], v[186:187], v[252:253]
    v_pk_fma_f32 v[248:249], v[186:187], v[250:251], v[248:249] neg_lo:[1,0,0] neg_hi:[1,0,0]
    v_pk_fma_f32 v[252:253], v[178:179], v[254:255], v[252:253]
    v_cvt_pk_bf16_f32 v209, v248, v249
    v_cvt_pk_bf16_f32 v213, v252, v253
    v_cvt_f32_i32 v180, v180
    v_cvt_f32_i32 v181, v181
    v_cvt_f32_i32 v188, v188
    v_cvt_f32_i32 v189, v189
    v_pk_fma_f32 v[180:181], v[180:181], v[240:241], v[242:243] op_sel:[0,0,0] op_sel_hi:[1,0,0]
    v_pk_fma_f32 v[188:189], v[188:189], v[240:241], v[242:243] op_sel:[0,1,1] op_sel_hi:[1,1,1]
    buffer_load_dwordx4 v[82:85], v14, s[52:55], s79 offen offset:0
    v_lshlrev_b32 v248, 16, v210
    v_and_b32 v249, 0xffff0000, v210
    v_lshlrev_b32 v250, 16, v218
    v_and_b32 v251, 0xffff0000, v218
    v_lshlrev_b32 v252, 16, v214
    v_and_b32 v253, 0xffff0000, v214
    v_lshlrev_b32 v254, 16, v222
    v_and_b32 v255, 0xffff0000, v222
    v_pk_mul_f32 v[248:249], v[180:181], v[248:249]
    v_pk_mul_f32 v[252:253], v[188:189], v[252:253]
    v_pk_fma_f32 v[248:249], v[188:189], v[250:251], v[248:249] neg_lo:[1,0,0] neg_hi:[1,0,0]
    v_pk_fma_f32 v[252:253], v[180:181], v[254:255], v[252:253]
    v_cvt_pk_bf16_f32 v210, v248, v249
    v_cvt_pk_bf16_f32 v214, v252, v253
    v_cvt_f32_i32 v182, v182
    v_cvt_f32_i32 v183, v183
    v_cvt_f32_i32 v190, v190
    buffer_load_dwordx4 v[86:89], v14, s[52:55], s79 offen offset:128
    v_cvt_f32_i32 v191, v191
    v_pk_fma_f32 v[182:183], v[182:183], v[240:241], v[242:243] op_sel:[0,0,0] op_sel_hi:[1,0,0]
    v_pk_fma_f32 v[190:191], v[190:191], v[240:241], v[242:243] op_sel:[0,1,1] op_sel_hi:[1,1,1]
    v_lshlrev_b32 v248, 16, v211
    v_and_b32 v249, 0xffff0000, v211
    v_lshlrev_b32 v250, 16, v219
    v_and_b32 v251, 0xffff0000, v219
    v_lshlrev_b32 v252, 16, v215
    v_and_b32 v253, 0xffff0000, v215
    v_lshlrev_b32 v254, 16, v223
    v_and_b32 v255, 0xffff0000, v223
    v_pk_mul_f32 v[248:249], v[182:183], v[248:249]
    v_pk_mul_f32 v[252:253], v[190:191], v[252:253]
    v_pk_fma_f32 v[248:249], v[190:191], v[250:251], v[248:249] neg_lo:[1,0,0] neg_hi:[1,0,0]
    v_pk_fma_f32 v[252:253], v[182:183], v[254:255], v[252:253]
    v_cvt_pk_bf16_f32 v211, v248, v249
    buffer_load_dwordx4 v[90:93], v14, s[44:47], s78 offen offset:2048
    v_cvt_pk_bf16_f32 v215, v252, v253
    buffer_store_dwordx4 v[208:211], v165, s[4:7], s75 offen offset:0 sc1
    buffer_store_dwordx4 v[212:215], v165, s[4:7], s76 offen offset:0 sc1
    ds_write_b128 v19, v[208:211] offset:0
    ds_write_b128 v19, v[212:215] offset:4096
    s_cmp_lg_u32 s62, 0
    s_cbranch_scc1 L_nononce2
    v_readfirstlane_b32 s80, v10
    v_readfirstlane_b32 s81, v11
    s_nop 3
    s_cmp_eq_u64 s[80:81], 0
    s_cbranch_scc1 L_mynonce
    v_mov_b32 v6, s80
    v_mov_b32 v7, s81
L_mynonce:
    v_mov_b32 v10, 133120
    ds_write_b64 v10, v[6:7]
L_nononce2:
    s_waitcnt vmcnt(27)
    v_lshlrev_b32 v28, 16, v244
    v_and_b32 v244, 0xffff0000, v244
    v_lshlrev_b32 v29, 16, v245
    v_and_b32 v245, 0xffff0000, v245
    v_lshlrev_b32 v30, 16, v246
    v_and_b32 v246, 0xffff0000, v246
    buffer_load_dwordx4 v[94:97], v14, s[44:47], s78 offen offset:2176
    v_lshlrev_b32 v31, 16, v247
    v_and_b32 v247, 0xffff0000, v247
    v_mul_f32 v28, s87, v28
    v_mul_f32 v244, s87, v244
    v_mul_f32 v29, s87, v29
    v_mul_f32 v245, s87, v245
    v_mul_f32_e64 v30, -v30, v28
    v_mul_f32_e64 v246, -v246, v244
    v_mul_f32_e64 v31, -v31, v29
    v_mul_f32_e64 v247, -v247, v245
    v_cvt_f32_i32 v192, v192
    v_cvt_f32_i32 v193, v193
    v_cvt_f32_i32 v200, v200
    v_cvt_f32_i32 v201, v201
    v_pk_fma_f32 v[192:193], v[192:193], v[28:29], v[30:31] op_sel:[0,0,0] op_sel_hi:[1,0,0]
    v_pk_fma_f32 v[200:201], v[200:201], v[28:29], v[30:31] op_sel:[0,1,1] op_sel_hi:[1,1,1]
    buffer_load_dwordx4 v[98:101], v14, s[48:51], s79 offen offset:2048
    s_waitcnt vmcnt(21)
    v_lshlrev_b32 v248, 16, v224
    v_and_b32 v249, 0xffff0000, v224
    v_lshlrev_b32 v250, 16, v232
    v_and_b32 v251, 0xffff0000, v232
    v_lshlrev_b32 v252, 16, v228
    v_and_b32 v253, 0xffff0000, v228
    v_lshlrev_b32 v254, 16, v236
    v_and_b32 v255, 0xffff0000, v236
    v_pk_mul_f32 v[248:249], v[192:193], v[248:249]
    v_pk_mul_f32 v[252:253], v[200:201], v[252:253]
    v_pk_fma_f32 v[248:249], v[200:201], v[250:251], v[248:249] neg_lo:[1,0,0] neg_hi:[1,0,0]
    v_pk_fma_f32 v[252:253], v[192:193], v[254:255], v[252:253]
    v_cvt_pk_bf16_f32 v224, v248, v249
    v_cvt_pk_bf16_f32 v228, v252, v253
    v_cvt_f32_i32 v194, v194
    v_cvt_f32_i32 v195, v195
    buffer_load_dwordx4 v[102:105], v14, s[48:51], s79 offen offset:2176
    v_cvt_f32_i32 v202, v202
    v_cvt_f32_i32 v203, v203
    v_pk_fma_f32 v[194:195], v[194:195], v[28:29], v[30:31] op_sel:[0,0,0] op_sel_hi:[1,0,0]
    v_pk_fma_f32 v[202:203], v[202:203], v[28:29], v[30:31] op_sel:[0,1,1] op_sel_hi:[1,1,1]
    v_lshlrev_b32 v248, 16, v225
    v_and_b32 v249, 0xffff0000, v225
    v_lshlrev_b32 v250, 16, v233
    v_and_b32 v251, 0xffff0000, v233
    v_lshlrev_b32 v252, 16, v229
    v_and_b32 v253, 0xffff0000, v229
    v_lshlrev_b32 v254, 16, v237
    v_and_b32 v255, 0xffff0000, v237
    v_pk_mul_f32 v[248:249], v[194:195], v[248:249]
    v_pk_mul_f32 v[252:253], v[202:203], v[252:253]
    v_pk_fma_f32 v[248:249], v[202:203], v[250:251], v[248:249] neg_lo:[1,0,0] neg_hi:[1,0,0]
    v_pk_fma_f32 v[252:253], v[194:195], v[254:255], v[252:253]
    buffer_load_dwordx4 v[106:109], v14, s[52:55], s79 offen offset:2048
    v_cvt_pk_bf16_f32 v225, v248, v249
    v_cvt_pk_bf16_f32 v229, v252, v253
    v_cvt_f32_i32 v196, v196
    v_cvt_f32_i32 v197, v197
    v_cvt_f32_i32 v204, v204
    v_cvt_f32_i32 v205, v205
    v_pk_fma_f32 v[196:197], v[196:197], v[244:245], v[246:247] op_sel:[0,0,0] op_sel_hi:[1,0,0]
    v_pk_fma_f32 v[204:205], v[204:205], v[244:245], v[246:247] op_sel:[0,1,1] op_sel_hi:[1,1,1]
    v_lshlrev_b32 v248, 16, v226
    v_and_b32 v249, 0xffff0000, v226
    v_lshlrev_b32 v250, 16, v234
    v_and_b32 v251, 0xffff0000, v234
    v_lshlrev_b32 v252, 16, v230
    v_and_b32 v253, 0xffff0000, v230
    v_lshlrev_b32 v254, 16, v238
    v_and_b32 v255, 0xffff0000, v238
    buffer_load_dwordx4 v[110:113], v14, s[52:55], s79 offen offset:2176
    v_pk_mul_f32 v[248:249], v[196:197], v[248:249]
    v_pk_mul_f32 v[252:253], v[204:205], v[252:253]
    v_pk_fma_f32 v[248:249], v[204:205], v[250:251], v[248:249] neg_lo:[1,0,0] neg_hi:[1,0,0]
    v_pk_fma_f32 v[252:253], v[196:197], v[254:255], v[252:253]
    v_cvt_pk_bf16_f32 v226, v248, v249
    v_cvt_pk_bf16_f32 v230, v252, v253
    v_cvt_f32_i32 v198, v198
    v_cvt_f32_i32 v199, v199
    v_cvt_f32_i32 v206, v206
    v_cvt_f32_i32 v207, v207
    v_pk_fma_f32 v[198:199], v[198:199], v[244:245], v[246:247] op_sel:[0,0,0] op_sel_hi:[1,0,0]
    v_pk_fma_f32 v[206:207], v[206:207], v[244:245], v[246:247] op_sel:[0,1,1] op_sel_hi:[1,1,1]
    v_lshlrev_b32 v248, 16, v227
    v_and_b32 v249, 0xffff0000, v227
    v_lshlrev_b32 v250, 16, v235
    v_and_b32 v251, 0xffff0000, v235
    buffer_load_dwordx4 v[114:117], v15, s[44:47], s78 offen offset:0
    v_lshlrev_b32 v252, 16, v231
    v_and_b32 v253, 0xffff0000, v231
    v_lshlrev_b32 v254, 16, v239
    v_and_b32 v255, 0xffff0000, v239
    v_pk_mul_f32 v[248:249], v[198:199], v[248:249]
    v_pk_mul_f32 v[252:253], v[206:207], v[252:253]
    v_pk_fma_f32 v[248:249], v[206:207], v[250:251], v[248:249] neg_lo:[1,0,0] neg_hi:[1,0,0]
    v_pk_fma_f32 v[252:253], v[198:199], v[254:255], v[252:253]
    v_cvt_pk_bf16_f32 v227, v248, v249
    v_cvt_pk_bf16_f32 v231, v252, v253
    buffer_store_dwordx4 v[224:227], v165, s[4:7], s75 offen offset:1024 sc1
    buffer_store_dwordx4 v[228:231], v165, s[4:7], s76 offen offset:1024 sc1
    ds_write_b128 v19, v[224:227] offset:1024
    ds_write_b128 v19, v[228:231] offset:5120
    s_waitcnt vmcnt(25)
    v_lshlrev_b32 v64, 16, v64
    buffer_load_dwordx4 v[118:121], v15, s[44:47], s78 offen offset:128
    v_lshlrev_b32 v65, 16, v65
    v_mul_f32_e64 v65, -v65, v64
    ds_write_b64 v169, v[64:65]
    s_waitcnt vmcnt(22)
    v_cvt_f32_i32 v32, v32
    v_cvt_f32_i32 v33, v33
    v_cvt_f32_i32 v34, v34
    v_cvt_f32_i32 v35, v35
    v_cvt_f32_i32 v36, v36
    v_cvt_f32_i32 v37, v37
    v_cvt_f32_i32 v38, v38
    v_cvt_f32_i32 v39, v39
    v_cvt_f32_i32 v40, v40
    v_cvt_f32_i32 v41, v41
    v_cvt_f32_i32 v42, v42
    v_cvt_f32_i32 v43, v43
    buffer_load_dwordx4 v[122:125], v15, s[48:51], s79 offen offset:0
    v_cvt_f32_i32 v44, v44
    v_cvt_f32_i32 v45, v45
    v_cvt_f32_i32 v46, v46
    v_cvt_f32_i32 v47, v47
    s_waitcnt lgkmcnt(0)
    ds_read_b128 v[176:179], v170 offset:0
    ds_read_b128 v[180:183], v170 offset:16
    ds_read_b128 v[184:187], v170 offset:32
    ds_read_b128 v[188:191], v170 offset:48
    s_waitcnt vmcnt(19)
    v_cvt_f32_i32 v48, v48
    v_cvt_f32_i32 v49, v49
    v_cvt_f32_i32 v50, v50
    v_cvt_f32_i32 v51, v51
    v_cvt_f32_i32 v52, v52
    v_cvt_f32_i32 v53, v53
    buffer_load_dwordx4 v[126:129], v15, s[48:51], s79 offen offset:128
    v_cvt_f32_i32 v54, v54
    v_cvt_f32_i32 v55, v55
    v_cvt_f32_i32 v56, v56
    v_cvt_f32_i32 v57, v57
    v_cvt_f32_i32 v58, v58
    v_cvt_f32_i32 v59, v59
    v_cvt_f32_i32 v60, v60
    v_cvt_f32_i32 v61, v61
    v_cvt_f32_i32 v62, v62
    v_cvt_f32_i32 v63, v63
    s_waitcnt lgkmcnt(0)
    v_pk_fma_f32 v[32:33], v[32:33], v[176:177], v[176:177] op_sel:[0,0,1] op_sel_hi:[1,0,1]
    v_pk_fma_f32 v[34:35], v[34:35], v[176:177], v[176:177] op_sel:[0,0,1] op_sel_hi:[1,0,1]
    v_pk_fma_f32 v[36:37], v[36:37], v[178:179], v[178:179] op_sel:[0,0,1] op_sel_hi:[1,0,1]
    v_pk_fma_f32 v[38:39], v[38:39], v[178:179], v[178:179] op_sel:[0,0,1] op_sel_hi:[1,0,1]
    v_cvt_pk_bf16_f32 v192, v32, v36
    buffer_load_dwordx4 v[130:133], v15, s[52:55], s79 offen offset:0
    v_cvt_pk_bf16_f32 v196, v33, v37
    v_cvt_pk_bf16_f32 v200, v34, v38
    v_cvt_pk_bf16_f32 v204, v35, v39
    v_pk_fma_f32 v[40:41], v[40:41], v[180:181], v[180:181] op_sel:[0,0,1] op_sel_hi:[1,0,1]
    v_pk_fma_f32 v[42:43], v[42:43], v[180:181], v[180:181] op_sel:[0,0,1] op_sel_hi:[1,0,1]
    v_pk_fma_f32 v[44:45], v[44:45], v[182:183], v[182:183] op_sel:[0,0,1] op_sel_hi:[1,0,1]
    v_pk_fma_f32 v[46:47], v[46:47], v[182:183], v[182:183] op_sel:[0,0,1] op_sel_hi:[1,0,1]
    v_cvt_pk_bf16_f32 v193, v40, v44
    v_cvt_pk_bf16_f32 v197, v41, v45
    v_cvt_pk_bf16_f32 v201, v42, v46
    v_cvt_pk_bf16_f32 v205, v43, v47
    v_pk_fma_f32 v[48:49], v[48:49], v[184:185], v[184:185] op_sel:[0,0,1] op_sel_hi:[1,0,1]
    v_pk_fma_f32 v[50:51], v[50:51], v[184:185], v[184:185] op_sel:[0,0,1] op_sel_hi:[1,0,1]
    v_pk_fma_f32 v[52:53], v[52:53], v[186:187], v[186:187] op_sel:[0,0,1] op_sel_hi:[1,0,1]
    v_pk_fma_f32 v[54:55], v[54:55], v[186:187], v[186:187] op_sel:[0,0,1] op_sel_hi:[1,0,1]
    v_cvt_pk_bf16_f32 v194, v48, v52
    v_cvt_pk_bf16_f32 v198, v49, v53
    buffer_load_dwordx4 v[134:137], v15, s[52:55], s79 offen offset:128
    v_cvt_pk_bf16_f32 v202, v50, v54
    v_cvt_pk_bf16_f32 v206, v51, v55
    v_pk_fma_f32 v[56:57], v[56:57], v[188:189], v[188:189] op_sel:[0,0,1] op_sel_hi:[1,0,1]
    v_pk_fma_f32 v[58:59], v[58:59], v[188:189], v[188:189] op_sel:[0,0,1] op_sel_hi:[1,0,1]
    v_pk_fma_f32 v[60:61], v[60:61], v[190:191], v[190:191] op_sel:[0,0,1] op_sel_hi:[1,0,1]
    v_pk_fma_f32 v[62:63], v[62:63], v[190:191], v[190:191] op_sel:[0,0,1] op_sel_hi:[1,0,1]
    v_cvt_pk_bf16_f32 v195, v56, v60
    v_cvt_pk_bf16_f32 v199, v57, v61
    v_cvt_pk_bf16_f32 v203, v58, v62
    v_cvt_pk_bf16_f32 v207, v59, v63
    buffer_store_dwordx4 v[192:195], v171, s[4:7], s77 offen offset:0 sc1
    buffer_store_dwordx4 v[196:199], v171, s[4:7], s77 offen offset:2048 sc1
    buffer_store_dwordx4 v[200:203], v171, s[4:7], s72 offen offset:0 sc1
    buffer_store_dwordx4 v[204:207], v171, s[4:7], s72 offen offset:2048 sc1
    ds_write_b128 v20, v[192:195] offset:0
    ds_write_b128 v20, v[196:199] offset:2048
    buffer_load_dwordx4 v[138:141], v15, s[44:47], s78 offen offset:2048
    ds_write_b128 v20, v[200:203] offset:4096
    ds_write_b128 v20, v[204:207] offset:6144
    s_add_u32 s71, s71, 32768
    s_add_u32 s73, s73, 16384
    s_add_u32 s74, s74, 512
    s_add_u32 s75, s75, 32768
    s_add_u32 s76, s76, 32768
    s_add_u32 s77, s77, 32768
    s_add_u32 s72, s72, 32768
    s_waitcnt vmcnt(21)
    v_lshlrev_b32 v22, 16, v66
    v_and_b32 v23, 0xffff0000, v66
    v_lshlrev_b32 v24, 16, v70
    v_and_b32 v25, 0xffff0000, v70
    buffer_load_dwordx4 v[142:145], v15, s[44:47], s78 offen offset:2176
    v_lshlrev_b32 v248, 16, v74
    v_and_b32 v249, 0xffff0000, v74
    v_lshlrev_b32 v250, 16, v82
    v_and_b32 v251, 0xffff0000, v82
    v_lshlrev_b32 v252, 16, v78
    v_and_b32 v253, 0xffff0000, v78
    v_lshlrev_b32 v254, 16, v86
    v_and_b32 v255, 0xffff0000, v86
    v_pk_mul_f32 v[248:249], v[22:23], v[248:249]
    v_pk_mul_f32 v[252:253], v[24:25], v[252:253]
    v_pk_fma_f32 v[248:249], v[24:25], v[250:251], v[248:249] neg_lo:[1,0,0] neg_hi:[1,0,0]
    v_pk_fma_f32 v[252:253], v[22:23], v[254:255], v[252:253]
    v_cvt_pk_bf16_f32 v66, v248, v249
    v_cvt_pk_bf16_f32 v70, v252, v253
    v_lshlrev_b32 v22, 16, v67
    v_and_b32 v23, 0xffff0000, v67
    buffer_load_dwordx4 v[146:149], v15, s[48:51], s79 offen offset:2048
    v_lshlrev_b32 v24, 16, v71
    v_and_b32 v25, 0xffff0000, v71
    v_lshlrev_b32 v248, 16, v75
    v_and_b32 v249, 0xffff0000, v75
    v_lshlrev_b32 v250, 16, v83
    v_and_b32 v251, 0xffff0000, v83
    v_lshlrev_b32 v252, 16, v79
    v_and_b32 v253, 0xffff0000, v79
    v_lshlrev_b32 v254, 16, v87
    v_and_b32 v255, 0xffff0000, v87
    v_pk_mul_f32 v[248:249], v[22:23], v[248:249]
    v_pk_mul_f32 v[252:253], v[24:25], v[252:253]
    v_pk_fma_f32 v[248:249], v[24:25], v[250:251], v[248:249] neg_lo:[1,0,0] neg_hi:[1,0,0]
    v_pk_fma_f32 v[252:253], v[22:23], v[254:255], v[252:253]
    v_cvt_pk_bf16_f32 v67, v248, v249
    v_cvt_pk_bf16_f32 v71, v252, v253
    v_lshlrev_b32 v22, 16, v68
    buffer_load_dwordx4 v[150:153], v15, s[48:51], s79 offen offset:2176
    v_and_b32 v23, 0xffff0000, v68
    v_lshlrev_b32 v24, 16, v72
    v_and_b32 v25, 0xffff0000, v72
    v_lshlrev_b32 v248, 16, v76
    v_and_b32 v249, 0xffff0000, v76
    v_lshlrev_b32 v250, 16, v84
    v_and_b32 v251, 0xffff0000, v84
    v_lshlrev_b32 v252, 16, v80
    v_and_b32 v253, 0xffff0000, v80
    v_lshlrev_b32 v254, 16, v88
    v_and_b32 v255, 0xffff0000, v88
    v_pk_mul_f32 v[248:249], v[22:23], v[248:249]
    v_pk_mul_f32 v[252:253], v[24:25], v[252:253]
    v_pk_fma_f32 v[248:249], v[24:25], v[250:251], v[248:249] neg_lo:[1,0,0] neg_hi:[1,0,0]
    v_pk_fma_f32 v[252:253], v[22:23], v[254:255], v[252:253]
    v_cvt_pk_bf16_f32 v68, v248, v249
    buffer_load_dwordx4 v[154:157], v15, s[52:55], s79 offen offset:2048
    v_cvt_pk_bf16_f32 v72, v252, v253
    v_lshlrev_b32 v22, 16, v69
    v_and_b32 v23, 0xffff0000, v69
    v_lshlrev_b32 v24, 16, v73
    v_and_b32 v25, 0xffff0000, v73
    v_lshlrev_b32 v248, 16, v77
    v_and_b32 v249, 0xffff0000, v77
    v_lshlrev_b32 v250, 16, v85
    v_and_b32 v251, 0xffff0000, v85
    v_lshlrev_b32 v252, 16, v81
    v_and_b32 v253, 0xffff0000, v81
    v_lshlrev_b32 v254, 16, v89
    v_and_b32 v255, 0xffff0000, v89
    v_pk_mul_f32 v[248:249], v[22:23], v[248:249]
    v_pk_mul_f32 v[252:253], v[24:25], v[252:253]
    v_pk_fma_f32 v[248:249], v[24:25], v[250:251], v[248:249] neg_lo:[1,0,0] neg_hi:[1,0,0]
    buffer_load_dwordx4 v[158:161], v15, s[52:55], s79 offen offset:2176
    v_pk_fma_f32 v[252:253], v[22:23], v[254:255], v[252:253]
    v_cvt_pk_bf16_f32 v69, v248, v249
    v_cvt_pk_bf16_f32 v73, v252, v253
    ds_write_b64 v18, v[66:67] offset:0
    ds_write_b64 v21, v[68:69] offset:0
    ds_write_b64 v18, v[70:71] offset:2048
    ds_write_b64 v21, v[72:73] offset:2048
    s_waitcnt vmcnt(18)
    v_lshlrev_b32 v22, 16, v90
    v_and_b32 v23, 0xffff0000, v90
    v_lshlrev_b32 v24, 16, v94
    v_and_b32 v25, 0xffff0000, v94
    v_lshlrev_b32 v248, 16, v98
    v_and_b32 v249, 0xffff0000, v98
    v_lshlrev_b32 v250, 16, v106
    buffer_load_dwordx4 a[128:131], v16, s[44:47], s78 offen offset:0
    v_and_b32 v251, 0xffff0000, v106
    v_lshlrev_b32 v252, 16, v102
    v_and_b32 v253, 0xffff0000, v102
    v_lshlrev_b32 v254, 16, v110
    v_and_b32 v255, 0xffff0000, v110
    v_pk_mul_f32 v[248:249], v[22:23], v[248:249]
    v_pk_mul_f32 v[252:253], v[24:25], v[252:253]
    v_pk_fma_f32 v[248:249], v[24:25], v[250:251], v[248:249] neg_lo:[1,0,0] neg_hi:[1,0,0]
    v_pk_fma_f32 v[252:253], v[22:23], v[254:255], v[252:253]
    v_cvt_pk_bf16_f32 v90, v248, v249
    v_cvt_pk_bf16_f32 v94, v252, v253
    v_lshlrev_b32 v22, 16, v91
    v_and_b32 v23, 0xffff0000, v91
    v_lshlrev_b32 v24, 16, v95
    v_and_b32 v25, 0xffff0000, v95
    v_lshlrev_b32 v248, 16, v99
    v_and_b32 v249, 0xffff0000, v99
    buffer_load_dwordx4 a[132:135], v16, s[44:47], s78 offen offset:128
    v_lshlrev_b32 v250, 16, v107
    v_and_b32 v251, 0xffff0000, v107
    v_lshlrev_b32 v252, 16, v103
    v_and_b32 v253, 0xffff0000, v103
    v_lshlrev_b32 v254, 16, v111
    v_and_b32 v255, 0xffff0000, v111
    v_pk_mul_f32 v[248:249], v[22:23], v[248:249]
    v_pk_mul_f32 v[252:253], v[24:25], v[252:253]
    v_pk_fma_f32 v[248:249], v[24:25], v[250:251], v[248:249] neg_lo:[1,0,0] neg_hi:[1,0,0]
    v_pk_fma_f32 v[252:253], v[22:23], v[254:255], v[252:253]
    v_cvt_pk_bf16_f32 v91, v248, v249
    v_cvt_pk_bf16_f32 v95, v252, v253
    v_lshlrev_b32 v22, 16, v92
    v_and_b32 v23, 0xffff0000, v92
    v_lshlrev_b32 v24, 16, v96
    v_and_b32 v25, 0xffff0000, v96
    buffer_load_dwordx4 a[136:139], v16, s[48:51], s79 offen offset:0
    v_lshlrev_b32 v248, 16, v100
    v_and_b32 v249, 0xffff0000, v100
    v_lshlrev_b32 v250, 16, v108
    v_and_b32 v251, 0xffff0000, v108
    v_lshlrev_b32 v252, 16, v104
    v_and_b32 v253, 0xffff0000, v104
    v_lshlrev_b32 v254, 16, v112
    v_and_b32 v255, 0xffff0000, v112
    v_pk_mul_f32 v[248:249], v[22:23], v[248:249]
    v_pk_mul_f32 v[252:253], v[24:25], v[252:253]
    v_pk_fma_f32 v[248:249], v[24:25], v[250:251], v[248:249] neg_lo:[1,0,0] neg_hi:[1,0,0]
    v_pk_fma_f32 v[252:253], v[22:23], v[254:255], v[252:253]
    v_cvt_pk_bf16_f32 v92, v248, v249
    v_cvt_pk_bf16_f32 v96, v252, v253
    v_lshlrev_b32 v22, 16, v93
    v_and_b32 v23, 0xffff0000, v93
    buffer_load_dwordx4 a[140:143], v16, s[48:51], s79 offen offset:128
    v_lshlrev_b32 v24, 16, v97
    v_and_b32 v25, 0xffff0000, v97
    v_lshlrev_b32 v248, 16, v101
    v_and_b32 v249, 0xffff0000, v101
    v_lshlrev_b32 v250, 16, v109
    v_and_b32 v251, 0xffff0000, v109
    v_lshlrev_b32 v252, 16, v105
    v_and_b32 v253, 0xffff0000, v105
    v_lshlrev_b32 v254, 16, v113
    v_and_b32 v255, 0xffff0000, v113
    v_pk_mul_f32 v[248:249], v[22:23], v[248:249]
    v_pk_mul_f32 v[252:253], v[24:25], v[252:253]
    v_pk_fma_f32 v[248:249], v[24:25], v[250:251], v[248:249] neg_lo:[1,0,0] neg_hi:[1,0,0]
    v_pk_fma_f32 v[252:253], v[22:23], v[254:255], v[252:253]
    v_cvt_pk_bf16_f32 v93, v248, v249
    v_cvt_pk_bf16_f32 v97, v252, v253
    buffer_load_dwordx4 a[144:147], v16, s[52:55], s79 offen offset:0
    ds_write_b64 v18, v[90:91] offset:128
    ds_write_b64 v21, v[92:93] offset:128
    ds_write_b64 v18, v[94:95] offset:2176
    ds_write_b64 v21, v[96:97] offset:2176
    s_waitcnt vmcnt(11)
    s_waitcnt lgkmcnt(0)
    s_barrier
    v_mov_b32 v22, 133120
    ds_read_b64 v[6:7], v22
    s_waitcnt lgkmcnt(0)
    s_cmp_lg_u32 s62, 0
    s_cbranch_scc1 L_pub1
    s_lshl_b32 s80, s61, 3
    v_mov_b32 v22, s80
    s_mov_b64 exec, 1
    buffer_store_dwordx2 v[6:7], v22, s[8:11], s85 offen sc1
    s_mov_b64 exec, -1
L_pub1:
    s_add_u32 s85, s85, 128
    s_waitcnt vmcnt(15)
    v_lshlrev_b32 v22, 16, v114
    v_and_b32 v23, 0xffff0000, v114
    v_lshlrev_b32 v24, 16, v118
    v_and_b32 v25, 0xffff0000, v118
    v_lshlrev_b32 v248, 16, v122
    v_and_b32 v249, 0xffff0000, v122
    v_lshlrev_b32 v250, 16, v130
    v_and_b32 v251, 0xffff0000, v130
    v_lshlrev_b32 v252, 16, v126
    v_and_b32 v253, 0xffff0000, v126
    buffer_load_dwordx4 a[148:151], v16, s[52:55], s79 offen offset:128
    v_lshlrev_b32 v254, 16, v134
    v_and_b32 v255, 0xffff0000, v134
    v_pk_mul_f32 v[248:249], v[22:23], v[248:249]
    v_pk_mul_f32 v[252:253], v[24:25], v[252:253]
    v_pk_fma_f32 v[248:249], v[24:25], v[250:251], v[248:249] neg_lo:[1,0,0] neg_hi:[1,0,0]
    v_pk_fma_f32 v[252:253], v[22:23], v[254:255], v[252:253]
    v_cvt_pk_bf16_f32 v114, v248, v249
    v_cvt_pk_bf16_f32 v118, v252, v253
    v_lshlrev_b32 v22, 16, v115
    v_and_b32 v23, 0xffff0000, v115
    v_lshlrev_b32 v24, 16, v119
    v_and_b32 v25, 0xffff0000, v119
    v_lshlrev_b32 v248, 16, v123
    v_and_b32 v249, 0xffff0000, v123
    v_lshlrev_b32 v250, 16, v131
    v_and_b32 v251, 0xffff0000, v131
    buffer_load_dwordx4 a[152:155], v16, s[44:47], s78 offen offset:2048
    v_lshlrev_b32 v252, 16, v127
    v_and_b32 v253, 0xffff0000, v127
    v_lshlrev_b32 v254, 16, v135
    v_and_b32 v255, 0xffff0000, v135
    v_pk_mul_f32 v[248:249], v[22:23], v[248:249]
    v_pk_mul_f32 v[252:253], v[24:25], v[252:253]
    v_pk_fma_f32 v[248:249], v[24:25], v[250:251], v[248:249] neg_lo:[1,0,0] neg_hi:[1,0,0]
    v_pk_fma_f32 v[252:253], v[22:23], v[254:255], v[252:253]
    v_cvt_pk_bf16_f32 v115, v248, v249
    v_cvt_pk_bf16_f32 v119, v252, v253
    v_lshlrev_b32 v22, 16, v116
    v_and_b32 v23, 0xffff0000, v116
    v_lshlrev_b32 v24, 16, v120
    v_and_b32 v25, 0xffff0000, v120
    v_lshlrev_b32 v248, 16, v124
    v_and_b32 v249, 0xffff0000, v124
    buffer_load_dwordx4 a[156:159], v16, s[44:47], s78 offen offset:2176
    v_lshlrev_b32 v250, 16, v132
    v_and_b32 v251, 0xffff0000, v132
    v_lshlrev_b32 v252, 16, v128
    v_and_b32 v253, 0xffff0000, v128
    v_lshlrev_b32 v254, 16, v136
    v_and_b32 v255, 0xffff0000, v136
    v_pk_mul_f32 v[248:249], v[22:23], v[248:249]
    v_pk_mul_f32 v[252:253], v[24:25], v[252:253]
    v_pk_fma_f32 v[248:249], v[24:25], v[250:251], v[248:249] neg_lo:[1,0,0] neg_hi:[1,0,0]
    v_pk_fma_f32 v[252:253], v[22:23], v[254:255], v[252:253]
    v_cvt_pk_bf16_f32 v116, v248, v249
    v_cvt_pk_bf16_f32 v120, v252, v253
    v_lshlrev_b32 v22, 16, v117
    v_and_b32 v23, 0xffff0000, v117
    v_lshlrev_b32 v24, 16, v121
    v_and_b32 v25, 0xffff0000, v121
    buffer_load_dwordx4 a[160:163], v16, s[48:51], s79 offen offset:2048
    v_lshlrev_b32 v248, 16, v125
    v_and_b32 v249, 0xffff0000, v125
    v_lshlrev_b32 v250, 16, v133
    v_and_b32 v251, 0xffff0000, v133
    v_lshlrev_b32 v252, 16, v129
    v_and_b32 v253, 0xffff0000, v129
    v_lshlrev_b32 v254, 16, v137
    v_and_b32 v255, 0xffff0000, v137
    v_pk_mul_f32 v[248:249], v[22:23], v[248:249]
    v_pk_mul_f32 v[252:253], v[24:25], v[252:253]
    v_pk_fma_f32 v[248:249], v[24:25], v[250:251], v[248:249] neg_lo:[1,0,0] neg_hi:[1,0,0]
    v_pk_fma_f32 v[252:253], v[22:23], v[254:255], v[252:253]
    v_cvt_pk_bf16_f32 v117, v248, v249
    v_cvt_pk_bf16_f32 v121, v252, v253
    ds_write_b64 v18, v[114:115] offset:4096
    ds_write_b64 v21, v[116:117] offset:4096
    ds_write_b64 v18, v[118:119] offset:6144
    buffer_load_dwordx4 a[164:167], v16, s[48:51], s79 offen offset:2176
    ds_write_b64 v21, v[120:121] offset:6144
    s_waitcnt vmcnt(10)
    v_lshlrev_b32 v22, 16, v138
    v_and_b32 v23, 0xffff0000, v138
    v_lshlrev_b32 v24, 16, v142
    v_and_b32 v25, 0xffff0000, v142
    v_lshlrev_b32 v248, 16, v146
    v_and_b32 v249, 0xffff0000, v146
    v_lshlrev_b32 v250, 16, v154
    v_and_b32 v251, 0xffff0000, v154
    v_lshlrev_b32 v252, 16, v150
    v_and_b32 v253, 0xffff0000, v150
    v_lshlrev_b32 v254, 16, v158
    v_and_b32 v255, 0xffff0000, v158
    v_pk_mul_f32 v[248:249], v[22:23], v[248:249]
    buffer_load_dwordx4 a[168:171], v16, s[52:55], s79 offen offset:2048
    v_pk_mul_f32 v[252:253], v[24:25], v[252:253]
    v_pk_fma_f32 v[248:249], v[24:25], v[250:251], v[248:249] neg_lo:[1,0,0] neg_hi:[1,0,0]
    v_pk_fma_f32 v[252:253], v[22:23], v[254:255], v[252:253]
    v_cvt_pk_bf16_f32 v138, v248, v249
    v_cvt_pk_bf16_f32 v142, v252, v253
    v_lshlrev_b32 v22, 16, v139
    v_and_b32 v23, 0xffff0000, v139
    v_lshlrev_b32 v24, 16, v143
    v_and_b32 v25, 0xffff0000, v143
    v_lshlrev_b32 v248, 16, v147
    v_and_b32 v249, 0xffff0000, v147
    v_lshlrev_b32 v250, 16, v155
    v_and_b32 v251, 0xffff0000, v155
    v_lshlrev_b32 v252, 16, v151
    v_and_b32 v253, 0xffff0000, v151
    v_lshlrev_b32 v254, 16, v159
    buffer_load_dwordx4 a[172:175], v16, s[52:55], s79 offen offset:2176
    v_and_b32 v255, 0xffff0000, v159
    v_pk_mul_f32 v[248:249], v[22:23], v[248:249]
    v_pk_mul_f32 v[252:253], v[24:25], v[252:253]
    v_pk_fma_f32 v[248:249], v[24:25], v[250:251], v[248:249] neg_lo:[1,0,0] neg_hi:[1,0,0]
    v_pk_fma_f32 v[252:253], v[22:23], v[254:255], v[252:253]
    v_cvt_pk_bf16_f32 v139, v248, v249
    v_cvt_pk_bf16_f32 v143, v252, v253
    v_lshlrev_b32 v22, 16, v140
    v_and_b32 v23, 0xffff0000, v140
    v_lshlrev_b32 v24, 16, v144
    v_and_b32 v25, 0xffff0000, v144
    v_lshlrev_b32 v248, 16, v148
    v_and_b32 v249, 0xffff0000, v148
    v_lshlrev_b32 v250, 16, v156
    v_and_b32 v251, 0xffff0000, v156
    v_lshlrev_b32 v252, 16, v152
    buffer_load_dwordx4 a[176:179], v17, s[44:47], s78 offen offset:0
    v_and_b32 v253, 0xffff0000, v152
    v_lshlrev_b32 v254, 16, v160
    v_and_b32 v255, 0xffff0000, v160
    v_pk_mul_f32 v[248:249], v[22:23], v[248:249]
    v_pk_mul_f32 v[252:253], v[24:25], v[252:253]
    v_pk_fma_f32 v[248:249], v[24:25], v[250:251], v[248:249] neg_lo:[1,0,0] neg_hi:[1,0,0]
    v_pk_fma_f32 v[252:253], v[22:23], v[254:255], v[252:253]
    v_cvt_pk_bf16_f32 v140, v248, v249
    v_cvt_pk_bf16_f32 v144, v252, v253
    v_lshlrev_b32 v22, 16, v141
    v_and_b32 v23, 0xffff0000, v141
    v_lshlrev_b32 v24, 16, v145
    v_and_b32 v25, 0xffff0000, v145
    v_lshlrev_b32 v248, 16, v149
    v_and_b32 v249, 0xffff0000, v149
    v_lshlrev_b32 v250, 16, v157
    v_and_b32 v251, 0xffff0000, v157
    buffer_load_dwordx4 a[180:183], v17, s[44:47], s78 offen offset:128
    v_lshlrev_b32 v252, 16, v153
    v_and_b32 v253, 0xffff0000, v153
    v_lshlrev_b32 v254, 16, v161
    v_and_b32 v255, 0xffff0000, v161
    v_pk_mul_f32 v[248:249], v[22:23], v[248:249]
    v_pk_mul_f32 v[252:253], v[24:25], v[252:253]
    v_pk_fma_f32 v[248:249], v[24:25], v[250:251], v[248:249] neg_lo:[1,0,0] neg_hi:[1,0,0]
    v_pk_fma_f32 v[252:253], v[22:23], v[254:255], v[252:253]
    v_cvt_pk_bf16_f32 v141, v248, v249
    v_cvt_pk_bf16_f32 v145, v252, v253
    ds_write_b64 v18, v[138:139] offset:4224
    ds_write_b64 v21, v[140:141] offset:4224
    ds_write_b64 v18, v[142:143] offset:6272
    ds_write_b64 v21, v[144:145] offset:6272
    s_waitcnt vmcnt(8)
    buffer_load_dwordx4 a[184:187], v17, s[48:51], s79 offen offset:0
    v_accvgpr_read_b32 v176, a128
    v_accvgpr_read_b32 v177, a129
    v_accvgpr_read_b32 v178, a130
    v_accvgpr_read_b32 v179, a131
    v_accvgpr_read_b32 v180, a132
    v_accvgpr_read_b32 v181, a133
    v_accvgpr_read_b32 v182, a134
    v_accvgpr_read_b32 v183, a135
    v_accvgpr_read_b32 v184, a136
    v_accvgpr_read_b32 v185, a137
    v_accvgpr_read_b32 v186, a138
    v_accvgpr_read_b32 v187, a139
    v_accvgpr_read_b32 v188, a140
    v_accvgpr_read_b32 v189, a141
    v_accvgpr_read_b32 v190, a142
    v_accvgpr_read_b32 v191, a143
    buffer_load_dwordx4 a[188:191], v17, s[48:51], s79 offen offset:128
    v_accvgpr_read_b32 v192, a144
    v_accvgpr_read_b32 v193, a145
    v_accvgpr_read_b32 v194, a146
    v_accvgpr_read_b32 v195, a147
    v_accvgpr_read_b32 v196, a148
    v_accvgpr_read_b32 v197, a149
    v_accvgpr_read_b32 v198, a150
    v_accvgpr_read_b32 v199, a151
    v_lshlrev_b32 v22, 16, v176
    v_and_b32 v23, 0xffff0000, v176
    v_lshlrev_b32 v24, 16, v180
    v_and_b32 v25, 0xffff0000, v180
    v_lshlrev_b32 v248, 16, v184
    v_and_b32 v249, 0xffff0000, v184
    v_lshlrev_b32 v250, 16, v192
    v_and_b32 v251, 0xffff0000, v192
    buffer_load_dwordx4 a[192:195], v17, s[52:55], s79 offen offset:0
    v_lshlrev_b32 v252, 16, v188
    v_and_b32 v253, 0xffff0000, v188
    v_lshlrev_b32 v254, 16, v196
    v_and_b32 v255, 0xffff0000, v196
    v_pk_mul_f32 v[248:249], v[22:23], v[248:249]
    v_pk_mul_f32 v[252:253], v[24:25], v[252:253]
    v_pk_fma_f32 v[248:249], v[24:25], v[250:251], v[248:249] neg_lo:[1,0,0] neg_hi:[1,0,0]
    v_pk_fma_f32 v[252:253], v[22:23], v[254:255], v[252:253]
    v_cvt_pk_bf16_f32 v176, v248, v249
    v_cvt_pk_bf16_f32 v180, v252, v253
    v_lshlrev_b32 v22, 16, v177
    v_and_b32 v23, 0xffff0000, v177
    v_lshlrev_b32 v24, 16, v181
    v_and_b32 v25, 0xffff0000, v181
    v_lshlrev_b32 v248, 16, v185
    v_and_b32 v249, 0xffff0000, v185
    v_lshlrev_b32 v250, 16, v193
    buffer_load_dwordx4 a[196:199], v17, s[52:55], s79 offen offset:128
    v_and_b32 v251, 0xffff0000, v193
    v_lshlrev_b32 v252, 16, v189
    v_and_b32 v253, 0xffff0000, v189
    v_lshlrev_b32 v254, 16, v197
    v_and_b32 v255, 0xffff0000, v197
    v_pk_mul_f32 v[248:249], v[22:23], v[248:249]
    v_pk_mul_f32 v[252:253], v[24:25], v[252:253]
    v_pk_fma_f32 v[248:249], v[24:25], v[250:251], v[248:249] neg_lo:[1,0,0] neg_hi:[1,0,0]
    v_pk_fma_f32 v[252:253], v[22:23], v[254:255], v[252:253]
    v_cvt_pk_bf16_f32 v177, v248, v249
    v_cvt_pk_bf16_f32 v181, v252, v253
    v_lshlrev_b32 v22, 16, v178
    v_and_b32 v23, 0xffff0000, v178
    v_lshlrev_b32 v24, 16, v182
    v_and_b32 v25, 0xffff0000, v182
    v_lshlrev_b32 v248, 16, v186
    buffer_load_dwordx4 a[200:203], v17, s[44:47], s78 offen offset:2048
    v_and_b32 v249, 0xffff0000, v186
    v_lshlrev_b32 v250, 16, v194
    v_and_b32 v251, 0xffff0000, v194
    v_lshlrev_b32 v252, 16, v190
    v_and_b32 v253, 0xffff0000, v190
    v_lshlrev_b32 v254, 16, v198
    v_and_b32 v255, 0xffff0000, v198
    v_pk_mul_f32 v[248:249], v[22:23], v[248:249]
    v_pk_mul_f32 v[252:253], v[24:25], v[252:253]
    v_pk_fma_f32 v[248:249], v[24:25], v[250:251], v[248:249] neg_lo:[1,0,0] neg_hi:[1,0,0]
    v_pk_fma_f32 v[252:253], v[22:23], v[254:255], v[252:253]
    v_cvt_pk_bf16_f32 v178, v248, v249
    v_cvt_pk_bf16_f32 v182, v252, v253
    v_lshlrev_b32 v22, 16, v179
    v_and_b32 v23, 0xffff0000, v179
    v_lshlrev_b32 v24, 16, v183
    buffer_load_dwordx4 a[204:207], v17, s[44:47], s78 offen offset:2176
    v_and_b32 v25, 0xffff0000, v183
    v_lshlrev_b32 v248, 16, v187
    v_and_b32 v249, 0xffff0000, v187
    v_lshlrev_b32 v250, 16, v195
    v_and_b32 v251, 0xffff0000, v195
    v_lshlrev_b32 v252, 16, v191
    v_and_b32 v253, 0xffff0000, v191
    v_lshlrev_b32 v254, 16, v199
    v_and_b32 v255, 0xffff0000, v199
    v_pk_mul_f32 v[248:249], v[22:23], v[248:249]
    v_pk_mul_f32 v[252:253], v[24:25], v[252:253]
    v_pk_fma_f32 v[248:249], v[24:25], v[250:251], v[248:249] neg_lo:[1,0,0] neg_hi:[1,0,0]
    v_pk_fma_f32 v[252:253], v[22:23], v[254:255], v[252:253]
    v_cvt_pk_bf16_f32 v179, v248, v249
    v_cvt_pk_bf16_f32 v183, v252, v253
    ds_write_b64 v18, v[176:177] offset:8192
    buffer_load_dwordx4 a[208:211], v17, s[48:51], s79 offen offset:2048
    ds_write_b64 v21, v[178:179] offset:8192
    ds_write_b64 v18, v[180:181] offset:10240
    ds_write_b64 v21, v[182:183] offset:10240
    s_waitcnt vmcnt(9)
    v_accvgpr_read_b32 v200, a152
    v_accvgpr_read_b32 v201, a153
    v_accvgpr_read_b32 v202, a154
    v_accvgpr_read_b32 v203, a155
    v_accvgpr_read_b32 v204, a156
    v_accvgpr_read_b32 v205, a157
    v_accvgpr_read_b32 v206, a158
    v_accvgpr_read_b32 v207, a159
    v_accvgpr_read_b32 v208, a160
    v_accvgpr_read_b32 v209, a161
    v_accvgpr_read_b32 v210, a162
    v_accvgpr_read_b32 v211, a163
    buffer_load_dwordx4 a[212:215], v17, s[48:51], s79 offen offset:2176
    v_accvgpr_read_b32 v212, a164
    v_accvgpr_read_b32 v213, a165
    v_accvgpr_read_b32 v214, a166
    v_accvgpr_read_b32 v215, a167
    v_accvgpr_read_b32 v216, a168
    v_accvgpr_read_b32 v217, a169
    v_accvgpr_read_b32 v218, a170
    v_accvgpr_read_b32 v219, a171
    v_accvgpr_read_b32 v220, a172
    v_accvgpr_read_b32 v221, a173
    v_accvgpr_read_b32 v222, a174
    v_accvgpr_read_b32 v223, a175
    v_lshlrev_b32 v22, 16, v200
    v_and_b32 v23, 0xffff0000, v200
    v_lshlrev_b32 v24, 16, v204
    v_and_b32 v25, 0xffff0000, v204
    buffer_load_dwordx4 a[216:219], v17, s[52:55], s79 offen offset:2048
    v_lshlrev_b32 v248, 16, v208
    v_and_b32 v249, 0xffff0000, v208
    v_lshlrev_b32 v250, 16, v216
    v_and_b32 v251, 0xffff0000, v216
    v_lshlrev_b32 v252, 16, v212
    v_and_b32 v253, 0xffff0000, v212
    v_lshlrev_b32 v254, 16, v220
    v_and_b32 v255, 0xffff0000, v220
    v_pk_mul_f32 v[248:249], v[22:23], v[248:249]
    v_pk_mul_f32 v[252:253], v[24:25], v[252:253]
    v_pk_fma_f32 v[248:249], v[24:25], v[250:251], v[248:249] neg_lo:[1,0,0] neg_hi:[1,0,0]
    v_pk_fma_f32 v[252:253], v[22:23], v[254:255], v[252:253]
    v_cvt_pk_bf16_f32 v200, v248, v249
    v_cvt_pk_bf16_f32 v204, v252, v253
    v_lshlrev_b32 v22, 16, v201
    v_and_b32 v23, 0xffff0000, v201
    buffer_load_dwordx4 a[220:223], v17, s[52:55], s79 offen offset:2176
    v_lshlrev_b32 v24, 16, v205
    v_and_b32 v25, 0xffff0000, v205
    v_lshlrev_b32 v248, 16, v209
    v_and_b32 v249, 0xffff0000, v209
    v_lshlrev_b32 v250, 16, v217
    v_and_b32 v251, 0xffff0000, v217
    v_lshlrev_b32 v252, 16, v213
    v_and_b32 v253, 0xffff0000, v213
    v_lshlrev_b32 v254, 16, v221
    v_and_b32 v255, 0xffff0000, v221
    v_pk_mul_f32 v[248:249], v[22:23], v[248:249]
    v_pk_mul_f32 v[252:253], v[24:25], v[252:253]
    v_pk_fma_f32 v[248:249], v[24:25], v[250:251], v[248:249] neg_lo:[1,0,0] neg_hi:[1,0,0]
    v_pk_fma_f32 v[252:253], v[22:23], v[254:255], v[252:253]
    v_cvt_pk_bf16_f32 v201, v248, v249
    v_cvt_pk_bf16_f32 v205, v252, v253
    v_lshlrev_b32 v22, 16, v202
    v_and_b32 v23, 0xffff0000, v202
    v_lshlrev_b32 v24, 16, v206
    v_and_b32 v25, 0xffff0000, v206
    v_lshlrev_b32 v248, 16, v210
    v_and_b32 v249, 0xffff0000, v210
    v_lshlrev_b32 v250, 16, v218
    v_and_b32 v251, 0xffff0000, v218
    v_lshlrev_b32 v252, 16, v214
    v_and_b32 v253, 0xffff0000, v214
    v_lshlrev_b32 v254, 16, v222
    v_and_b32 v255, 0xffff0000, v222
    v_pk_mul_f32 v[248:249], v[22:23], v[248:249]
    v_pk_mul_f32 v[252:253], v[24:25], v[252:253]
    v_pk_fma_f32 v[248:249], v[24:25], v[250:251], v[248:249] neg_lo:[1,0,0] neg_hi:[1,0,0]
    v_pk_fma_f32 v[252:253], v[22:23], v[254:255], v[252:253]
    v_cvt_pk_bf16_f32 v202, v248, v249
    v_cvt_pk_bf16_f32 v206, v252, v253
    v_lshlrev_b32 v22, 16, v203
    v_and_b32 v23, 0xffff0000, v203
    v_lshlrev_b32 v24, 16, v207
    v_and_b32 v25, 0xffff0000, v207
    v_lshlrev_b32 v248, 16, v211
    v_and_b32 v249, 0xffff0000, v211
    v_lshlrev_b32 v250, 16, v219
    v_and_b32 v251, 0xffff0000, v219
    v_lshlrev_b32 v252, 16, v215
    v_and_b32 v253, 0xffff0000, v215
    v_lshlrev_b32 v254, 16, v223
    v_and_b32 v255, 0xffff0000, v223
    v_pk_mul_f32 v[248:249], v[22:23], v[248:249]
    v_pk_mul_f32 v[252:253], v[24:25], v[252:253]
    v_pk_fma_f32 v[248:249], v[24:25], v[250:251], v[248:249] neg_lo:[1,0,0] neg_hi:[1,0,0]
    v_pk_fma_f32 v[252:253], v[22:23], v[254:255], v[252:253]
    v_cvt_pk_bf16_f32 v203, v248, v249
    v_cvt_pk_bf16_f32 v207, v252, v253
    ds_write_b64 v18, v[200:201] offset:8320
    ds_write_b64 v21, v[202:203] offset:8320
    ds_write_b64 v18, v[204:205] offset:10368
    ds_write_b64 v21, v[206:207] offset:10368
    s_waitcnt vmcnt(6)
    v_accvgpr_read_b32 v176, a176
    v_accvgpr_read_b32 v177, a177
    v_accvgpr_read_b32 v178, a178
    v_accvgpr_read_b32 v179, a179
    v_accvgpr_read_b32 v180, a180
    v_accvgpr_read_b32 v181, a181
    v_accvgpr_read_b32 v182, a182
    v_accvgpr_read_b32 v183, a183
    v_accvgpr_read_b32 v184, a184
    v_accvgpr_read_b32 v185, a185
    v_accvgpr_read_b32 v186, a186
    v_accvgpr_read_b32 v187, a187
    v_accvgpr_read_b32 v188, a188
    v_accvgpr_read_b32 v189, a189
    v_accvgpr_read_b32 v190, a190
    v_accvgpr_read_b32 v191, a191
    v_accvgpr_read_b32 v192, a192
    v_accvgpr_read_b32 v193, a193
    v_accvgpr_read_b32 v194, a194
    v_accvgpr_read_b32 v195, a195
    v_accvgpr_read_b32 v196, a196
    v_accvgpr_read_b32 v197, a197
    v_accvgpr_read_b32 v198, a198
    v_accvgpr_read_b32 v199, a199
    v_lshlrev_b32 v22, 16, v176
    v_and_b32 v23, 0xffff0000, v176
    v_lshlrev_b32 v24, 16, v180
    v_and_b32 v25, 0xffff0000, v180
    v_lshlrev_b32 v248, 16, v184
    v_and_b32 v249, 0xffff0000, v184
    v_lshlrev_b32 v250, 16, v192
    v_and_b32 v251, 0xffff0000, v192
    v_lshlrev_b32 v252, 16, v188
    v_and_b32 v253, 0xffff0000, v188
    v_lshlrev_b32 v254, 16, v196
    v_and_b32 v255, 0xffff0000, v196
    v_pk_mul_f32 v[248:249], v[22:23], v[248:249]
    v_pk_mul_f32 v[252:253], v[24:25], v[252:253]
    v_pk_fma_f32 v[248:249], v[24:25], v[250:251], v[248:249] neg_lo:[1,0,0] neg_hi:[1,0,0]
    v_pk_fma_f32 v[252:253], v[22:23], v[254:255], v[252:253]
    v_cvt_pk_bf16_f32 v176, v248, v249
    v_cvt_pk_bf16_f32 v180, v252, v253
    v_lshlrev_b32 v22, 16, v177
    v_and_b32 v23, 0xffff0000, v177
    v_lshlrev_b32 v24, 16, v181
    v_and_b32 v25, 0xffff0000, v181
    v_lshlrev_b32 v248, 16, v185
    v_and_b32 v249, 0xffff0000, v185
    v_lshlrev_b32 v250, 16, v193
    v_and_b32 v251, 0xffff0000, v193
    v_lshlrev_b32 v252, 16, v189
    v_and_b32 v253, 0xffff0000, v189
    v_lshlrev_b32 v254, 16, v197
    v_and_b32 v255, 0xffff0000, v197
    v_pk_mul_f32 v[248:249], v[22:23], v[248:249]
    v_pk_mul_f32 v[252:253], v[24:25], v[252:253]
    v_pk_fma_f32 v[248:249], v[24:25], v[250:251], v[248:249] neg_lo:[1,0,0] neg_hi:[1,0,0]
    v_pk_fma_f32 v[252:253], v[22:23], v[254:255], v[252:253]
    v_cvt_pk_bf16_f32 v177, v248, v249
    v_cvt_pk_bf16_f32 v181, v252, v253
    v_lshlrev_b32 v22, 16, v178
    v_and_b32 v23, 0xffff0000, v178
    v_lshlrev_b32 v24, 16, v182
    v_and_b32 v25, 0xffff0000, v182
    v_lshlrev_b32 v248, 16, v186
    v_and_b32 v249, 0xffff0000, v186
    v_lshlrev_b32 v250, 16, v194
    v_and_b32 v251, 0xffff0000, v194
    v_lshlrev_b32 v252, 16, v190
    v_and_b32 v253, 0xffff0000, v190
    v_lshlrev_b32 v254, 16, v198
    v_and_b32 v255, 0xffff0000, v198
    v_pk_mul_f32 v[248:249], v[22:23], v[248:249]
    v_pk_mul_f32 v[252:253], v[24:25], v[252:253]
    v_pk_fma_f32 v[248:249], v[24:25], v[250:251], v[248:249] neg_lo:[1,0,0] neg_hi:[1,0,0]
    v_pk_fma_f32 v[252:253], v[22:23], v[254:255], v[252:253]
    v_cvt_pk_bf16_f32 v178, v248, v249
    v_cvt_pk_bf16_f32 v182, v252, v253
    v_lshlrev_b32 v22, 16, v179
    v_and_b32 v23, 0xffff0000, v179
    v_lshlrev_b32 v24, 16, v183
    v_and_b32 v25, 0xffff0000, v183
    v_lshlrev_b32 v248, 16, v187
    v_and_b32 v249, 0xffff0000, v187
    v_lshlrev_b32 v250, 16, v195
    v_and_b32 v251, 0xffff0000, v195
    v_lshlrev_b32 v252, 16, v191
    v_and_b32 v253, 0xffff0000, v191
    v_lshlrev_b32 v254, 16, v199
    v_and_b32 v255, 0xffff0000, v199
    v_pk_mul_f32 v[248:249], v[22:23], v[248:249]
    v_pk_mul_f32 v[252:253], v[24:25], v[252:253]
    v_pk_fma_f32 v[248:249], v[24:25], v[250:251], v[248:249] neg_lo:[1,0,0] neg_hi:[1,0,0]
    v_pk_fma_f32 v[252:253], v[22:23], v[254:255], v[252:253]
    v_cvt_pk_bf16_f32 v179, v248, v249
    v_cvt_pk_bf16_f32 v183, v252, v253
    ds_write_b64 v18, v[176:177] offset:12288
    ds_write_b64 v21, v[178:179] offset:12288
    ds_write_b64 v18, v[180:181] offset:14336
    ds_write_b64 v21, v[182:183] offset:14336
    s_add_u32 s80, s61, 0
    s_and_b32 s80, s80, 7
    s_lshl_b32 s44, s80, 17
    s_add_u32 s80, s61, 1
    s_and_b32 s80, s80, 7
    s_lshl_b32 s45, s80, 17
    s_add_u32 s80, s61, 2
    s_and_b32 s80, s80, 7
    s_lshl_b32 s46, s80, 17
    s_add_u32 s80, s61, 3
    s_and_b32 s80, s80, 7
    s_lshl_b32 s47, s80, 17
    s_add_u32 s80, s61, 4
    s_and_b32 s80, s80, 7
    s_lshl_b32 s48, s80, 17
    s_add_u32 s80, s61, 5
    s_and_b32 s80, s80, 7
    s_lshl_b32 s49, s80, 17
    s_add_u32 s80, s61, 6
    s_and_b32 s80, s80, 7
    s_lshl_b32 s50, s80, 17
    s_add_u32 s80, s61, 7
    s_and_b32 s80, s80, 7
    s_lshl_b32 s51, s80, 17
    buffer_load_dwordx2 v[4:5], v8, s[8:11], s88 offen sc1
    s_waitcnt vmcnt(1)
    v_accvgpr_read_b32 v200, a200
    v_accvgpr_read_b32 v201, a201
    v_accvgpr_read_b32 v202, a202
    v_accvgpr_read_b32 v203, a203
    v_accvgpr_read_b32 v204, a204
    v_accvgpr_read_b32 v205, a205
    v_accvgpr_read_b32 v206, a206
    v_accvgpr_read_b32 v207, a207
    v_accvgpr_read_b32 v208, a208
    v_accvgpr_read_b32 v209, a209
    v_accvgpr_read_b32 v210, a210
    v_accvgpr_read_b32 v211, a211
    v_accvgpr_read_b32 v212, a212
    v_accvgpr_read_b32 v213, a213
    v_accvgpr_read_b32 v214, a214
    v_accvgpr_read_b32 v215, a215
    v_accvgpr_read_b32 v216, a216
    v_accvgpr_read_b32 v217, a217
    v_accvgpr_read_b32 v218, a218
    v_accvgpr_read_b32 v219, a219
    v_accvgpr_read_b32 v220, a220
    v_accvgpr_read_b32 v221, a221
    v_accvgpr_read_b32 v222, a222
    v_accvgpr_read_b32 v223, a223
    v_lshlrev_b32 v22, 16, v200
    v_and_b32 v23, 0xffff0000, v200
    v_lshlrev_b32 v24, 16, v204
    v_and_b32 v25, 0xffff0000, v204
    v_lshlrev_b32 v248, 16, v208
    v_and_b32 v249, 0xffff0000, v208
    v_lshlrev_b32 v250, 16, v216
    v_and_b32 v251, 0xffff0000, v216
    v_lshlrev_b32 v252, 16, v212
    v_and_b32 v253, 0xffff0000, v212
    v_lshlrev_b32 v254, 16, v220
    v_and_b32 v255, 0xffff0000, v220
    v_pk_mul_f32 v[248:249], v[22:23], v[248:249]
    v_pk_mul_f32 v[252:253], v[24:25], v[252:253]
    v_pk_fma_f32 v[248:249], v[24:25], v[250:251], v[248:249] neg_lo:[1,0,0] neg_hi:[1,0,0]
    v_pk_fma_f32 v[252:253], v[22:23], v[254:255], v[252:253]
    v_cvt_pk_bf16_f32 v200, v248, v249
    v_cvt_pk_bf16_f32 v204, v252, v253
    v_lshlrev_b32 v22, 16, v201
    v_and_b32 v23, 0xffff0000, v201
    v_lshlrev_b32 v24, 16, v205
    v_and_b32 v25, 0xffff0000, v205
    v_lshlrev_b32 v248, 16, v209
    v_and_b32 v249, 0xffff0000, v209
    v_lshlrev_b32 v250, 16, v217
    v_and_b32 v251, 0xffff0000, v217
    v_lshlrev_b32 v252, 16, v213
    v_and_b32 v253, 0xffff0000, v213
    v_lshlrev_b32 v254, 16, v221
    v_and_b32 v255, 0xffff0000, v221
    v_pk_mul_f32 v[248:249], v[22:23], v[248:249]
    v_pk_mul_f32 v[252:253], v[24:25], v[252:253]
    v_pk_fma_f32 v[248:249], v[24:25], v[250:251], v[248:249] neg_lo:[1,0,0] neg_hi:[1,0,0]
    v_pk_fma_f32 v[252:253], v[22:23], v[254:255], v[252:253]
    v_cvt_pk_bf16_f32 v201, v248, v249
    v_cvt_pk_bf16_f32 v205, v252, v253
    v_lshlrev_b32 v22, 16, v202
    v_and_b32 v23, 0xffff0000, v202
    v_lshlrev_b32 v24, 16, v206
    v_and_b32 v25, 0xffff0000, v206
    v_lshlrev_b32 v248, 16, v210
    v_and_b32 v249, 0xffff0000, v210
    v_lshlrev_b32 v250, 16, v218
    v_and_b32 v251, 0xffff0000, v218
    v_lshlrev_b32 v252, 16, v214
    v_and_b32 v253, 0xffff0000, v214
    v_lshlrev_b32 v254, 16, v222
    v_and_b32 v255, 0xffff0000, v222
    v_pk_mul_f32 v[248:249], v[22:23], v[248:249]
    v_pk_mul_f32 v[252:253], v[24:25], v[252:253]
    v_pk_fma_f32 v[248:249], v[24:25], v[250:251], v[248:249] neg_lo:[1,0,0] neg_hi:[1,0,0]
    v_pk_fma_f32 v[252:253], v[22:23], v[254:255], v[252:253]
    v_cvt_pk_bf16_f32 v202, v248, v249
    v_cvt_pk_bf16_f32 v206, v252, v253
    v_lshlrev_b32 v22, 16, v203
    v_and_b32 v23, 0xffff0000, v203
    v_lshlrev_b32 v24, 16, v207
    v_and_b32 v25, 0xffff0000, v207
    v_lshlrev_b32 v248, 16, v211
    v_and_b32 v249, 0xffff0000, v211
    v_lshlrev_b32 v250, 16, v219
    v_and_b32 v251, 0xffff0000, v219
    v_lshlrev_b32 v252, 16, v215
    v_and_b32 v253, 0xffff0000, v215
    v_lshlrev_b32 v254, 16, v223
    v_and_b32 v255, 0xffff0000, v223
    v_pk_mul_f32 v[248:249], v[22:23], v[248:249]
    v_pk_mul_f32 v[252:253], v[24:25], v[252:253]
    v_pk_fma_f32 v[248:249], v[24:25], v[250:251], v[248:249] neg_lo:[1,0,0] neg_hi:[1,0,0]
    v_pk_fma_f32 v[252:253], v[22:23], v[254:255], v[252:253]
    v_cvt_pk_bf16_f32 v203, v248, v249
    v_cvt_pk_bf16_f32 v207, v252, v253
    ds_write_b64 v18, v[200:201] offset:12416
    ds_write_b64 v21, v[202:203] offset:12416
    ds_write_b64 v18, v[204:205] offset:14464
    ds_write_b64 v21, v[206:207] offset:14464
    v_lshrrev_b32 v22, 4, v0
    v_and_b32 v23, 7, v0
    v_xor_b32 v23, v23, v22
    v_lshlrev_b32 v23, 4, v23
    v_lshrrev_b32 v24, 3, v0
    v_lshl_add_u32 v23, v24, 7, v23
    v_add_u32 v23, s82, v23
    v_xor_b32 v24, 64, v23
    s_waitcnt lgkmcnt(0)
    ds_read_b128 a[224:227], v23 offset:0
    ds_read_b128 a[228:231], v24 offset:1024
    ds_read_b128 a[232:235], v23 offset:2048
    ds_read_b128 a[236:239], v24 offset:3072
    ds_read_b128 a[240:243], v23 offset:4096
    ds_read_b128 a[244:247], v24 offset:5120
    ds_read_b128 a[248:251], v23 offset:6144
    ds_read_b128 a[252:255], v24 offset:7168
    ds_read_b128 v[128:131], v23 offset:8192
    ds_read_b128 v[132:135], v24 offset:9216
    ds_read_b128 v[136:139], v23 offset:10240
    ds_read_b128 v[140:143], v24 offset:11264
    ds_read_b128 v[144:147], v23 offset:12288
    ds_read_b128 v[148:151], v24 offset:13312
    ds_read_b128 v[152:155], v23 offset:14336
    ds_read_b128 v[156:159], v24 offset:15360
    ds_read_b128 a[128:131], v1 offset:0
    ds_read_b128 a[132:135], v1 offset:1024
    ds_read_b128 a[136:139], v1 offset:2048
    ds_read_b128 a[140:143], v1 offset:3072
    ds_read_b128 a[144:147], v1 offset:4096
    ds_read_b128 a[148:151], v1 offset:5120
    ds_read_b128 a[152:155], v1 offset:6144
    ds_read_b128 a[156:159], v1 offset:7168
    v_and_b32 v25, 3, v0
    v_mov_b32 v26, 0x3f803f80
    v_cmp_eq_u32 vcc, 0, v25
    v_cmp_eq_u32 s[80:81], 2, v25
    s_nop 1
    s_or_b64 vcc, vcc, s[80:81]
    s_nop 1
    v_cndmask_b32 v14, 0, v26, vcc
    v_cndmask_b32 v15, 0, v26, vcc
    v_cndmask_b32 v16, 0, v26, vcc
    v_cndmask_b32 v17, 0, v26, vcc
    v_cmp_eq_u32 vcc, 1, v25
    v_cmp_eq_u32 s[80:81], 2, v25
    s_nop 1
    s_or_b64 vcc, vcc, s[80:81]
    s_nop 1
    v_cndmask_b32 v18, 0, v26, vcc
    v_cndmask_b32 v19, 0, v26, vcc
    v_cndmask_b32 v20, 0, v26, vcc
    v_cndmask_b32 v21, 0, v26, vcc
    v_mov_b32 v84, 0
    v_mov_b32 v85, 0
    v_mov_b32 v86, 0
    v_mov_b32 v87, 0
    v_mov_b32 v92, 0
    v_mov_b32 v93, 0
    v_mov_b32 v94, 0
    v_mov_b32 v95, 0
    s_waitcnt vmcnt(0)
    v_cmp_eq_u64 vcc, v[4:5], v[6:7]
    s_nop 3
    s_andn2_b32 s83, 0x110, vcc_lo
    s_cbranch_scc0 L_have12
    s_mov_b32 s84, 0x40000
L_spin2:
    buffer_load_dwordx2 v[4:5], v8, s[8:11], s88 offen sc1
    s_waitcnt vmcnt(0)
    v_cmp_eq_u64 vcc, v[4:5], v[6:7]
    s_nop 3
    s_andn2_b32 s83, 0x110, vcc_lo
    s_cbranch_scc0 L_spun2
    s_sleep 8
    s_sub_u32 s84, s84, 1
    s_cmp_lg_u32 s84, 0
    s_cbranch_scc1 L_spin2
L_spun2:
L_have12:
    s_waitcnt lgkmcnt(0)
    s_barrier
    v_mfma_f32_16x16x32_bf16 v[32:35], a[128:131], a[224:227], 0
    s_add_u32 s64, s45, 0
    s_add_u32 m0, s65, 32768
    s_nop 0
    buffer_load_dwordx4 v3, s[4:7], s64 offen offset:0 lds
    v_mfma_f32_16x16x32_bf16 v[40:43], a[128:131], a[240:243], 0
    v_mfma_f32_16x16x32_bf16 v[36:39], a[132:135], a[224:227], 0
    v_mfma_f32_16x16x32_bf16 v[44:47], a[132:135], a[240:243], 0
    v_mfma_f32_16x16x32_bf16 v[32:35], a[136:139], a[228:231], v[32:35]
    buffer_load_dwordx4 v3, s[4:7], s64 offen offset:1024 lds
    v_mfma_f32_16x16x32_bf16 v[40:43], a[136:139], a[244:247], v[40:43]
    v_mfma_f32_16x16x32_bf16 v[36:39], a[140:143], a[228:231], v[36:39]
    v_mfma_f32_16x16x32_bf16 v[44:47], a[140:143], a[244:247], v[44:47]
    v_mfma_f32_16x16x32_bf16 v[32:35], a[144:147], a[232:235], v[32:35]
    buffer_load_dwordx4 v3, s[4:7], s64 offen offset:2048 lds
    v_mfma_f32_16x16x32_bf16 v[40:43], a[144:147], a[248:251], v[40:43]
    v_mfma_f32_16x16x32_bf16 v[36:39], a[148:151], a[232:235], v[36:39]
    v_mfma_f32_16x16x32_bf16 v[44:47], a[148:151], a[248:251], v[44:47]
    v_mfma_f32_16x16x32_bf16 v[32:35], a[152:155], a[236:239], v[32:35]
    buffer_load_dwordx4 v3, s[4:7], s64 offen offset:3072 lds
    v_mfma_f32_16x16x32_bf16 v[40:43], a[152:155], a[252:255], v[40:43]
    v_mfma_f32_16x16x32_bf16 v[36:39], a[156:159], a[236:239], v[36:39]
    v_mfma_f32_16x16x32_bf16 v[44:47], a[156:159], a[252:255], v[44:47]
    v_mfma_f32_16x16x32_bf16 v[48:51], a[128:131], v[128:131], 0
    s_add_u32 m0, s65, 36864
    s_nop 0
    buffer_load_dwordx4 v9, s[4:7], s64 offen offset:0 lds
    v_mfma_f32_16x16x32_bf16 v[56:59], a[128:131], v[144:147], 0
    v_mfma_f32_16x16x32_bf16 v[52:55], a[132:135], v[128:131], 0
    v_mfma_f32_16x16x32_bf16 v[60:63], a[132:135], v[144:147], 0
    v_mfma_f32_16x16x32_bf16 v[48:51], a[136:139], v[132:135], v[48:51]
    buffer_load_dwordx4 v9, s[4:7], s64 offen offset:1024 lds
    v_mfma_f32_16x16x32_bf16 v[56:59], a[136:139], v[148:151], v[56:59]
    v_mfma_f32_16x16x32_bf16 v[52:55], a[140:143], v[132:135], v[52:55]
    v_mfma_f32_16x16x32_bf16 v[60:63], a[140:143], v[148:151], v[60:63]
    v_mfma_f32_16x16x32_bf16 v[48:51], a[144:147], v[136:139], v[48:51]
    buffer_load_dwordx4 v9, s[4:7], s64 offen offset:2048 lds
    v_mfma_f32_16x16x32_bf16 v[56:59], a[144:147], v[152:155], v[56:59]
    v_mfma_f32_16x16x32_bf16 v[52:55], a[148:151], v[136:139], v[52:55]
    v_mfma_f32_16x16x32_bf16 v[60:63], a[148:151], v[152:155], v[60:63]
    v_mfma_f32_16x16x32_bf16 v[48:51], a[152:155], v[140:143], v[48:51]
    buffer_load_dwordx4 v9, s[4:7], s64 offen offset:3072 lds
    v_mfma_f32_16x16x32_bf16 v[56:59], a[152:155], v[156:159], v[56:59]
    v_mfma_f32_16x16x32_bf16 v[52:55], a[156:159], v[140:143], v[52:55]
    v_mfma_f32_16x16x32_bf16 v[60:63], a[156:159], v[156:159], v[60:63]
    buffer_load_dwordx2 v[4:5], v8, s[8:11], s88 offen sc1
    s_nop 3
    v_max3_f32 v22, v32, v33, v34
    v_max3_f32 v22, v22, v35, v36
    v_max3_f32 v22, v22, v37, v38
    v_max_f32 v22, v22, v39
    v_mov_b32 v23, v22
    s_nop 1
    v_permlane32_swap_b32 v22, v23
    v_max_f32 v22, v22, v23
    v_mov_b32 v23, v22
    s_nop 1
    v_permlane16_swap_b32 v22, v23
    v_max_f32 v22, v22, v23
    v_sub_f32 v32, v32, v22
    v_sub_f32 v33, v33, v22
    v_sub_f32 v34, v34, v22
    v_sub_f32 v35, v35, v22
    v_sub_f32 v36, v36, v22
    v_sub_f32 v37, v37, v22
    v_sub_f32 v38, v38, v22
    v_sub_f32 v39, v39, v22
    v_sub_f32 v64, 0, v22
    v_sub_f32 v65, 0, v22
    v_sub_f32 v66, 0, v22
    v_sub_f32 v67, 0, v22
    v_max3_f32 v22, v40, v41, v42
    v_max3_f32 v22, v22, v43, v44
    v_max3_f32 v22, v22, v45, v46
    v_max_f32 v22, v22, v47
    v_mov_b32 v23, v22
    s_nop 1
    v_permlane32_swap_b32 v22, v23
    v_max_f32 v22, v22, v23
    v_mov_b32 v23, v22
    s_nop 1
    v_permlane16_swap_b32 v22, v23
    v_max_f32 v22, v22, v23
    v_sub_f32 v40, v40, v22
    v_sub_f32 v41, v41, v22
    v_sub_f32 v42, v42, v22
    v_sub_f32 v43, v43, v22
    v_sub_f32 v44, v44, v22
    v_sub_f32 v45, v45, v22
    v_sub_f32 v46, v46, v22
    v_sub_f32 v47, v47, v22
    v_sub_f32 v68, 0, v22
    v_sub_f32 v69, 0, v22
    v_sub_f32 v70, 0, v22
    v_sub_f32 v71, 0, v22
    v_max3_f32 v22, v48, v49, v50
    v_max3_f32 v22, v22, v51, v52
    v_max3_f32 v22, v22, v53, v54
    v_max_f32 v22, v22, v55
    v_mov_b32 v23, v22
    s_nop 1
    v_permlane32_swap_b32 v22, v23
    v_max_f32 v22, v22, v23
    v_mov_b32 v23, v22
    s_nop 1
    v_permlane16_swap_b32 v22, v23
    v_max_f32 v22, v22, v23
    v_sub_f32 v48, v48, v22
    v_sub_f32 v49, v49, v22
    v_sub_f32 v50, v50, v22
    v_sub_f32 v51, v51, v22
    v_sub_f32 v52, v52, v22
    v_sub_f32 v53, v53, v22
    v_sub_f32 v54, v54, v22
    v_sub_f32 v55, v55, v22
    v_sub_f32 v72, 0, v22
    v_sub_f32 v73, 0, v22
    v_sub_f32 v74, 0, v22
    v_sub_f32 v75, 0, v22
    v_max3_f32 v22, v56, v57, v58
    v_max3_f32 v22, v22, v59, v60
    v_max3_f32 v22, v22, v61, v62
    v_max_f32 v22, v22, v63
    v_mov_b32 v23, v22
    s_nop 1
    v_permlane32_swap_b32 v22, v23
    v_max_f32 v22, v22, v23
    v_mov_b32 v23, v22
    s_nop 1
    v_permlane16_swap_b32 v22, v23
    v_max_f32 v22, v22, v23
    v_sub_f32 v56, v56, v22
    v_sub_f32 v57, v57, v22
    v_sub_f32 v58, v58, v22
    v_sub_f32 v59, v59, v22
    v_sub_f32 v60, v60, v22
    v_sub_f32 v61, v61, v22
    v_sub_f32 v62, v62, v22
    v_sub_f32 v63, v63, v22
    v_sub_f32 v76, 0, v22
    v_sub_f32 v77, 0, v22
    v_sub_f32 v78, 0, v22
    v_sub_f32 v79, 0, v22
    ds_read_b128 a[160:163], v1 offset:8192
    ds_read_b128 a[164:167], v1 offset:9216
    ds_read_b128 a[168:171], v1 offset:10240
    ds_read_b128 a[172:175], v1 offset:11264
    v_exp_f32 v10, v32
    v_exp_f32 v11, v33
    ds_read_b128 a[176:179], v1 offset:12288
    ds_read_b128 a[188:191], v1 offset:15360
    v_exp_f32 v12, v34
    s_add_u32 s64, s46, 0
    s_add_u32 m0, s65, 65536
    s_nop 0
    buffer_load_dwordx4 v3, s[4:7], s64 offen offset:0 lds
    v_cvt_pk_bf16_f32 v96, v10, v11
    v_exp_f32 v13, v35
    ds_read_b128 a[180:183], v1 offset:13312
    v_exp_f32 v10, v36
    v_cvt_pk_bf16_f32 v97, v12, v13
    v_exp_f32 v11, v37
    ds_read_b128 a[184:187], v1 offset:14336
    v_exp_f32 v12, v38
    buffer_load_dwordx4 v3, s[4:7], s64 offen offset:1024 lds
    v_cvt_pk_bf16_f32 v98, v10, v11
    v_exp_f32 v13, v39
    v_exp_f32 v10, v40
    v_cvt_pk_bf16_f32 v99, v12, v13
    v_exp_f32 v11, v41
    v_exp_f32 v12, v42
    buffer_load_dwordx4 v3, s[4:7], s64 offen offset:2048 lds
    v_cvt_pk_bf16_f32 v100, v10, v11
    v_exp_f32 v13, v43
    ds_read_b128 a[128:131], v1 offset:16384
    s_nop 1
    v_mfma_f32_16x16x32_bf16 v[80:83], v[14:17], v[96:99], v[84:87]
    ds_read_b128 a[136:139], v1 offset:18432
    v_exp_f32 v10, v44
    v_cvt_pk_bf16_f32 v101, v12, v13
    v_exp_f32 v11, v45
    ds_read_b128 a[144:147], v1 offset:20480
    v_exp_f32 v12, v46
    buffer_load_dwordx4 v3, s[4:7], s64 offen offset:3072 lds
    v_cvt_pk_bf16_f32 v102, v10, v11
    v_exp_f32 v13, v47
    ds_read_b128 a[152:155], v1 offset:22528
    v_exp_f32 v10, v48
    v_cvt_pk_bf16_f32 v103, v12, v13
    v_exp_f32 v11, v49
    ds_read_b128 a[132:135], v1 offset:17408
    s_nop 1
    v_mfma_f32_16x16x32_bf16 v[80:83], v[18:21], v[100:103], v[80:83]
    ds_read_b128 a[140:143], v1 offset:19456
    v_exp_f32 v12, v50
    s_add_u32 m0, s65, 69632
    s_nop 0
    buffer_load_dwordx4 v9, s[4:7], s64 offen offset:0 lds
    v_cvt_pk_bf16_f32 v104, v10, v11
    v_exp_f32 v13, v51
    ds_read_b128 a[148:151], v1 offset:21504
    v_exp_f32 v10, v52
    v_cvt_pk_bf16_f32 v105, v12, v13
    v_exp_f32 v11, v53
    ds_read_b128 a[156:159], v1 offset:23552
    v_exp_f32 v12, v54
    buffer_load_dwordx4 v9, s[4:7], s64 offen offset:1024 lds
    v_cvt_pk_bf16_f32 v106, v10, v11
    v_exp_f32 v13, v55
    s_waitcnt lgkmcnt(4)
    v_mfma_f32_16x16x32_bf16 v[32:35], a[128:131], a[224:227], v[64:67]
    v_exp_f32 v10, v56
    v_mfma_f32_16x16x32_bf16 v[32:35], a[136:139], a[228:231], v[32:35]
    v_cvt_pk_bf16_f32 v107, v12, v13
    v_mfma_f32_16x16x32_bf16 v[32:35], a[144:147], a[232:235], v[32:35]
    v_exp_f32 v11, v57
    v_mfma_f32_16x16x32_bf16 v[32:35], a[152:155], a[236:239], v[32:35]
    ds_read_b128 a[192:195], v1 offset:24576
    v_mfma_f32_16x16x32_bf16 v[40:43], a[128:131], a[240:243], v[68:71]
    v_exp_f32 v12, v58
    v_mfma_f32_16x16x32_bf16 v[40:43], a[136:139], a[244:247], v[40:43]
    buffer_load_dwordx4 v9, s[4:7], s64 offen offset:2048 lds
    v_cvt_pk_bf16_f32 v108, v10, v11
    v_mfma_f32_16x16x32_bf16 v[40:43], a[144:147], a[248:251], v[40:43]
    v_exp_f32 v13, v59
    v_mfma_f32_16x16x32_bf16 v[40:43], a[152:155], a[252:255], v[40:43]
    ds_read_b128 a[196:199], v1 offset:25600
    v_mfma_f32_16x16x32_bf16 v[88:91], v[14:17], v[104:107], v[92:95]
    s_waitcnt lgkmcnt(2)
    v_mfma_f32_16x16x32_bf16 v[36:39], a[132:135], a[224:227], v[64:67]
    v_exp_f32 v10, v60
    v_mfma_f32_16x16x32_bf16 v[36:39], a[140:143], a[228:231], v[36:39]
    v_cvt_pk_bf16_f32 v109, v12, v13
    v_mfma_f32_16x16x32_bf16 v[36:39], a[148:151], a[232:235], v[36:39]
    v_exp_f32 v11, v61
    v_mfma_f32_16x16x32_bf16 v[36:39], a[156:159], a[236:239], v[36:39]
    ds_read_b128 a[200:203], v1 offset:26624
    v_mfma_f32_16x16x32_bf16 v[44:47], a[132:135], a[240:243], v[68:71]
    v_exp_f32 v12, v62
    v_mfma_f32_16x16x32_bf16 v[44:47], a[140:143], a[244:247], v[44:47]
    buffer_load_dwordx4 v9, s[4:7], s64 offen offset:3072 lds
    v_cvt_pk_bf16_f32 v110, v10, v11
    v_mfma_f32_16x16x32_bf16 v[44:47], a[148:151], a[248:251], v[44:47]
    v_exp_f32 v13, v63
    v_mfma_f32_16x16x32_bf16 v[44:47], a[156:159], a[252:255], v[44:47]
    ds_read_b128 a[204:207], v1 offset:27648
    v_mfma_f32_16x16x32_bf16 a[0:3], a[160:163], v[96:99], a[0:3]
    v_exp_f32 v10, v32
    v_mfma_f32_16x16x32_bf16 a[32:35], a[160:163], v[100:103], a[32:35]
    v_cvt_pk_bf16_f32 v111, v12, v13
    v_mfma_f32_16x16x32_bf16 a[4:7], a[164:167], v[96:99], a[4:7]
    v_exp_f32 v11, v33
    v_mfma_f32_16x16x32_bf16 a[36:39], a[164:167], v[100:103], a[36:39]
    ds_read_b128 a[208:211], v1 offset:28672
    v_mfma_f32_16x16x32_bf16 v[88:91], v[18:21], v[108:111], v[88:91]
    ds_read_b128 a[220:223], v1 offset:31744
    v_mfma_f32_16x16x32_bf16 a[8:11], a[168:171], v[96:99], a[8:11]
    v_exp_f32 v12, v34
    v_mfma_f32_16x16x32_bf16 a[40:43], a[168:171], v[100:103], a[40:43]
    s_waitcnt vmcnt(8)
    v_cvt_pk_bf16_f32 v112, v10, v11
    v_cmp_eq_u64 vcc, v[4:5], v[6:7]
    v_mfma_f32_16x16x32_bf16 a[12:15], a[172:175], v[96:99], a[12:15]
    v_exp_f32 v13, v35
    v_mfma_f32_16x16x32_bf16 a[44:47], a[172:175], v[100:103], a[44:47]
    s_or_b32 s83, vcc_lo, 15
    ds_read_b128 a[212:215], v1 offset:29696
    v_mfma_f32_16x16x32_bf16 a[16:19], a[176:179], v[96:99], a[16:19]
    v_exp_f32 v10, v36
    v_mfma_f32_16x16x32_bf16 a[48:51], a[176:179], v[100:103], a[48:51]
    v_cvt_pk_bf16_f32 v113, v12, v13
    v_mfma_f32_16x16x32_bf16 a[20:23], a[180:183], v[96:99], a[20:23]
    v_exp_f32 v11, v37
    v_mfma_f32_16x16x32_bf16 a[52:55], a[180:183], v[100:103], a[52:55]
    ds_read_b128 a[216:219], v1 offset:30720
    v_mfma_f32_16x16x32_bf16 a[24:27], a[184:187], v[96:99], a[24:27]
    s_cmp_eq_u32 s83, -1
    v_exp_f32 v12, v38
    v_mfma_f32_16x16x32_bf16 a[56:59], a[184:187], v[100:103], a[56:59]
    s_cbranch_scc0 L_fh0
L_fhret0:
    v_cvt_pk_bf16_f32 v114, v10, v11
    v_mfma_f32_16x16x32_bf16 a[28:31], a[188:191], v[96:99], a[28:31]
    v_exp_f32 v13, v39
    v_mfma_f32_16x16x32_bf16 a[60:63], a[188:191], v[100:103], a[60:63]
    s_mov_b32 s63, 0
L_loop:
    v_mfma_f32_16x16x32_bf16 v[48:51], a[128:131], v[128:131], v[72:75]
    s_waitcnt vmcnt(8)
    v_exp_f32 v10, v40
    v_mfma_f32_16x16x32_bf16 v[48:51], a[136:139], v[132:135], v[48:51]
    s_barrier
    v_cvt_pk_bf16_f32 v115, v12, v13
    v_mfma_f32_16x16x32_bf16 v[48:51], a[144:147], v[136:139], v[48:51]
    v_exp_f32 v11, v41
    v_mfma_f32_16x16x32_bf16 v[48:51], a[152:155], v[140:143], v[48:51]
    buffer_load_dwordx4 v[176:179], v162, s[12:15], s71 offen offset:0 nt
    v_mfma_f32_16x16x32_bf16 v[56:59], a[128:131], v[144:147], v[76:79]
    v_exp_f32 v12, v42
    v_mfma_f32_16x16x32_bf16 v[56:59], a[136:139], v[148:151], v[56:59]
    v_cvt_pk_bf16_f32 v116, v10, v11
    v_mfma_f32_16x16x32_bf16 v[56:59], a[144:147], v[152:155], v[56:59]
    s_add_u32 s64, s47, s69
    v_exp_f32 v13, v43
    v_mfma_f32_16x16x32_bf16 v[56:59], a[152:155], v[156:159], v[56:59]
    s_add_u32 m0, s65, 98304
    ds_read_b128 a[128:131], v1 offset:32768
    v_mfma_f32_16x16x32_bf16 v[84:87], v[14:17], v[112:115], v[80:83]
    ds_read_b128 a[136:139], v1 offset:34816
    buffer_load_dwordx4 v3, s[4:7], s64 offen offset:0 lds
    v_mfma_f32_16x16x32_bf16 v[52:55], a[132:135], v[128:131], v[72:75]
    v_exp_f32 v10, v44
    v_mfma_f32_16x16x32_bf16 v[52:55], a[140:143], v[132:135], v[52:55]
    v_cvt_pk_bf16_f32 v117, v12, v13
    v_mfma_f32_16x16x32_bf16 v[52:55], a[148:151], v[136:139], v[52:55]
    v_exp_f32 v11, v45
    v_mfma_f32_16x16x32_bf16 v[52:55], a[156:159], v[140:143], v[52:55]
    ds_read_b128 a[144:147], v1 offset:36864
    buffer_load_dwordx4 v[180:183], v162, s[12:15], s71 offen offset:128 nt
    v_mfma_f32_16x16x32_bf16 v[60:63], a[132:135], v[144:147], v[76:79]
    v_exp_f32 v12, v46
    v_mfma_f32_16x16x32_bf16 v[60:63], a[140:143], v[148:151], v[60:63]
    v_cvt_pk_bf16_f32 v118, v10, v11
    v_mfma_f32_16x16x32_bf16 v[60:63], a[148:151], v[152:155], v[60:63]
    v_exp_f32 v13, v47
    v_mfma_f32_16x16x32_bf16 v[60:63], a[156:159], v[156:159], v[60:63]
    ds_read_b128 a[152:155], v1 offset:38912
    buffer_load_dwordx4 v[184:187], v162, s[12:15], s71 offen offset:256 nt
    v_mfma_f32_16x16x32_bf16 a[64:67], a[160:163], v[104:107], a[64:67]
    v_exp_f32 v10, v48
    v_mfma_f32_16x16x32_bf16 a[96:99], a[160:163], v[108:111], a[96:99]
    v_cvt_pk_bf16_f32 v119, v12, v13
    v_mfma_f32_16x16x32_bf16 a[68:71], a[164:167], v[104:107], a[68:71]
    v_exp_f32 v11, v49
    v_mfma_f32_16x16x32_bf16 a[100:103], a[164:167], v[108:111], a[100:103]
    ds_read_b128 a[132:135], v1 offset:33792
    v_mfma_f32_16x16x32_bf16 v[84:87], v[18:21], v[116:119], v[84:87]
    ds_read_b128 a[140:143], v1 offset:35840
    v_mfma_f32_16x16x32_bf16 a[72:75], a[168:171], v[104:107], a[72:75]
    v_exp_f32 v12, v50
    v_mfma_f32_16x16x32_bf16 a[104:107], a[168:171], v[108:111], a[104:107]
    buffer_load_dwordx4 v3, s[4:7], s64 offen offset:1024 lds
    v_cvt_pk_bf16_f32 v120, v10, v11
    v_mfma_f32_16x16x32_bf16 a[76:79], a[172:175], v[104:107], a[76:79]
    v_exp_f32 v13, v51
    v_mfma_f32_16x16x32_bf16 a[108:111], a[172:175], v[108:111], a[108:111]
    ds_read_b128 a[148:151], v1 offset:37888
    v_mfma_f32_16x16x32_bf16 a[80:83], a[176:179], v[104:107], a[80:83]
    v_exp_f32 v10, v52
    v_mfma_f32_16x16x32_bf16 a[112:115], a[176:179], v[108:111], a[112:115]
    buffer_load_dwordx4 v[188:191], v162, s[12:15], s71 offen offset:384 nt
    v_cvt_pk_bf16_f32 v121, v12, v13
    v_mfma_f32_16x16x32_bf16 a[84:87], a[180:183], v[104:107], a[84:87]
    v_exp_f32 v11, v53
    v_mfma_f32_16x16x32_bf16 a[116:119], a[180:183], v[108:111], a[116:119]
    ds_read_b128 a[156:159], v1 offset:39936
    v_cmp_nge_f32 vcc, s66, v86
    v_mfma_f32_16x16x32_bf16 a[88:91], a[184:187], v[104:107], a[88:91]
    v_exp_f32 v12, v54
    v_mfma_f32_16x16x32_bf16 a[120:123], a[184:187], v[108:111], a[120:123]
    buffer_load_dwordx2 v[240:241], v164, s[16:19], s74 offen offset:0
    v_cvt_pk_bf16_f32 v122, v10, v11
    v_mfma_f32_16x16x32_bf16 a[92:95], a[188:191], v[104:107], a[92:95]
    v_exp_f32 v13, v55
    v_mfma_f32_16x16x32_bf16 a[124:127], a[188:191], v[108:111], a[124:127]
    s_waitcnt lgkmcnt(4)
    s_cbranch_vccnz L_tramp0
L_ret0:
    v_mfma_f32_16x16x32_bf16 v[32:35], a[128:131], a[224:227], v[64:67]
    v_exp_f32 v10, v56
    v_mfma_f32_16x16x32_bf16 v[32:35], a[136:139], a[228:231], v[32:35]
    buffer_load_dwordx2 v[242:243], v164, s[20:23], s74 offen offset:0
    v_cvt_pk_bf16_f32 v123, v12, v13
    v_mfma_f32_16x16x32_bf16 v[32:35], a[144:147], a[232:235], v[32:35]
    v_exp_f32 v11, v57
    v_mfma_f32_16x16x32_bf16 v[32:35], a[152:155], a[236:239], v[32:35]
    ds_read_b128 a[160:163], v1 offset:40960
    v_mfma_f32_16x16x32_bf16 v[40:43], a[128:131], a[240:243], v[68:71]
    v_exp_f32 v12, v58
    v_mfma_f32_16x16x32_bf16 v[40:43], a[136:139], a[244:247], v[40:43]
    v_cvt_pk_bf16_f32 v124, v10, v11
    v_mfma_f32_16x16x32_bf16 v[40:43], a[144:147], a[248:251], v[40:43]
    v_exp_f32 v13, v59
    v_mfma_f32_16x16x32_bf16 v[40:43], a[152:155], a[252:255], v[40:43]
    ds_read_b128 a[164:167], v1 offset:41984
    v_mfma_f32_16x16x32_bf16 v[92:95], v[14:17], v[120:123], v[88:91]
    s_waitcnt lgkmcnt(2)
    buffer_load_dwordx4 v3, s[4:7], s64 offen offset:2048 lds
    v_mfma_f32_16x16x32_bf16 v[36:39], a[132:135], a[224:227], v[64:67]
    v_exp_f32 v10, v60
    v_mfma_f32_16x16x32_bf16 v[36:39], a[140:143], a[228:231], v[36:39]
    v_cvt_pk_bf16_f32 v125, v12, v13
    v_mfma_f32_16x16x32_bf16 v[36:39], a[148:151], a[232:235], v[36:39]
    v_exp_f32 v11, v61
    v_mfma_f32_16x16x32_bf16 v[36:39], a[156:159], a[236:239], v[36:39]
    ds_read_b128 a[168:171], v1 offset:43008
    buffer_load_dwordx2 v[208:209], v163, s[36:39], s73 offen offset:0
    v_mfma_f32_16x16x32_bf16 v[44:47], a[132:135], a[240:243], v[68:71]
    v_exp_f32 v12, v62
    v_mfma_f32_16x16x32_bf16 v[44:47], a[140:143], a[244:247], v[44:47]
    v_cvt_pk_bf16_f32 v126, v10, v11
    v_mfma_f32_16x16x32_bf16 v[44:47], a[148:151], a[248:251], v[44:47]
    v_exp_f32 v13, v63
    v_mfma_f32_16x16x32_bf16 v[44:47], a[156:159], a[252:255], v[44:47]
    ds_read_b128 a[172:175], v1 offset:44032
    buffer_load_dwordx2 v[210:211], v163, s[36:39], s73 offen offset:64
    v_mfma_f32_16x16x32_bf16 a[0:3], a[192:195], v[112:115], a[0:3]
    v_exp_f32 v10, v32
    v_mfma_f32_16x16x32_bf16 a[32:35], a[192:195], v[116:119], a[32:35]
    v_cvt_pk_bf16_f32 v127, v12, v13
    v_mfma_f32_16x16x32_bf16 a[4:7], a[196:199], v[112:115], a[4:7]
    v_exp_f32 v11, v33
    v_mfma_f32_16x16x32_bf16 a[36:39], a[196:199], v[116:119], a[36:39]
    ds_read_b128 a[176:179], v1 offset:45056
    v_mfma_f32_16x16x32_bf16 v[92:95], v[18:21], v[124:127], v[92:95]
    ds_read_b128 a[188:191], v1 offset:48128
    v_mfma_f32_16x16x32_bf16 a[8:11], a[200:203], v[112:115], a[8:11]
    v_exp_f32 v12, v34
    v_mfma_f32_16x16x32_bf16 a[40:43], a[200:203], v[116:119], a[40:43]
    buffer_load_dwordx4 v3, s[4:7], s64 offen offset:3072 lds
    v_cvt_pk_bf16_f32 v96, v10, v11
    v_mfma_f32_16x16x32_bf16 a[12:15], a[204:207], v[112:115], a[12:15]
    v_exp_f32 v13, v35
    v_mfma_f32_16x16x32_bf16 a[44:47], a[204:207], v[116:119], a[44:47]
    ds_read_b128 a[180:183], v1 offset:46080
    v_mfma_f32_16x16x32_bf16 a[16:19], a[208:211], v[112:115], a[16:19]
    v_exp_f32 v10, v36
    v_mfma_f32_16x16x32_bf16 a[48:51], a[208:211], v[116:119], a[48:51]
    buffer_load_dwordx2 v[212:213], v163, s[36:39], s73 offen offset:128
    v_cvt_pk_bf16_f32 v97, v12, v13
    v_mfma_f32_16x16x32_bf16 a[20:23], a[212:215], v[112:115], a[20:23]
    v_exp_f32 v11, v37
    v_mfma_f32_16x16x32_bf16 a[52:55], a[212:215], v[116:119], a[52:55]
    ds_read_b128 a[184:187], v1 offset:47104
    v_cmp_nge_f32 vcc, s66, v94
    v_mfma_f32_16x16x32_bf16 a[24:27], a[216:219], v[112:115], a[24:27]
    v_exp_f32 v12, v38
    v_mfma_f32_16x16x32_bf16 a[56:59], a[216:219], v[116:119], a[56:59]
    buffer_load_dwordx2 v[214:215], v163, s[36:39], s73 offen offset:192
    v_cvt_pk_bf16_f32 v98, v10, v11
    v_mfma_f32_16x16x32_bf16 a[28:31], a[220:223], v[112:115], a[28:31]
    v_exp_f32 v13, v39
    v_mfma_f32_16x16x32_bf16 a[60:63], a[220:223], v[116:119], a[60:63]
    s_cbranch_vccnz L_tramp1
L_ret1:
    v_mfma_f32_16x16x32_bf16 v[48:51], a[128:131], v[128:131], v[72:75]
    v_exp_f32 v10, v40
    v_mfma_f32_16x16x32_bf16 v[48:51], a[136:139], v[132:135], v[48:51]
    buffer_load_dwordx2 v[216:217], v163, s[40:43], s73 offen offset:0
    v_cvt_pk_bf16_f32 v99, v12, v13
    v_mfma_f32_16x16x32_bf16 v[48:51], a[144:147], v[136:139], v[48:51]
    v_exp_f32 v11, v41
    v_mfma_f32_16x16x32_bf16 v[48:51], a[152:155], v[140:143], v[48:51]
    v_mfma_f32_16x16x32_bf16 v[56:59], a[128:131], v[144:147], v[76:79]
    v_exp_f32 v12, v42
    v_mfma_f32_16x16x32_bf16 v[56:59], a[136:139], v[148:151], v[56:59]
    v_cvt_pk_bf16_f32 v100, v10, v11
    v_mfma_f32_16x16x32_bf16 v[56:59], a[144:147], v[152:155], v[56:59]
    v_exp_f32 v13, v43
    v_mfma_f32_16x16x32_bf16 v[56:59], a[152:155], v[156:159], v[56:59]
    s_add_u32 m0, s65, 102400
    ds_read_b128 a[128:131], v1 offset:49152
    v_mfma_f32_16x16x32_bf16 v[80:83], v[14:17], v[96:99], v[84:87]
    ds_read_b128 a[136:139], v1 offset:51200
    buffer_load_dwordx4 v9, s[4:7], s64 offen offset:0 lds
    v_mfma_f32_16x16x32_bf16 v[52:55], a[132:135], v[128:131], v[72:75]
    v_exp_f32 v10, v44
    v_mfma_f32_16x16x32_bf16 v[52:55], a[140:143], v[132:135], v[52:55]
    v_cvt_pk_bf16_f32 v101, v12, v13
    v_mfma_f32_16x16x32_bf16 v[52:55], a[148:151], v[136:139], v[52:55]
    v_exp_f32 v11, v45
    v_mfma_f32_16x16x32_bf16 v[52:55], a[156:159], v[140:143], v[52:55]
    ds_read_b128 a[144:147], v1 offset:53248
    buffer_load_dwordx2 v[218:219], v163, s[40:43], s73 offen offset:64
    v_mfma_f32_16x16x32_bf16 v[60:63], a[132:135], v[144:147], v[76:79]
    v_exp_f32 v12, v46
    v_mfma_f32_16x16x32_bf16 v[60:63], a[140:143], v[148:151], v[60:63]
    v_cvt_pk_bf16_f32 v102, v10, v11
    v_mfma_f32_16x16x32_bf16 v[60:63], a[148:151], v[152:155], v[60:63]
    v_exp_f32 v13, v47
    v_mfma_f32_16x16x32_bf16 v[60:63], a[156:159], v[156:159], v[60:63]
    ds_read_b128 a[152:155], v1 offset:55296
    buffer_load_dwordx2 v[220:221], v163, s[40:43], s73 offen offset:128
    v_mfma_f32_16x16x32_bf16 a[64:67], a[192:195], v[120:123], a[64:67]
    v_exp_f32 v10, v48
    v_mfma_f32_16x16x32_bf16 a[96:99], a[192:195], v[124:127], a[96:99]
    v_cvt_pk_bf16_f32 v103, v12, v13
    v_mfma_f32_16x16x32_bf16 a[68:71], a[196:199], v[120:123], a[68:71]
    v_exp_f32 v11, v49
    v_mfma_f32_16x16x32_bf16 a[100:103], a[196:199], v[124:127], a[100:103]
    ds_read_b128 a[132:135], v1 offset:50176
    v_mfma_f32_16x16x32_bf16 v[80:83], v[18:21], v[100:103], v[80:83]
    ds_read_b128 a[140:143], v1 offset:52224
    v_mfma_f32_16x16x32_bf16 a[72:75], a[200:203], v[120:123], a[72:75]
    v_exp_f32 v12, v50
    v_mfma_f32_16x16x32_bf16 a[104:107], a[200:203], v[124:127], a[104:107]
    buffer_load_dwordx4 v9, s[4:7], s64 offen offset:1024 lds
    v_cvt_pk_bf16_f32 v104, v10, v11
    v_mfma_f32_16x16x32_bf16 a[76:79], a[204:207], v[120:123], a[76:79]
    v_exp_f32 v13, v51
    v_mfma_f32_16x16x32_bf16 a[108:111], a[204:207], v[124:127], a[108:111]
    ds_read_b128 a[148:151], v1 offset:54272
    v_mfma_f32_16x16x32_bf16 a[80:83], a[208:211], v[120:123], a[80:83]
    v_exp_f32 v10, v52
    v_mfma_f32_16x16x32_bf16 a[112:115], a[208:211], v[124:127], a[112:115]
    buffer_load_dwordx2 v[222:223], v163, s[40:43], s73 offen offset:192
    v_cvt_pk_bf16_f32 v105, v12, v13
    v_mfma_f32_16x16x32_bf16 a[84:87], a[212:215], v[120:123], a[84:87]
    v_exp_f32 v11, v53
    v_mfma_f32_16x16x32_bf16 a[116:119], a[212:215], v[124:127], a[116:119]
    ds_read_b128 a[156:159], v1 offset:56320
    v_cmp_nge_f32 vcc, s66, v82
    v_mfma_f32_16x16x32_bf16 a[88:91], a[216:219], v[120:123], a[88:91]
    v_exp_f32 v12, v54
    v_mfma_f32_16x16x32_bf16 a[120:123], a[216:219], v[124:127], a[120:123]
    buffer_load_dwordx4 v[192:195], v162, s[12:15], s71 offen offset:2048 nt
    v_cvt_pk_bf16_f32 v106, v10, v11
    v_mfma_f32_16x16x32_bf16 a[92:95], a[220:223], v[120:123], a[92:95]
    v_exp_f32 v13, v55
    v_mfma_f32_16x16x32_bf16 a[124:127], a[220:223], v[124:127], a[124:127]
    s_waitcnt lgkmcnt(4)
    s_cbranch_vccnz L_tramp2
L_ret2:
    v_mfma_f32_16x16x32_bf16 v[32:35], a[128:131], a[224:227], v[64:67]
    v_exp_f32 v10, v56
    v_mfma_f32_16x16x32_bf16 v[32:35], a[136:139], a[228:231], v[32:35]
    buffer_load_dwordx4 v[196:199], v162, s[12:15], s71 offen offset:2176 nt
    v_cvt_pk_bf16_f32 v107, v12, v13
    v_mfma_f32_16x16x32_bf16 v[32:35], a[144:147], a[232:235], v[32:35]
    v_exp_f32 v11, v57
    v_mfma_f32_16x16x32_bf16 v[32:35], a[152:155], a[236:239], v[32:35]
    ds_read_b128 a[192:195], v1 offset:57344
    v_mfma_f32_16x16x32_bf16 v[40:43], a[128:131], a[240:243], v[68:71]
    v_exp_f32 v12, v58
    v_mfma_f32_16x16x32_bf16 v[40:43], a[136:139], a[244:247], v[40:43]
    v_cvt_pk_bf16_f32 v108, v10, v11
    v_mfma_f32_16x16x32_bf16 v[40:43], a[144:147], a[248:251], v[40:43]
    v_exp_f32 v13, v59
    v_mfma_f32_16x16x32_bf16 v[40:43], a[152:155], a[252:255], v[40:43]
    ds_read_b128 a[196:199], v1 offset:58368
    v_mfma_f32_16x16x32_bf16 v[88:91], v[14:17], v[104:107], v[92:95]
    s_waitcnt lgkmcnt(2)
    buffer_load_dwordx4 v9, s[4:7], s64 offen offset:2048 lds
    v_mfma_f32_16x16x32_bf16 v[36:39], a[132:135], a[224:227], v[64:67]
    v_exp_f32 v10, v60
    v_mfma_f32_16x16x32_bf16 v[36:39], a[140:143], a[228:231], v[36:39]
    v_cvt_pk_bf16_f32 v109, v12, v13
    v_mfma_f32_16x16x32_bf16 v[36:39], a[148:151], a[232:235], v[36:39]
    v_exp_f32 v11, v61
    v_mfma_f32_16x16x32_bf16 v[36:39], a[156:159], a[236:239], v[36:39]
    ds_read_b128 a[200:203], v1 offset:59392
    buffer_load_dwordx4 v[200:203], v162, s[12:15], s71 offen offset:2304 nt
    v_mfma_f32_16x16x32_bf16 v[44:47], a[132:135], a[240:243], v[68:71]
    v_exp_f32 v12, v62
    v_mfma_f32_16x16x32_bf16 v[44:47], a[140:143], a[244:247], v[44:47]
    v_cvt_pk_bf16_f32 v110, v10, v11
    v_mfma_f32_16x16x32_bf16 v[44:47], a[148:151], a[248:251], v[44:47]
    v_exp_f32 v13, v63
    v_mfma_f32_16x16x32_bf16 v[44:47], a[156:159], a[252:255], v[44:47]
    ds_read_b128 a[204:207], v1 offset:60416
    buffer_load_dwordx4 v[204:207], v162, s[12:15], s71 offen offset:2432 nt
    v_mfma_f32_16x16x32_bf16 a[0:3], a[160:163], v[96:99], a[0:3]
    v_exp_f32 v10, v32
    v_mfma_f32_16x16x32_bf16 a[32:35], a[160:163], v[100:103], a[32:35]
    v_cvt_pk_bf16_f32 v111, v12, v13
    v_mfma_f32_16x16x32_bf16 a[4:7], a[164:167], v[96:99], a[4:7]
    v_exp_f32 v11, v33
    v_mfma_f32_16x16x32_bf16 a[36:39], a[164:167], v[100:103], a[36:39]
    ds_read_b128 a[208:211], v1 offset:61440
    v_mfma_f32_16x16x32_bf16 v[88:91], v[18:21], v[108:111], v[88:91]
    ds_read_b128 a[220:223], v1 offset:64512
    v_mfma_f32_16x16x32_bf16 a[8:11], a[168:171], v[96:99], a[8:11]
    v_exp_f32 v12, v34
    v_mfma_f32_16x16x32_bf16 a[40:43], a[168:171], v[100:103], a[40:43]
    buffer_load_dwordx4 v9, s[4:7], s64 offen offset:3072 lds
    v_cvt_pk_bf16_f32 v112, v10, v11
    v_mfma_f32_16x16x32_bf16 a[12:15], a[172:175], v[96:99], a[12:15]
    v_exp_f32 v13, v35
    v_mfma_f32_16x16x32_bf16 a[44:47], a[172:175], v[100:103], a[44:47]
    ds_read_b128 a[212:215], v1 offset:62464
    v_mfma_f32_16x16x32_bf16 a[16:19], a[176:179], v[96:99], a[16:19]
    v_exp_f32 v10, v36
    v_mfma_f32_16x16x32_bf16 a[48:51], a[176:179], v[100:103], a[48:51]
    buffer_load_dwordx2 v[244:245], v164, s[16:19], s74 offen offset:32
    v_cvt_pk_bf16_f32 v113, v12, v13
    v_mfma_f32_16x16x32_bf16 a[20:23], a[180:183], v[96:99], a[20:23]
    v_exp_f32 v11, v37
    v_mfma_f32_16x16x32_bf16 a[52:55], a[180:183], v[100:103], a[52:55]
    ds_read_b128 a[216:219], v1 offset:63488
    v_cmp_nge_f32 vcc, s66, v90
    v_mfma_f32_16x16x32_bf16 a[24:27], a[184:187], v[96:99], a[24:27]
    v_exp_f32 v12, v38
    v_mfma_f32_16x16x32_bf16 a[56:59], a[184:187], v[100:103], a[56:59]
    buffer_load_dwordx2 v[246:247], v164, s[20:23], s74 offen offset:32
    v_cvt_pk_bf16_f32 v114, v10, v11
    v_mfma_f32_16x16x32_bf16 a[28:31], a[188:191], v[96:99], a[28:31]
    v_exp_f32 v13, v39
    v_mfma_f32_16x16x32_bf16 a[60:63], a[188:191], v[100:103], a[60:63]
    s_cbranch_vccnz L_tramp3
L_ret3:
    v_mfma_f32_16x16x32_bf16 v[48:51], a[128:131], v[128:131], v[72:75]
    s_waitcnt vmcnt(28)
    v_exp_f32 v10, v40
    v_mfma_f32_16x16x32_bf16 v[48:51], a[136:139], v[132:135], v[48:51]
    s_barrier
    buffer_load_dwordx2 v[224:225], v163, s[36:39], s73 offen offset:1024
    v_cvt_pk_bf16_f32 v115, v12, v13
    v_mfma_f32_16x16x32_bf16 v[48:51], a[144:147], v[136:139], v[48:51]
    v_exp_f32 v11, v41
    v_mfma_f32_16x16x32_bf16 v[48:51], a[152:155], v[140:143], v[48:51]
    v_mfma_f32_16x16x32_bf16 v[56:59], a[128:131], v[144:147], v[76:79]
    v_exp_f32 v12, v42
    v_mfma_f32_16x16x32_bf16 v[56:59], a[136:139], v[148:151], v[56:59]
    v_cvt_pk_bf16_f32 v116, v10, v11
    v_mfma_f32_16x16x32_bf16 v[56:59], a[144:147], v[152:155], v[56:59]
    s_add_u32 s64, s48, s69
    v_exp_f32 v13, v43
    v_mfma_f32_16x16x32_bf16 v[56:59], a[152:155], v[156:159], v[56:59]
    s_add_u32 m0, s65, 0
    ds_read_b128 a[128:131], v2 offset:0
    v_mfma_f32_16x16x32_bf16 v[84:87], v[14:17], v[112:115], v[80:83]
    ds_read_b128 a[136:139], v2 offset:2048
    buffer_load_dwordx4 v3, s[4:7], s64 offen offset:0 lds
    v_mfma_f32_16x16x32_bf16 v[52:55], a[132:135], v[128:131], v[72:75]
    s_waitcnt vmcnt(22)
    v_exp_f32 v10, v44
    v_lshlrev_b32 v28, 16, v240
    v_mfma_f32_16x16x32_bf16 v[52:55], a[140:143], v[132:135], v[52:55]
    v_cvt_pk_bf16_f32 v117, v12, v13
    v_and_b32 v240, 0xffff0000, v240
    v_mfma_f32_16x16x32_bf16 v[52:55], a[148:151], v[136:139], v[52:55]
    v_exp_f32 v11, v45
    v_lshlrev_b32 v29, 16, v241
    v_mfma_f32_16x16x32_bf16 v[52:55], a[156:159], v[140:143], v[52:55]
    ds_read_b128 a[144:147], v2 offset:4096
    buffer_load_dwordx2 v[226:227], v163, s[36:39], s73 offen offset:1088
    v_mfma_f32_16x16x32_bf16 v[60:63], a[132:135], v[144:147], v[76:79]
    v_exp_f32 v12, v46
    v_mfma_f32_16x16x32_bf16 v[60:63], a[140:143], v[148:151], v[60:63]
    v_cvt_pk_bf16_f32 v118, v10, v11
    v_and_b32 v241, 0xffff0000, v241
    v_lshlrev_b32 v30, 16, v242
    v_mfma_f32_16x16x32_bf16 v[60:63], a[148:151], v[152:155], v[60:63]
    v_exp_f32 v13, v47
    v_mfma_f32_16x16x32_bf16 v[60:63], a[156:159], v[156:159], v[60:63]
    ds_read_b128 a[152:155], v2 offset:6144
    buffer_load_dwordx2 v[228:229], v163, s[36:39], s73 offen offset:1152
    v_mfma_f32_16x16x32_bf16 a[64:67], a[160:163], v[104:107], a[64:67]
    v_exp_f32 v10, v48
    v_and_b32 v242, 0xffff0000, v242
    v_mfma_f32_16x16x32_bf16 a[96:99], a[160:163], v[108:111], a[96:99]
    v_cvt_pk_bf16_f32 v119, v12, v13
    v_lshlrev_b32 v31, 16, v243
    v_mfma_f32_16x16x32_bf16 a[68:71], a[164:167], v[104:107], a[68:71]
    v_exp_f32 v11, v49
    v_mfma_f32_16x16x32_bf16 a[100:103], a[164:167], v[108:111], a[100:103]
    ds_read_b128 a[132:135], v2 offset:1024
    v_and_b32 v243, 0xffff0000, v243
    v_mul_f32 v28, s87, v28
    v_mfma_f32_16x16x32_bf16 v[84:87], v[18:21], v[116:119], v[84:87]
    ds_read_b128 a[140:143], v2 offset:3072
    v_mul_f32 v240, s87, v240
    v_mfma_f32_16x16x32_bf16 a[72:75], a[168:171], v[104:107], a[72:75]
    v_exp_f32 v12, v50
    v_mul_f32 v29, s87, v29
    v_mfma_f32_16x16x32_bf16 a[104:107], a[168:171], v[108:111], a[104:107]
    buffer_load_dwordx4 v3, s[4:7], s64 offen offset:1024 lds
    v_cvt_pk_bf16_f32 v120, v10, v11
    v_mfma_f32_16x16x32_bf16 a[76:79], a[172:175], v[104:107], a[76:79]
    v_exp_f32 v13, v51
    v_mfma_f32_16x16x32_bf16 a[108:111], a[172:175], v[108:111], a[108:111]
    ds_read_b128 a[148:151], v2 offset:5120
    v_mul_f32 v241, s87, v241
    v_mul_f32_e64 v30, -v30, v28
    v_mfma_f32_16x16x32_bf16 a[80:83], a[176:179], v[104:107], a[80:83]
    v_exp_f32 v10, v52
    v_mfma_f32_16x16x32_bf16 a[112:115], a[176:179], v[108:111], a[112:115]
    buffer_load_dwordx2 v[230:231], v163, s[36:39], s73 offen offset:1216
    v_cvt_pk_bf16_f32 v121, v12, v13
    v_mfma_f32_16x16x32_bf16 a[84:87], a[180:183], v[104:107], a[84:87]
    v_exp_f32 v11, v53
    v_mfma_f32_16x16x32_bf16 a[116:119], a[180:183], v[108:111], a[116:119]
    ds_read_b128 a[156:159], v2 offset:7168
    v_cmp_nge_f32 vcc, s66, v86
    v_mul_f32_e64 v242, -v242, v240
    v_mfma_f32_16x16x32_bf16 a[88:91], a[184:187], v[104:107], a[88:91]
    v_exp_f32 v12, v54
    v_mfma_f32_16x16x32_bf16 a[120:123], a[184:187], v[108:111], a[120:123]
    buffer_load_dwordx2 v[232:233], v163, s[40:43], s73 offen offset:1024
    v_cvt_pk_bf16_f32 v122, v10, v11
    v_mfma_f32_16x16x32_bf16 a[92:95], a[188:191], v[104:107], a[92:95]
    v_exp_f32 v13, v55
    v_mul_f32_e64 v31, -v31, v29
    v_mfma_f32_16x16x32_bf16 a[124:127], a[188:191], v[108:111], a[124:127]
    s_waitcnt lgkmcnt(4)
    s_cbranch_vccnz L_tramp4
L_ret4:
    v_mfma_f32_16x16x32_bf16 v[32:35], a[128:131], a[224:227], v[64:67]
    v_exp_f32 v10, v56
    v_mfma_f32_16x16x32_bf16 v[32:35], a[136:139], a[228:231], v[32:35]
    buffer_load_dwordx2 v[234:235], v163, s[40:43], s73 offen offset:1088
    v_cvt_pk_bf16_f32 v123, v12, v13
    v_mfma_f32_16x16x32_bf16 v[32:35], a[144:147], a[232:235], v[32:35]
    v_exp_f32 v11, v57
    v_mfma_f32_16x16x32_bf16 v[32:35], a[152:155], a[236:239], v[32:35]
    ds_read_b128 a[160:163], v2 offset:8192
    v_mul_f32_e64 v243, -v243, v241
    v_cvt_f32_i32 v176, v176
    v_mfma_f32_16x16x32_bf16 v[40:43], a[128:131], a[240:243], v[68:71]
    v_exp_f32 v12, v58
    v_mfma_f32_16x16x32_bf16 v[40:43], a[136:139], a[244:247], v[40:43]
    v_cvt_pk_bf16_f32 v124, v10, v11
    v_cvt_f32_i32 v177, v177
    v_mfma_f32_16x16x32_bf16 v[40:43], a[144:147], a[248:251], v[40:43]
    v_exp_f32 v13, v59
    v_cvt_f32_i32 v184, v184
    v_mfma_f32_16x16x32_bf16 v[40:43], a[152:155], a[252:255], v[40:43]
    ds_read_b128 a[164:167], v2 offset:9216
    v_cvt_f32_i32 v185, v185
    v_mfma_f32_16x16x32_bf16 v[92:95], v[14:17], v[120:123], v[88:91]
    s_waitcnt lgkmcnt(2)
    buffer_load_dwordx4 v3, s[4:7], s64 offen offset:2048 lds
    v_fma_f32 v176, v176, v28, v30
    v_mfma_f32_16x16x32_bf16 v[36:39], a[132:135], a[224:227], v[64:67]
    v_exp_f32 v10, v60
    v_mfma_f32_16x16x32_bf16 v[36:39], a[140:143], a[228:231], v[36:39]
    v_cvt_pk_bf16_f32 v125, v12, v13
    v_fma_f32 v177, v177, v28, v30
    v_fma_f32 v184, v184, v29, v31
    v_mfma_f32_16x16x32_bf16 v[36:39], a[148:151], a[232:235], v[36:39]
    v_exp_f32 v11, v61
    v_mfma_f32_16x16x32_bf16 v[36:39], a[156:159], a[236:239], v[36:39]
    ds_read_b128 a[168:171], v2 offset:10240
    buffer_load_dwordx2 v[236:237], v163, s[40:43], s73 offen offset:1152
    v_mfma_f32_16x16x32_bf16 v[44:47], a[132:135], a[240:243], v[68:71]
    v_exp_f32 v12, v62
    v_mfma_f32_16x16x32_bf16 v[44:47], a[140:143], a[244:247], v[44:47]
    v_cvt_pk_bf16_f32 v126, v10, v11
    v_fma_f32 v185, v185, v29, v31
    v_mfma_f32_16x16x32_bf16 v[44:47], a[148:151], a[248:251], v[44:47]
    s_waitcnt vmcnt(18)
    v_exp_f32 v13, v63
    v_lshlrev_b32 v248, 16, v208
    v_mfma_f32_16x16x32_bf16 v[44:47], a[156:159], a[252:255], v[44:47]
    ds_read_b128 a[172:175], v2 offset:11264
    buffer_load_dwordx2 v[238:239], v163, s[40:43], s73 offen offset:1216
    v_mfma_f32_16x16x32_bf16 a[0:3], a[192:195], v[112:115], a[0:3]
    v_exp_f32 v10, v32
    v_mfma_f32_16x16x32_bf16 a[32:35], a[192:195], v[116:119], a[32:35]
    v_cvt_pk_bf16_f32 v127, v12, v13
    v_and_b32 v249, 0xffff0000, v208
    v_lshlrev_b32 v250, 16, v216
    v_mfma_f32_16x16x32_bf16 a[4:7], a[196:199], v[112:115], a[4:7]
    v_exp_f32 v11, v33
    v_mfma_f32_16x16x32_bf16 a[36:39], a[196:199], v[116:119], a[36:39]
    ds_read_b128 a[176:179], v2 offset:12288
    v_and_b32 v251, 0xffff0000, v216
    v_mul_f32 v248, v176, v248
    v_mfma_f32_16x16x32_bf16 v[92:95], v[18:21], v[124:127], v[92:95]
    ds_read_b128 a[188:191], v2 offset:15360
    v_mul_f32 v249, v177, v249
    v_mfma_f32_16x16x32_bf16 a[8:11], a[200:203], v[112:115], a[8:11]
    v_exp_f32 v12, v34
    v_fma_f32 v248, -v184, v250, v248
    v_mfma_f32_16x16x32_bf16 a[40:43], a[200:203], v[116:119], a[40:43]
    buffer_load_dwordx4 v3, s[4:7], s64 offen offset:3072 lds
    v_cvt_pk_bf16_f32 v96, v10, v11
    v_mfma_f32_16x16x32_bf16 a[12:15], a[204:207], v[112:115], a[12:15]
    v_exp_f32 v13, v35
    v_mfma_f32_16x16x32_bf16 a[44:47], a[204:207], v[116:119], a[44:47]
    ds_read_b128 a[180:183], v2 offset:13312
    v_fma_f32 v249, -v185, v251, v249
    v_mfma_f32_16x16x32_bf16 a[16:19], a[208:211], v[112:115], a[16:19]
    v_exp_f32 v10, v36
    v_cvt_pk_bf16_f32 v208, v248, v249
    v_mfma_f32_16x16x32_bf16 a[48:51], a[208:211], v[116:119], a[48:51]
    v_cvt_pk_bf16_f32 v97, v12, v13
    v_lshlrev_b32 v248, 16, v212
    v_mfma_f32_16x16x32_bf16 a[20:23], a[212:215], v[112:115], a[20:23]
    v_exp_f32 v11, v37
    v_and_b32 v249, 0xffff0000, v212
    v_mfma_f32_16x16x32_bf16 a[52:55], a[212:215], v[116:119], a[52:55]
    ds_read_b128 a[184:187], v2 offset:14336
    v_cmp_nge_f32 vcc, s66, v94
    v_mfma_f32_16x16x32_bf16 a[24:27], a[216:219], v[112:115], a[24:27]
    v_exp_f32 v12, v38
    v_lshlrev_b32 v250, 16, v220
    v_mfma_f32_16x16x32_bf16 a[56:59], a[216:219], v[116:119], a[56:59]
    v_cvt_pk_bf16_f32 v98, v10, v11
    v_and_b32 v251, 0xffff0000, v220
    v_mfma_f32_16x16x32_bf16 a[28:31], a[220:223], v[112:115], a[28:31]
    v_exp_f32 v13, v39
    v_mfma_f32_16x16x32_bf16 a[60:63], a[220:223], v[116:119], a[60:63]
    s_cbranch_vccnz L_tramp5
L_ret5:
    v_mfma_f32_16x16x32_bf16 v[48:51], a[128:131], v[128:131], v[72:75]
    v_exp_f32 v10, v40
    v_mul_f32 v248, v184, v248
    v_mfma_f32_16x16x32_bf16 v[48:51], a[136:139], v[132:135], v[48:51]
    v_cvt_pk_bf16_f32 v99, v12, v13
    v_mul_f32 v249, v185, v249
    v_mfma_f32_16x16x32_bf16 v[48:51], a[144:147], v[136:139], v[48:51]
    v_exp_f32 v11, v41
    v_fmac_f32 v248, v176, v250
    v_mfma_f32_16x16x32_bf16 v[48:51], a[152:155], v[140:143], v[48:51]
    v_fmac_f32 v249, v177, v251
    v_cvt_pk_bf16_f32 v212, v248, v249
    v_mfma_f32_16x16x32_bf16 v[56:59], a[128:131], v[144:147], v[76:79]
    v_exp_f32 v12, v42
    v_cvt_f32_i32 v178, v178
    v_mfma_f32_16x16x32_bf16 v[56:59], a[136:139], v[148:151], v[56:59]
    v_cvt_pk_bf16_f32 v100, v10, v11
    v_cvt_f32_i32 v179, v179
    v_mfma_f32_16x16x32_bf16 v[56:59], a[144:147], v[152:155], v[56:59]
    v_exp_f32 v13, v43
    v_mfma_f32_16x16x32_bf16 v[56:59], a[152:155], v[156:159], v[56:59]
    s_add_u32 m0, s65, 4096
    ds_read_b128 a[128:131], v2 offset:16384
    v_cvt_f32_i32 v186, v186
    v_cvt_f32_i32 v187, v187
    v_mfma_f32_16x16x32_bf16 v[80:83], v[14:17], v[96:99], v[84:87]
    ds_read_b128 a[136:139], v2 offset:18432
    buffer_load_dwordx4 v9, s[4:7], s64 offen offset:0 lds
    v_mfma_f32_16x16x32_bf16 v[52:55], a[132:135], v[128:131], v[72:75]
    v_exp_f32 v10, v44
    v_mfma_f32_16x16x32_bf16 v[52:55], a[140:143], v[132:135], v[52:55]
    v_cvt_pk_bf16_f32 v101, v12, v13
    v_fma_f32 v178, v178, v28, v30
    v_fma_f32 v179, v179, v28, v30
    v_mfma_f32_16x16x32_bf16 v[52:55], a[148:151], v[136:139], v[52:55]
    v_exp_f32 v11, v45
    v_mfma_f32_16x16x32_bf16 v[52:55], a[156:159], v[140:143], v[52:55]
    ds_read_b128 a[144:147], v2 offset:20480
    v_fma_f32 v186, v186, v29, v31
    v_fma_f32 v187, v187, v29, v31
    v_mfma_f32_16x16x32_bf16 v[60:63], a[132:135], v[144:147], v[76:79]
    v_exp_f32 v12, v46
    v_mfma_f32_16x16x32_bf16 v[60:63], a[140:143], v[148:151], v[60:63]
    v_cvt_pk_bf16_f32 v102, v10, v11
    v_lshlrev_b32 v248, 16, v209
    v_mfma_f32_16x16x32_bf16 v[60:63], a[148:151], v[152:155], v[60:63]
    v_exp_f32 v13, v47
    v_and_b32 v249, 0xffff0000, v209
    v_mfma_f32_16x16x32_bf16 v[60:63], a[156:159], v[156:159], v[60:63]
    ds_read_b128 a[152:155], v2 offset:22528
    v_lshlrev_b32 v250, 16, v217
    v_mfma_f32_16x16x32_bf16 a[64:67], a[192:195], v[120:123], a[64:67]
    v_exp_f32 v10, v48
    v_and_b32 v251, 0xffff0000, v217
    v_mfma_f32_16x16x32_bf16 a[96:99], a[192:195], v[124:127], a[96:99]
    v_cvt_pk_bf16_f32 v103, v12, v13
    v_mul_f32 v248, v178, v248
    v_mfma_f32_16x16x32_bf16 a[68:71], a[196:199], v[120:123], a[68:71]
    v_exp_f32 v11, v49
    v_mul_f32 v249, v179, v249
    v_mfma_f32_16x16x32_bf16 a[100:103], a[196:199], v[124:127], a[100:103]
    ds_read_b128 a[132:135], v2 offset:17408
    v_fma_f32 v248, -v186, v250, v248
    v_mfma_f32_16x16x32_bf16 v[80:83], v[18:21], v[100:103], v[80:83]
    ds_read_b128 a[140:143], v2 offset:19456
    v_fma_f32 v249, -v187, v251, v249
    v_mfma_f32_16x16x32_bf16 a[72:75], a[200:203], v[120:123], a[72:75]
    v_exp_f32 v12, v50
    v_cvt_pk_bf16_f32 v209, v248, v249
    v_mfma_f32_16x16x32_bf16 a[104:107], a[200:203], v[124:127], a[104:107]
    buffer_load_dwordx4 v9, s[4:7], s64 offen offset:1024 lds
    v_cvt_pk_bf16_f32 v104, v10, v11
    v_mfma_f32_16x16x32_bf16 a[76:79], a[204:207], v[120:123], a[76:79]
    v_exp_f32 v13, v51
    v_mfma_f32_16x16x32_bf16 a[108:111], a[204:207], v[124:127], a[108:111]
    ds_read_b128 a[148:151], v2 offset:21504
    v_lshlrev_b32 v248, 16, v213
    v_and_b32 v249, 0xffff0000, v213
    v_mfma_f32_16x16x32_bf16 a[80:83], a[208:211], v[120:123], a[80:83]
    v_exp_f32 v10, v52
    v_mfma_f32_16x16x32_bf16 a[112:115], a[208:211], v[124:127], a[112:115]
    v_cvt_pk_bf16_f32 v105, v12, v13
    v_lshlrev_b32 v250, 16, v221
    v_and_b32 v251, 0xffff0000, v221
    v_mfma_f32_16x16x32_bf16 a[84:87], a[212:215], v[120:123], a[84:87]
    v_exp_f32 v11, v53
    v_mfma_f32_16x16x32_bf16 a[116:119], a[212:215], v[124:127], a[116:119]
    ds_read_b128 a[156:159], v2 offset:23552
    v_cmp_nge_f32 vcc, s66, v82
    v_mfma_f32_16x16x32_bf16 a[88:91], a[216:219], v[120:123], a[88:91]
    v_exp_f32 v12, v54
    v_mul_f32 v248, v186, v248
    v_mfma_f32_16x16x32_bf16 a[120:123], a[216:219], v[124:127], a[120:123]
    v_cvt_pk_bf16_f32 v106, v10, v11
    v_mul_f32 v249, v187, v249
    v_mfma_f32_16x16x32_bf16 a[92:95], a[220:223], v[120:123], a[92:95]
    v_exp_f32 v13, v55
    v_fmac_f32 v248, v178, v250
    v_mfma_f32_16x16x32_bf16 a[124:127], a[220:223], v[124:127], a[124:127]
    s_waitcnt lgkmcnt(4)
    s_cbranch_vccnz L_tramp6
L_ret6:
    v_mfma_f32_16x16x32_bf16 v[32:35], a[128:131], a[224:227], v[64:67]
    v_exp_f32 v10, v56
    v_mfma_f32_16x16x32_bf16 v[32:35], a[136:139], a[228:231], v[32:35]
    v_cvt_pk_bf16_f32 v107, v12, v13
    v_fmac_f32 v249, v179, v251
    v_mfma_f32_16x16x32_bf16 v[32:35], a[144:147], a[232:235], v[32:35]
    v_exp_f32 v11, v57
    v_cvt_pk_bf16_f32 v213, v248, v249
    v_mfma_f32_16x16x32_bf16 v[32:35], a[152:155], a[236:239], v[32:35]
    ds_read_b128 a[192:195], v2 offset:24576
    v_cvt_f32_i32 v180, v180
    v_mfma_f32_16x16x32_bf16 v[40:43], a[128:131], a[240:243], v[68:71]
    v_exp_f32 v12, v58
    v_mfma_f32_16x16x32_bf16 v[40:43], a[136:139], a[244:247], v[40:43]
    v_cvt_pk_bf16_f32 v108, v10, v11
    v_cvt_f32_i32 v181, v181
    v_cvt_f32_i32 v188, v188
    v_mfma_f32_16x16x32_bf16 v[40:43], a[144:147], a[248:251], v[40:43]
    v_exp_f32 v13, v59
    v_mfma_f32_16x16x32_bf16 v[40:43], a[152:155], a[252:255], v[40:43]
    ds_read_b128 a[196:199], v2 offset:25600
    v_cvt_f32_i32 v189, v189
    v_fma_f32 v180, v180, v240, v242
    v_mfma_f32_16x16x32_bf16 v[88:91], v[14:17], v[104:107], v[92:95]
    s_waitcnt lgkmcnt(2)
    buffer_load_dwordx4 v9, s[4:7], s64 offen offset:2048 lds
    v_fma_f32 v181, v181, v240, v242
    v_mfma_f32_16x16x32_bf16 v[36:39], a[132:135], a[224:227], v[64:67]
    v_exp_f32 v10, v60
    v_mfma_f32_16x16x32_bf16 v[36:39], a[140:143], a[228:231], v[36:39]
    v_cvt_pk_bf16_f32 v109, v12, v13
    v_fma_f32 v188, v188, v241, v243
    v_mfma_f32_16x16x32_bf16 v[36:39], a[148:151], a[232:235], v[36:39]
    v_exp_f32 v11, v61
    v_fma_f32 v189, v189, v241, v243
    v_mfma_f32_16x16x32_bf16 v[36:39], a[156:159], a[236:239], v[36:39]
    ds_read_b128 a[200:203], v2 offset:26624
    v_lshlrev_b32 v248, 16, v210
    v_mfma_f32_16x16x32_bf16 v[44:47], a[132:135], a[240:243], v[68:71]
    v_exp_f32 v12, v62
    v_mfma_f32_16x16x32_bf16 v[44:47], a[140:143], a[244:247], v[44:47]
    v_cvt_pk_bf16_f32 v110, v10, v11
    v_and_b32 v249, 0xffff0000, v210
    v_lshlrev_b32 v250, 16, v218
    v_mfma_f32_16x16x32_bf16 v[44:47], a[148:151], a[248:251], v[44:47]
    v_exp_f32 v13, v63
    v_mfma_f32_16x16x32_bf16 v[44:47], a[156:159], a[252:255], v[44:47]
    ds_read_b128 a[204:207], v2 offset:27648
    v_and_b32 v251, 0xffff0000, v218
    v_mul_f32 v248, v180, v248
    v_mfma_f32_16x16x32_bf16 a[0:3], a[160:163], v[96:99], a[0:3]
    v_exp_f32 v10, v32
    v_mfma_f32_16x16x32_bf16 a[32:35], a[160:163], v[100:103], a[32:35]
    v_cvt_pk_bf16_f32 v111, v12, v13
    v_mul_f32 v249, v181, v249
    v_fma_f32 v248, -v188, v250, v248
    v_mfma_f32_16x16x32_bf16 a[4:7], a[164:167], v[96:99], a[4:7]
    v_exp_f32 v11, v33
    v_mfma_f32_16x16x32_bf16 a[36:39], a[164:167], v[100:103], a[36:39]
    ds_read_b128 a[208:211], v2 offset:28672
    v_fma_f32 v249, -v189, v251, v249
    v_mfma_f32_16x16x32_bf16 v[88:91], v[18:21], v[108:111], v[88:91]
    ds_read_b128 a[220:223], v2 offset:31744
    v_cvt_pk_bf16_f32 v210, v248, v249
    v_lshlrev_b32 v248, 16, v214
    v_mfma_f32_16x16x32_bf16 a[8:11], a[168:171], v[96:99], a[8:11]
    v_exp_f32 v12, v34
    v_mfma_f32_16x16x32_bf16 a[40:43], a[168:171], v[100:103], a[40:43]
    buffer_load_dwordx4 v9, s[4:7], s64 offen offset:3072 lds
    v_cvt_pk_bf16_f32 v112, v10, v11
    v_mfma_f32_16x16x32_bf16 a[12:15], a[172:175], v[96:99], a[12:15]
    v_exp_f32 v13, v35
    v_and_b32 v249, 0xffff0000, v214
    v_mfma_f32_16x16x32_bf16 a[44:47], a[172:175], v[100:103], a[44:47]
    ds_read_b128 a[212:215], v2 offset:29696
    v_lshlrev_b32 v250, 16, v222
    v_mfma_f32_16x16x32_bf16 a[16:19], a[176:179], v[96:99], a[16:19]
    v_exp_f32 v10, v36
    v_and_b32 v251, 0xffff0000, v222
    v_mfma_f32_16x16x32_bf16 a[48:51], a[176:179], v[100:103], a[48:51]
    v_cvt_pk_bf16_f32 v113, v12, v13
    v_mul_f32 v248, v188, v248
    v_mfma_f32_16x16x32_bf16 a[20:23], a[180:183], v[96:99], a[20:23]
    v_exp_f32 v11, v37
    v_mfma_f32_16x16x32_bf16 a[52:55], a[180:183], v[100:103], a[52:55]
    ds_read_b128 a[216:219], v2 offset:30720
    v_cmp_nge_f32 vcc, s66, v90
    v_mul_f32 v249, v189, v249
    v_mfma_f32_16x16x32_bf16 a[24:27], a[184:187], v[96:99], a[24:27]
    v_exp_f32 v12, v38
    v_mfma_f32_16x16x32_bf16 a[56:59], a[184:187], v[100:103], a[56:59]
    v_cvt_pk_bf16_f32 v114, v10, v11
    v_fmac_f32 v248, v180, v250
    v_fmac_f32 v249, v181, v251
    v_mfma_f32_16x16x32_bf16 a[28:31], a[188:191], v[96:99], a[28:31]
    v_exp_f32 v13, v39
    v_mfma_f32_16x16x32_bf16 a[60:63], a[188:191], v[100:103], a[60:63]
    s_cbranch_vccnz L_tramp7
L_ret7:
    v_mfma_f32_16x16x32_bf16 v[48:51], a[128:131], v[128:131], v[72:75]
    s_waitcnt vmcnt(18)
    v_exp_f32 v10, v40
    v_cvt_pk_bf16_f32 v214, v248, v249
    v_mfma_f32_16x16x32_bf16 v[48:51], a[136:139], v[132:135], v[48:51]
    s_barrier
    v_cvt_pk_bf16_f32 v115, v12, v13
    v_cvt_f32_i32 v182, v182
    v_mfma_f32_16x16x32_bf16 v[48:51], a[144:147], v[136:139], v[48:51]
    v_exp_f32 v11, v41
    v_mfma_f32_16x16x32_bf16 v[48:51], a[152:155], v[140:143], v[48:51]
    v_cvt_f32_i32 v183, v183
    v_cvt_f32_i32 v190, v190
    v_cvt_f32_i32 v191, v191
    v_mfma_f32_16x16x32_bf16 v[56:59], a[128:131], v[144:147], v[76:79]
    v_exp_f32 v12, v42
    v_mfma_f32_16x16x32_bf16 v[56:59], a[136:139], v[148:151], v[56:59]
    v_cvt_pk_bf16_f32 v116, v10, v11
    v_fma_f32 v182, v182, v240, v242
    v_fma_f32 v183, v183, v240, v242
    v_mfma_f32_16x16x32_bf16 v[56:59], a[144:147], v[152:155], v[56:59]
    s_add_u32 s64, s49, s69
    v_exp_f32 v13, v43
    v_mfma_f32_16x16x32_bf16 v[56:59], a[152:155], v[156:159], v[56:59]
    s_add_u32 m0, s65, 32768
    ds_read_b128 a[128:131], v2 offset:32768
    v_fma_f32 v190, v190, v241, v243
    v_fma_f32 v191, v191, v241, v243
    v_mfma_f32_16x16x32_bf16 v[84:87], v[14:17], v[112:115], v[80:83]
    ds_read_b128 a[136:139], v2 offset:34816
    buffer_load_dwordx4 v3, s[4:7], s64 offen offset:0 lds
    v_mfma_f32_16x16x32_bf16 v[52:55], a[132:135], v[128:131], v[72:75]
    v_exp_f32 v10, v44
    v_mfma_f32_16x16x32_bf16 v[52:55], a[140:143], v[132:135], v[52:55]
    v_cvt_pk_bf16_f32 v117, v12, v13
    v_lshlrev_b32 v248, 16, v211
    v_mfma_f32_16x16x32_bf16 v[52:55], a[148:151], v[136:139], v[52:55]
    v_exp_f32 v11, v45
    v_and_b32 v249, 0xffff0000, v211
    v_mfma_f32_16x16x32_bf16 v[52:55], a[156:159], v[140:143], v[52:55]
    ds_read_b128 a[144:147], v2 offset:36864
    v_lshlrev_b32 v250, 16, v219
    v_mfma_f32_16x16x32_bf16 v[60:63], a[132:135], v[144:147], v[76:79]
    v_exp_f32 v12, v46
    v_and_b32 v251, 0xffff0000, v219
    v_mfma_f32_16x16x32_bf16 v[60:63], a[140:143], v[148:151], v[60:63]
    v_cvt_pk_bf16_f32 v118, v10, v11
    v_mul_f32 v248, v182, v248
    v_mfma_f32_16x16x32_bf16 v[60:63], a[148:151], v[152:155], v[60:63]
    v_exp_f32 v13, v47
    v_mul_f32 v249, v183, v249
    v_mfma_f32_16x16x32_bf16 v[60:63], a[156:159], v[156:159], v[60:63]
    ds_read_b128 a[152:155], v2 offset:38912
    v_fma_f32 v248, -v190, v250, v248
    v_mfma_f32_16x16x32_bf16 a[64:67], a[160:163], v[104:107], a[64:67]
    v_exp_f32 v10, v48
    v_mfma_f32_16x16x32_bf16 a[96:99], a[160:163], v[108:111], a[96:99]
    v_cvt_pk_bf16_f32 v119, v12, v13
    v_fma_f32 v249, -v191, v251, v249
    v_cvt_pk_bf16_f32 v211, v248, v249
    v_mfma_f32_16x16x32_bf16 a[68:71], a[164:167], v[104:107], a[68:71]
    v_exp_f32 v11, v49
    v_mfma_f32_16x16x32_bf16 a[100:103], a[164:167], v[108:111], a[100:103]
    ds_read_b128 a[132:135], v2 offset:33792
    v_lshlrev_b32 v248, 16, v215
    v_and_b32 v249, 0xffff0000, v215
    v_mfma_f32_16x16x32_bf16 v[84:87], v[18:21], v[116:119], v[84:87]
    ds_read_b128 a[140:143], v2 offset:35840
    v_lshlrev_b32 v250, 16, v223
    v_mfma_f32_16x16x32_bf16 a[72:75], a[168:171], v[104:107], a[72:75]
    v_exp_f32 v12, v50
    v_and_b32 v251, 0xffff0000, v223
    v_mfma_f32_16x16x32_bf16 a[104:107], a[168:171], v[108:111], a[104:107]
    buffer_load_dwordx4 v3, s[4:7], s64 offen offset:1024 lds
    v_cvt_pk_bf16_f32 v120, v10, v11
    v_mfma_f32_16x16x32_bf16 a[76:79], a[172:175], v[104:107], a[76:79]
    v_exp_f32 v13, v51
    v_mfma_f32_16x16x32_bf16 a[108:111], a[172:175], v[108:111], a[108:111]
    ds_read_b128 a[148:151], v2 offset:37888
    v_mul_f32 v248, v190, v248
    v_mfma_f32_16x16x32_bf16 a[80:83], a[176:179], v[104:107], a[80:83]
    v_exp_f32 v10, v52
    v_mul_f32 v249, v191, v249
    v_mfma_f32_16x16x32_bf16 a[112:115], a[176:179], v[108:111], a[112:115]
    v_cvt_pk_bf16_f32 v121, v12, v13
    v_fmac_f32 v248, v182, v250
    v_mfma_f32_16x16x32_bf16 a[84:87], a[180:183], v[104:107], a[84:87]
    v_exp_f32 v11, v53
    v_fmac_f32 v249, v183, v251
    v_mfma_f32_16x16x32_bf16 a[116:119], a[180:183], v[108:111], a[116:119]
    ds_read_b128 a[156:159], v2 offset:39936
    v_cmp_nge_f32 vcc, s66, v86
    v_mfma_f32_16x16x32_bf16 a[88:91], a[184:187], v[104:107], a[88:91]
    v_exp_f32 v12, v54
    v_cvt_pk_bf16_f32 v215, v248, v249
    v_mfma_f32_16x16x32_bf16 a[120:123], a[184:187], v[108:111], a[120:123]
    buffer_store_dwordx4 v[208:211], v165, s[4:7], s75 offen offset:0 sc1
    v_cvt_pk_bf16_f32 v122, v10, v11
    v_mfma_f32_16x16x32_bf16 a[92:95], a[188:191], v[104:107], a[92:95]
    v_exp_f32 v13, v55
    v_mfma_f32_16x16x32_bf16 a[124:127], a[188:191], v[108:111], a[124:127]
    s_waitcnt lgkmcnt(4)
    s_cbranch_vccnz L_tramp8
L_ret8:
    v_mfma_f32_16x16x32_bf16 v[32:35], a[128:131], a[224:227], v[64:67]
    v_exp_f32 v10, v56
    v_mfma_f32_16x16x32_bf16 v[32:35], a[136:139], a[228:231], v[32:35]
    v_cvt_pk_bf16_f32 v123, v12, v13
    v_mfma_f32_16x16x32_bf16 v[32:35], a[144:147], a[232:235], v[32:35]
    v_exp_f32 v11, v57
    v_mfma_f32_16x16x32_bf16 v[32:35], a[152:155], a[236:239], v[32:35]
    ds_read_b128 a[160:163], v2 offset:40960
    buffer_store_dwordx4 v[212:215], v165, s[4:7], s76 offen offset:0 sc1
    v_mfma_f32_16x16x32_bf16 v[40:43], a[128:131], a[240:243], v[68:71]
    s_waitcnt vmcnt(20)
    v_exp_f32 v12, v58
    v_mfma_f32_16x16x32_bf16 v[40:43], a[136:139], a[244:247], v[40:43]
    v_cvt_pk_bf16_f32 v124, v10, v11
    v_lshlrev_b32 v28, 16, v244
    v_and_b32 v244, 0xffff0000, v244
    v_mfma_f32_16x16x32_bf16 v[40:43], a[144:147], a[248:251], v[40:43]
    v_exp_f32 v13, v59
    v_mfma_f32_16x16x32_bf16 v[40:43], a[152:155], a[252:255], v[40:43]
    ds_read_b128 a[164:167], v2 offset:41984
    v_lshlrev_b32 v29, 16, v245
    v_and_b32 v245, 0xffff0000, v245
    v_mfma_f32_16x16x32_bf16 v[92:95], v[14:17], v[120:123], v[88:91]
    s_waitcnt lgkmcnt(2)
    buffer_load_dwordx4 v3, s[4:7], s64 offen offset:2048 lds
    v_lshlrev_b32 v30, 16, v246
    v_mfma_f32_16x16x32_bf16 v[36:39], a[132:135], a[224:227], v[64:67]
    v_exp_f32 v10, v60
    v_mfma_f32_16x16x32_bf16 v[36:39], a[140:143], a[228:231], v[36:39]
    v_cvt_pk_bf16_f32 v125, v12, v13
    v_and_b32 v246, 0xffff0000, v246
    v_mfma_f32_16x16x32_bf16 v[36:39], a[148:151], a[232:235], v[36:39]
    v_exp_f32 v11, v61
    v_lshlrev_b32 v31, 16, v247
    v_mfma_f32_16x16x32_bf16 v[36:39], a[156:159], a[236:239], v[36:39]
    ds_read_b128 a[168:171], v2 offset:43008
    buffer_load_ushort v240, v168, s[28:31], s74 offen
    v_mfma_f32_16x16x32_bf16 v[44:47], a[132:135], a[240:243], v[68:71]
    v_exp_f32 v12, v62
    v_mfma_f32_16x16x32_bf16 v[44:47], a[140:143], a[244:247], v[44:47]
    v_cvt_pk_bf16_f32 v126, v10, v11
    v_and_b32 v247, 0xffff0000, v247
    v_mfma_f32_16x16x32_bf16 v[44:47], a[148:151], a[248:251], v[44:47]
    v_exp_f32 v13, v63
    v_mul_f32 v28, s87, v28
    v_mfma_f32_16x16x32_bf16 v[44:47], a[156:159], a[252:255], v[44:47]
    ds_read_b128 a[172:175], v2 offset:44032
    buffer_load_ushort v241, v168, s[32:35], s74 offen
    v_mfma_f32_16x16x32_bf16 a[0:3], a[192:195], v[112:115], a[0:3]
    v_exp_f32 v10, v32
    v_mfma_f32_16x16x32_bf16 a[32:35], a[192:195], v[116:119], a[32:35]
    v_cvt_pk_bf16_f32 v127, v12, v13
    v_mul_f32 v244, s87, v244
    v_mul_f32 v29, s87, v29
    v_mfma_f32_16x16x32_bf16 a[4:7], a[196:199], v[112:115], a[4:7]
    v_exp_f32 v11, v33
    v_mfma_f32_16x16x32_bf16 a[36:39], a[196:199], v[116:119], a[36:39]
    ds_read_b128 a[176:179], v2 offset:45056
    v_mul_f32 v245, s87, v245
    v_mul_f32_e64 v30, -v30, v28
    v_mfma_f32_16x16x32_bf16 v[92:95], v[18:21], v[124:127], v[92:95]
    ds_read_b128 a[188:191], v2 offset:48128
    v_mul_f32_e64 v246, -v246, v244
    v_mfma_f32_16x16x32_bf16 a[8:11], a[200:203], v[112:115], a[8:11]
    v_exp_f32 v12, v34
    v_mfma_f32_16x16x32_bf16 a[40:43], a[200:203], v[116:119], a[40:43]
    buffer_load_dwordx4 v3, s[4:7], s64 offen offset:3072 lds
    v_cvt_pk_bf16_f32 v96, v10, v11
    v_mfma_f32_16x16x32_bf16 a[12:15], a[204:207], v[112:115], a[12:15]
    v_exp_f32 v13, v35
    v_mul_f32_e64 v31, -v31, v29
    v_mfma_f32_16x16x32_bf16 a[44:47], a[204:207], v[116:119], a[44:47]
    ds_read_b128 a[180:183], v2 offset:46080
    v_mul_f32_e64 v247, -v247, v245
    v_mfma_f32_16x16x32_bf16 a[16:19], a[208:211], v[112:115], a[16:19]
    v_exp_f32 v10, v36
    v_cvt_f32_i32 v192, v192
    v_mfma_f32_16x16x32_bf16 a[48:51], a[208:211], v[116:119], a[48:51]
    buffer_load_dwordx4 v[176:179], v167, s[24:27], s71 offen offset:0 nt
    v_cvt_pk_bf16_f32 v97, v12, v13
    v_mfma_f32_16x16x32_bf16 a[20:23], a[212:215], v[112:115], a[20:23]
    v_exp_f32 v11, v37
    v_mfma_f32_16x16x32_bf16 a[52:55], a[212:215], v[116:119], a[52:55]
    ds_read_b128 a[184:187], v2 offset:47104
    v_cmp_nge_f32 vcc, s66, v94
    v_cvt_f32_i32 v193, v193
    v_mfma_f32_16x16x32_bf16 a[24:27], a[216:219], v[112:115], a[24:27]
    v_exp_f32 v12, v38
    v_mfma_f32_16x16x32_bf16 a[56:59], a[216:219], v[116:119], a[56:59]
    buffer_load_dwordx4 v[180:183], v167, s[24:27], s71 offen offset:512 nt
    v_cvt_pk_bf16_f32 v98, v10, v11
    v_mfma_f32_16x16x32_bf16 a[28:31], a[220:223], v[112:115], a[28:31]
    v_exp_f32 v13, v39
    v_mfma_f32_16x16x32_bf16 a[60:63], a[220:223], v[116:119], a[60:63]
    s_cbranch_vccnz L_tramp9
L_ret9:
    v_mfma_f32_16x16x32_bf16 v[48:51], a[128:131], v[128:131], v[72:75]
    v_exp_f32 v10, v40
    v_cvt_f32_i32 v200, v200
    v_mfma_f32_16x16x32_bf16 v[48:51], a[136:139], v[132:135], v[48:51]
    buffer_load_dwordx4 v[184:187], v167, s[24:27], s71 offen offset:1024 nt
    v_cvt_pk_bf16_f32 v99, v12, v13
    v_mfma_f32_16x16x32_bf16 v[48:51], a[144:147], v[136:139], v[48:51]
    v_exp_f32 v11, v41
    v_mfma_f32_16x16x32_bf16 v[48:51], a[152:155], v[140:143], v[48:51]
    v_cvt_f32_i32 v201, v201
    v_fma_f32 v192, v192, v28, v30
    v_fma_f32 v193, v193, v28, v30
    v_mfma_f32_16x16x32_bf16 v[56:59], a[128:131], v[144:147], v[76:79]
    v_exp_f32 v12, v42
    v_mfma_f32_16x16x32_bf16 v[56:59], a[136:139], v[148:151], v[56:59]
    v_cvt_pk_bf16_f32 v100, v10, v11
    v_fma_f32 v200, v200, v29, v31
    v_fma_f32 v201, v201, v29, v31
    v_mfma_f32_16x16x32_bf16 v[56:59], a[144:147], v[152:155], v[56:59]
    s_waitcnt vmcnt(16)
    v_exp_f32 v13, v43
    v_mfma_f32_16x16x32_bf16 v[56:59], a[152:155], v[156:159], v[56:59]
    s_add_u32 m0, s65, 36864
    ds_read_b128 a[128:131], v2 offset:49152
    v_lshlrev_b32 v248, 16, v224
    v_mfma_f32_16x16x32_bf16 v[80:83], v[14:17], v[96:99], v[84:87]
    ds_read_b128 a[136:139], v2 offset:51200
    buffer_load_dwordx4 v9, s[4:7], s64 offen offset:0 lds
    v_mfma_f32_16x16x32_bf16 v[52:55], a[132:135], v[128:131], v[72:75]
    v_exp_f32 v10, v44
    v_and_b32 v249, 0xffff0000, v224
    v_mfma_f32_16x16x32_bf16 v[52:55], a[140:143], v[132:135], v[52:55]
    v_cvt_pk_bf16_f32 v101, v12, v13
    v_lshlrev_b32 v250, 16, v232
    v_mfma_f32_16x16x32_bf16 v[52:55], a[148:151], v[136:139], v[52:55]
    v_exp_f32 v11, v45
    v_and_b32 v251, 0xffff0000, v232
    v_mfma_f32_16x16x32_bf16 v[52:55], a[156:159], v[140:143], v[52:55]
    ds_read_b128 a[144:147], v2 offset:53248
    buffer_load_dwordx4 v[188:191], v167, s[24:27], s71 offen offset:1536 nt
    v_mfma_f32_16x16x32_bf16 v[60:63], a[132:135], v[144:147], v[76:79]
    v_exp_f32 v12, v46
    v_mfma_f32_16x16x32_bf16 v[60:63], a[140:143], v[148:151], v[60:63]
    v_cvt_pk_bf16_f32 v102, v10, v11
    v_mul_f32 v248, v192, v248
    v_mul_f32 v249, v193, v249
    v_mfma_f32_16x16x32_bf16 v[60:63], a[148:151], v[152:155], v[60:63]
    v_exp_f32 v13, v47
    v_mfma_f32_16x16x32_bf16 v[60:63], a[156:159], v[156:159], v[60:63]
    ds_read_b128 a[152:155], v2 offset:55296
    buffer_load_dwordx4 v[208:211], v167, s[24:27], s71 offen offset:2048 nt
    v_mfma_f32_16x16x32_bf16 a[64:67], a[192:195], v[120:123], a[64:67]
    v_exp_f32 v10, v48
    v_mfma_f32_16x16x32_bf16 a[96:99], a[192:195], v[124:127], a[96:99]
    v_cvt_pk_bf16_f32 v103, v12, v13
    v_fma_f32 v248, -v200, v250, v248
    v_fma_f32 v249, -v201, v251, v249
    v_mfma_f32_16x16x32_bf16 a[68:71], a[196:199], v[120:123], a[68:71]
    v_exp_f32 v11, v49
    v_mfma_f32_16x16x32_bf16 a[100:103], a[196:199], v[124:127], a[100:103]
    ds_read_b128 a[132:135], v2 offset:50176
    v_cvt_pk_bf16_f32 v224, v248, v249
    v_lshlrev_b32 v248, 16, v228
    v_mfma_f32_16x16x32_bf16 v[80:83], v[18:21], v[100:103], v[80:83]
    ds_read_b128 a[140:143], v2 offset:52224
    v_and_b32 v249, 0xffff0000, v228
    v_mfma_f32_16x16x32_bf16 a[72:75], a[200:203], v[120:123], a[72:75]
    v_exp_f32 v12, v50
    v_lshlrev_b32 v250, 16, v236
    v_mfma_f32_16x16x32_bf16 a[104:107], a[200:203], v[124:127], a[104:107]
    buffer_load_dwordx4 v9, s[4:7], s64 offen offset:1024 lds
    v_cvt_pk_bf16_f32 v104, v10, v11
    v_mfma_f32_16x16x32_bf16 a[76:79], a[204:207], v[120:123], a[76:79]
    v_exp_f32 v13, v51
    v_mfma_f32_16x16x32_bf16 a[108:111], a[204:207], v[124:127], a[108:111]
    ds_read_b128 a[148:151], v2 offset:54272
    v_and_b32 v251, 0xffff0000, v236
    v_mfma_f32_16x16x32_bf16 a[80:83], a[208:211], v[120:123], a[80:83]
    v_exp_f32 v10, v52
    v_mul_f32 v248, v200, v248
    v_mfma_f32_16x16x32_bf16 a[112:115], a[208:211], v[124:127], a[112:115]
    buffer_load_dwordx4 v[212:215], v167, s[24:27], s71 offen offset:2560 nt
    v_cvt_pk_bf16_f32 v105, v12, v13
    v_mfma_f32_16x16x32_bf16 a[84:87], a[212:215], v[120:123], a[84:87]
    v_exp_f32 v11, v53
    v_mfma_f32_16x16x32_bf16 a[116:119], a[212:215], v[124:127], a[116:119]
    ds_read_b128 a[156:159], v2 offset:56320
    v_cmp_nge_f32 vcc, s66, v82
    v_mul_f32 v249, v201, v249
    v_mfma_f32_16x16x32_bf16 a[88:91], a[216:219], v[120:123], a[88:91]
    v_exp_f32 v12, v54
    v_mfma_f32_16x16x32_bf16 a[120:123], a[216:219], v[124:127], a[120:123]
    buffer_load_dwordx4 v[216:219], v167, s[24:27], s71 offen offset:3072 nt
    v_cvt_pk_bf16_f32 v106, v10, v11
    v_mfma_f32_16x16x32_bf16 a[92:95], a[220:223], v[120:123], a[92:95]
    v_exp_f32 v13, v55
    v_fmac_f32 v248, v192, v250
    v_mfma_f32_16x16x32_bf16 a[124:127], a[220:223], v[124:127], a[124:127]
    s_waitcnt lgkmcnt(4)
    s_cbranch_vccnz L_tramp10
L_ret10:
    v_mfma_f32_16x16x32_bf16 v[32:35], a[128:131], a[224:227], v[64:67]
    v_exp_f32 v10, v56
    v_mfma_f32_16x16x32_bf16 v[32:35], a[136:139], a[228:231], v[32:35]
    buffer_load_dwordx4 v[220:223], v167, s[24:27], s71 offen offset:3584 nt
    v_cvt_pk_bf16_f32 v107, v12, v13
    v_mfma_f32_16x16x32_bf16 v[32:35], a[144:147], a[232:235], v[32:35]
    v_exp_f32 v11, v57
    v_mfma_f32_16x16x32_bf16 v[32:35], a[152:155], a[236:239], v[32:35]
    ds_read_b128 a[192:195], v2 offset:57344
    v_fmac_f32 v249, v193, v251
    v_mfma_f32_16x16x32_bf16 v[40:43], a[128:131], a[240:243], v[68:71]
    v_exp_f32 v12, v58
    v_cvt_pk_bf16_f32 v228, v248, v249
    v_mfma_f32_16x16x32_bf16 v[40:43], a[136:139], a[244:247], v[40:43]
    v_cvt_pk_bf16_f32 v108, v10, v11
    v_cvt_f32_i32 v194, v194
    v_mfma_f32_16x16x32_bf16 v[40:43], a[144:147], a[248:251], v[40:43]
    v_exp_f32 v13, v59
    v_cvt_f32_i32 v195, v195
    v_mfma_f32_16x16x32_bf16 v[40:43], a[152:155], a[252:255], v[40:43]
    ds_read_b128 a[196:199], v2 offset:58368
    v_cvt_f32_i32 v202, v202
    v_mfma_f32_16x16x32_bf16 v[88:91], v[14:17], v[104:107], v[92:95]
    s_waitcnt lgkmcnt(2)
    buffer_load_dwordx4 v9, s[4:7], s64 offen offset:2048 lds
    v_cvt_f32_i32 v203, v203
    v_mfma_f32_16x16x32_bf16 v[36:39], a[132:135], a[224:227], v[64:67]
    v_exp_f32 v10, v60
    v_mfma_f32_16x16x32_bf16 v[36:39], a[140:143], a[228:231], v[36:39]
    v_cvt_pk_bf16_f32 v109, v12, v13
    v_fma_f32 v194, v194, v28, v30
    v_fma_f32 v195, v195, v28, v30
    v_mfma_f32_16x16x32_bf16 v[36:39], a[148:151], a[232:235], v[36:39]
    v_exp_f32 v11, v61
    v_mfma_f32_16x16x32_bf16 v[36:39], a[156:159], a[236:239], v[36:39]
    ds_read_b128 a[200:203], v2 offset:59392
    v_fma_f32 v202, v202, v29, v31
    v_mfma_f32_16x16x32_bf16 v[44:47], a[132:135], a[240:243], v[68:71]
    v_exp_f32 v12, v62
    v_fma_f32 v203, v203, v29, v31
    v_mfma_f32_16x16x32_bf16 v[44:47], a[140:143], a[244:247], v[44:47]
    v_cvt_pk_bf16_f32 v110, v10, v11
    v_lshlrev_b32 v248, 16, v225
    v_mfma_f32_16x16x32_bf16 v[44:47], a[148:151], a[248:251], v[44:47]
    v_exp_f32 v13, v63
    v_and_b32 v249, 0xffff0000, v225
    v_mfma_f32_16x16x32_bf16 v[44:47], a[156:159], a[252:255], v[44:47]
    ds_read_b128 a[204:207], v2 offset:60416
    v_lshlrev_b32 v250, 16, v233
    v_mfma_f32_16x16x32_bf16 a[0:3], a[160:163], v[96:99], a[0:3]
    v_exp_f32 v10, v32
    v_and_b32 v251, 0xffff0000, v233
    v_mfma_f32_16x16x32_bf16 a[32:35], a[160:163], v[100:103], a[32:35]
    v_cvt_pk_bf16_f32 v111, v12, v13
    v_mul_f32 v248, v194, v248
    v_mfma_f32_16x16x32_bf16 a[4:7], a[164:167], v[96:99], a[4:7]
    v_exp_f32 v11, v33
    v_mfma_f32_16x16x32_bf16 a[36:39], a[164:167], v[100:103], a[36:39]
    ds_read_b128 a[208:211], v2 offset:61440
    v_mul_f32 v249, v195, v249
    v_fma_f32 v248, -v202, v250, v248
    v_mfma_f32_16x16x32_bf16 v[88:91], v[18:21], v[108:111], v[88:91]
    ds_read_b128 a[220:223], v2 offset:64512
    v_fma_f32 v249, -v203, v251, v249
    v_mfma_f32_16x16x32_bf16 a[8:11], a[168:171], v[96:99], a[8:11]
    v_exp_f32 v12, v34
    v_cvt_pk_bf16_f32 v225, v248, v249
    v_mfma_f32_16x16x32_bf16 a[40:43], a[168:171], v[100:103], a[40:43]
    buffer_load_dwordx4 v9, s[4:7], s64 offen offset:3072 lds
    v_cvt_pk_bf16_f32 v112, v10, v11
    v_mfma_f32_16x16x32_bf16 a[12:15], a[172:175], v[96:99], a[12:15]
    v_exp_f32 v13, v35
    v_mfma_f32_16x16x32_bf16 a[44:47], a[172:175], v[100:103], a[44:47]
    ds_read_b128 a[212:215], v2 offset:62464
    v_lshlrev_b32 v248, 16, v229
    v_and_b32 v249, 0xffff0000, v229
    v_mfma_f32_16x16x32_bf16 a[16:19], a[176:179], v[96:99], a[16:19]
    v_exp_f32 v10, v36
    v_mfma_f32_16x16x32_bf16 a[48:51], a[176:179], v[100:103], a[48:51]
    v_cvt_pk_bf16_f32 v113, v12, v13
    v_lshlrev_b32 v250, 16, v237
    v_mfma_f32_16x16x32_bf16 a[20:23], a[180:183], v[96:99], a[20:23]
    v_exp_f32 v11, v37
    v_and_b32 v251, 0xffff0000, v237
    v_mfma_f32_16x16x32_bf16 a[52:55], a[180:183], v[100:103], a[52:55]
    ds_read_b128 a[216:219], v2 offset:63488
    v_cmp_nge_f32 vcc, s66, v90
    v_mfma_f32_16x16x32_bf16 a[24:27], a[184:187], v[96:99], a[24:27]
    v_exp_f32 v12, v38
    v_mul_f32 v248, v202, v248
    v_mfma_f32_16x16x32_bf16 a[56:59], a[184:187], v[100:103], a[56:59]
    v_cvt_pk_bf16_f32 v114, v10, v11
    v_mul_f32 v249, v203, v249
    v_mfma_f32_16x16x32_bf16 a[28:31], a[188:191], v[96:99], a[28:31]
    v_exp_f32 v13, v39
    v_fmac_f32 v248, v194, v250
    v_mfma_f32_16x16x32_bf16 a[60:63], a[188:191], v[100:103], a[60:63]
    s_cbranch_vccnz L_tramp11
L_ret11:
    v_mfma_f32_16x16x32_bf16 v[48:51], a[128:131], v[128:131], v[72:75]
    s_waitcnt vmcnt(20)
    v_exp_f32 v10, v40
    v_mfma_f32_16x16x32_bf16 v[48:51], a[136:139], v[132:135], v[48:51]
    s_barrier
    v_cvt_pk_bf16_f32 v115, v12, v13
    v_fmac_f32 v249, v195, v251
    v_mfma_f32_16x16x32_bf16 v[48:51], a[144:147], v[136:139], v[48:51]
    v_exp_f32 v11, v41
    v_cvt_pk_bf16_f32 v229, v248, v249
    v_mfma_f32_16x16x32_bf16 v[48:51], a[152:155], v[140:143], v[48:51]
    v_cvt_f32_i32 v196, v196
    v_cvt_f32_i32 v197, v197
    v_mfma_f32_16x16x32_bf16 v[56:59], a[128:131], v[144:147], v[76:79]
    v_exp_f32 v12, v42
    v_cvt_f32_i32 v204, v204
    v_mfma_f32_16x16x32_bf16 v[56:59], a[136:139], v[148:151], v[56:59]
    v_cvt_pk_bf16_f32 v116, v10, v11
    v_cvt_f32_i32 v205, v205
    v_mfma_f32_16x16x32_bf16 v[56:59], a[144:147], v[152:155], v[56:59]
    s_add_u32 s64, s50, s69
    v_exp_f32 v13, v43
    v_fma_f32 v196, v196, v244, v246
    v_mfma_f32_16x16x32_bf16 v[56:59], a[152:155], v[156:159], v[56:59]
    s_add_u32 m0, s65, 65536
    ds_read_b128 a[128:131], v1 offset:0
    v_fma_f32 v197, v197, v244, v246
    v_mfma_f32_16x16x32_bf16 v[84:87], v[14:17], v[112:115], v[80:83]
    ds_read_b128 a[136:139], v1 offset:2048
    buffer_load_dwordx4 v3, s[4:7], s64 offen offset:0 lds
    v_mfma_f32_16x16x32_bf16 v[52:55], a[132:135], v[128:131], v[72:75]
    v_exp_f32 v10, v44
    v_mfma_f32_16x16x32_bf16 v[52:55], a[140:143], v[132:135], v[52:55]
    v_cvt_pk_bf16_f32 v117, v12, v13
    v_fma_f32 v204, v204, v245, v247
    v_fma_f32 v205, v205, v245, v247
    v_mfma_f32_16x16x32_bf16 v[52:55], a[148:151], v[136:139], v[52:55]
    v_exp_f32 v11, v45
    v_mfma_f32_16x16x32_bf16 v[52:55], a[156:159], v[140:143], v[52:55]
    ds_read_b128 a[144:147], v1 offset:4096
    v_lshlrev_b32 v248, 16, v226
    v_and_b32 v249, 0xffff0000, v226
    v_mfma_f32_16x16x32_bf16 v[60:63], a[132:135], v[144:147], v[76:79]
    v_exp_f32 v12, v46
    v_mfma_f32_16x16x32_bf16 v[60:63], a[140:143], v[148:151], v[60:63]
    v_cvt_pk_bf16_f32 v118, v10, v11
    v_lshlrev_b32 v250, 16, v234
    v_and_b32 v251, 0xffff0000, v234
    v_mfma_f32_16x16x32_bf16 v[60:63], a[148:151], v[152:155], v[60:63]
    v_exp_f32 v13, v47
    v_mfma_f32_16x16x32_bf16 v[60:63], a[156:159], v[156:159], v[60:63]
    ds_read_b128 a[152:155], v1 offset:6144
    v_mul_f32 v248, v196, v248
    v_mfma_f32_16x16x32_bf16 a[64:67], a[160:163], v[104:107], a[64:67]
    v_exp_f32 v10, v48
    v_mul_f32 v249, v197, v249
    v_mfma_f32_16x16x32_bf16 a[96:99], a[160:163], v[108:111], a[96:99]
    v_cvt_pk_bf16_f32 v119, v12, v13
    v_fma_f32 v248, -v204, v250, v248
    v_mfma_f32_16x16x32_bf16 a[68:71], a[164:167], v[104:107], a[68:71]
    v_exp_f32 v11, v49
    v_fma_f32 v249, -v205, v251, v249
    v_mfma_f32_16x16x32_bf16 a[100:103], a[164:167], v[108:111], a[100:103]
    ds_read_b128 a[132:135], v1 offset:1024
    v_cvt_pk_bf16_f32 v226, v248, v249
    v_mfma_f32_16x16x32_bf16 v[84:87], v[18:21], v[116:119], v[84:87]
    ds_read_b128 a[140:143], v1 offset:3072
    v_lshlrev_b32 v248, 16, v230
    v_and_b32 v249, 0xffff0000, v230
    v_mfma_f32_16x16x32_bf16 a[72:75], a[168:171], v[104:107], a[72:75]
    v_exp_f32 v12, v50
    v_mfma_f32_16x16x32_bf16 a[104:107], a[168:171], v[108:111], a[104:107]
    buffer_load_dwordx4 v3, s[4:7], s64 offen offset:1024 lds
    v_cvt_pk_bf16_f32 v120, v10, v11
    v_mfma_f32_16x16x32_bf16 a[76:79], a[172:175], v[104:107], a[76:79]
    v_exp_f32 v13, v51
    v_lshlrev_b32 v250, 16, v238
    v_mfma_f32_16x16x32_bf16 a[108:111], a[172:175], v[108:111], a[108:111]
    ds_read_b128 a[148:151], v1 offset:5120
    v_and_b32 v251, 0xffff0000, v238
    v_mfma_f32_16x16x32_bf16 a[80:83], a[176:179], v[104:107], a[80:83]
    v_exp_f32 v10, v52
    v_mfma_f32_16x16x32_bf16 a[112:115], a[176:179], v[108:111], a[112:115]
    v_cvt_pk_bf16_f32 v121, v12, v13
    v_mul_f32 v248, v204, v248
    v_mul_f32 v249, v205, v249
    v_mfma_f32_16x16x32_bf16 a[84:87], a[180:183], v[104:107], a[84:87]
    v_exp_f32 v11, v53
    v_mfma_f32_16x16x32_bf16 a[116:119], a[180:183], v[108:111], a[116:119]
    ds_read_b128 a[156:159], v1 offset:7168
    v_cmp_nge_f32 vcc, s66, v86
    v_fmac_f32 v248, v196, v250
    v_mfma_f32_16x16x32_bf16 a[88:91], a[184:187], v[104:107], a[88:91]
    v_exp_f32 v12, v54
    v_mfma_f32_16x16x32_bf16 a[120:123], a[184:187], v[108:111], a[120:123]
    v_cvt_pk_bf16_f32 v122, v10, v11
    v_fmac_f32 v249, v197, v251
    v_cvt_pk_bf16_f32 v230, v248, v249
    v_mfma_f32_16x16x32_bf16 a[92:95], a[188:191], v[104:107], a[92:95]
    v_exp_f32 v13, v55
    v_mfma_f32_16x16x32_bf16 a[124:127], a[188:191], v[108:111], a[124:127]
    s_waitcnt lgkmcnt(4)
    s_cbranch_vccnz L_tramp12
L_ret12:
    v_mfma_f32_16x16x32_bf16 v[32:35], a[128:131], a[224:227], v[64:67]
    v_exp_f32 v10, v56
    v_mfma_f32_16x16x32_bf16 v[32:35], a[136:139], a[228:231], v[32:35]
    v_cvt_pk_bf16_f32 v123, v12, v13
    v_cvt_f32_i32 v198, v198
    v_mfma_f32_16x16x32_bf16 v[32:35], a[144:147], a[232:235], v[32:35]
    v_exp_f32 v11, v57
    v_cvt_f32_i32 v199, v199
    v_mfma_f32_16x16x32_bf16 v[32:35], a[152:155], a[236:239], v[32:35]
    ds_read_b128 a[160:163], v1 offset:8192
    v_cvt_f32_i32 v206, v206
    v_mfma_f32_16x16x32_bf16 v[40:43], a[128:131], a[240:243], v[68:71]
    v_exp_f32 v12, v58
    v_cvt_f32_i32 v207, v207
    v_mfma_f32_16x16x32_bf16 v[40:43], a[136:139], a[244:247], v[40:43]
    v_cvt_pk_bf16_f32 v124, v10, v11
    v_fma_f32 v198, v198, v244, v246
    v_mfma_f32_16x16x32_bf16 v[40:43], a[144:147], a[248:251], v[40:43]
    v_exp_f32 v13, v59
    v_fma_f32 v199, v199, v244, v246
    v_mfma_f32_16x16x32_bf16 v[40:43], a[152:155], a[252:255], v[40:43]
    ds_read_b128 a[164:167], v1 offset:9216
    v_fma_f32 v206, v206, v245, v247
    v_mfma_f32_16x16x32_bf16 v[92:95], v[14:17], v[120:123], v[88:91]
    s_waitcnt lgkmcnt(2)
    buffer_load_dwordx4 v3, s[4:7], s64 offen offset:2048 lds
    v_fma_f32 v207, v207, v245, v247
    v_mfma_f32_16x16x32_bf16 v[36:39], a[132:135], a[224:227], v[64:67]
    v_exp_f32 v10, v60
    v_mfma_f32_16x16x32_bf16 v[36:39], a[140:143], a[228:231], v[36:39]
    v_cvt_pk_bf16_f32 v125, v12, v13
    v_lshlrev_b32 v248, 16, v227
    v_mfma_f32_16x16x32_bf16 v[36:39], a[148:151], a[232:235], v[36:39]
    v_exp_f32 v11, v61
    v_and_b32 v249, 0xffff0000, v227
    v_mfma_f32_16x16x32_bf16 v[36:39], a[156:159], a[236:239], v[36:39]
    ds_read_b128 a[168:171], v1 offset:10240
    v_lshlrev_b32 v250, 16, v235
    v_mfma_f32_16x16x32_bf16 v[44:47], a[132:135], a[240:243], v[68:71]
    v_exp_f32 v12, v62
    v_and_b32 v251, 0xffff0000, v235
    v_mfma_f32_16x16x32_bf16 v[44:47], a[140:143], a[244:247], v[44:47]
    v_cvt_pk_bf16_f32 v126, v10, v11
    v_mul_f32 v248, v198, v248
    v_mfma_f32_16x16x32_bf16 v[44:47], a[148:151], a[248:251], v[44:47]
    v_exp_f32 v13, v63
    v_mfma_f32_16x16x32_bf16 v[44:47], a[156:159], a[252:255], v[44:47]
    ds_read_b128 a[172:175], v1 offset:11264
    v_mul_f32 v249, v199, v249
    v_fma_f32 v248, -v206, v250, v248
    v_mfma_f32_16x16x32_bf16 a[0:3], a[192:195], v[112:115], a[0:3]
    v_exp_f32 v10, v32
    v_mfma_f32_16x16x32_bf16 a[32:35], a[192:195], v[116:119], a[32:35]
    v_cvt_pk_bf16_f32 v127, v12, v13
    v_fma_f32 v249, -v207, v251, v249
    v_cvt_pk_bf16_f32 v227, v248, v249
    v_mfma_f32_16x16x32_bf16 a[4:7], a[196:199], v[112:115], a[4:7]
    v_exp_f32 v11, v33
    v_mfma_f32_16x16x32_bf16 a[36:39], a[196:199], v[116:119], a[36:39]
    ds_read_b128 a[176:179], v1 offset:12288
    v_lshlrev_b32 v248, 16, v231
    v_and_b32 v249, 0xffff0000, v231
    v_mfma_f32_16x16x32_bf16 v[92:95], v[18:21], v[124:127], v[92:95]
    ds_read_b128 a[188:191], v1 offset:15360
    v_lshlrev_b32 v250, 16, v239
    v_mfma_f32_16x16x32_bf16 a[8:11], a[200:203], v[112:115], a[8:11]
    v_exp_f32 v12, v34
    v_mfma_f32_16x16x32_bf16 a[40:43], a[200:203], v[116:119], a[40:43]
    buffer_load_dwordx4 v3, s[4:7], s64 offen offset:3072 lds
    v_cvt_pk_bf16_f32 v96, v10, v11
    v_mfma_f32_16x16x32_bf16 a[12:15], a[204:207], v[112:115], a[12:15]
    v_exp_f32 v13, v35
    v_and_b32 v251, 0xffff0000, v239
    v_mfma_f32_16x16x32_bf16 a[44:47], a[204:207], v[116:119], a[44:47]
    ds_read_b128 a[180:183], v1 offset:13312
    v_mul_f32 v248, v206, v248
    v_mfma_f32_16x16x32_bf16 a[16:19], a[208:211], v[112:115], a[16:19]
    v_exp_f32 v10, v36
    v_mul_f32 v249, v207, v249
    v_mfma_f32_16x16x32_bf16 a[48:51], a[208:211], v[116:119], a[48:51]
    v_cvt_pk_bf16_f32 v97, v12, v13
    v_fmac_f32 v248, v198, v250
    v_mfma_f32_16x16x32_bf16 a[20:23], a[212:215], v[112:115], a[20:23]
    v_exp_f32 v11, v37
    v_fmac_f32 v249, v199, v251
    v_mfma_f32_16x16x32_bf16 a[52:55], a[212:215], v[116:119], a[52:55]
    ds_read_b128 a[184:187], v1 offset:14336
    v_cmp_nge_f32 vcc, s66, v94
    v_mfma_f32_16x16x32_bf16 a[24:27], a[216:219], v[112:115], a[24:27]
    v_exp_f32 v12, v38
    v_cvt_pk_bf16_f32 v231, v248, v249
    v_mfma_f32_16x16x32_bf16 a[56:59], a[216:219], v[116:119], a[56:59]
    buffer_store_dwordx4 v[224:227], v165, s[4:7], s75 offen offset:1024 sc1
    v_cvt_pk_bf16_f32 v98, v10, v11
    v_mfma_f32_16x16x32_bf16 a[28:31], a[220:223], v[112:115], a[28:31]
    v_exp_f32 v13, v39
    v_mfma_f32_16x16x32_bf16 a[60:63], a[220:223], v[116:119], a[60:63]
    s_cbranch_vccnz L_tramp13
L_ret13:
    v_mfma_f32_16x16x32_bf16 v[48:51], a[128:131], v[128:131], v[72:75]
    v_exp_f32 v10, v40
    v_mfma_f32_16x16x32_bf16 v[48:51], a[136:139], v[132:135], v[48:51]
    v_cvt_pk_bf16_f32 v99, v12, v13
    v_mfma_f32_16x16x32_bf16 v[48:51], a[144:147], v[136:139], v[48:51]
    v_exp_f32 v11, v41
    v_mfma_f32_16x16x32_bf16 v[48:51], a[152:155], v[140:143], v[48:51]
    buffer_store_dwordx4 v[228:231], v165, s[4:7], s76 offen offset:1024 sc1
    v_mfma_f32_16x16x32_bf16 v[56:59], a[128:131], v[144:147], v[76:79]
    s_waitcnt vmcnt(19)
    v_exp_f32 v12, v42
    v_mfma_f32_16x16x32_bf16 v[56:59], a[136:139], v[148:151], v[56:59]
    v_cvt_pk_bf16_f32 v100, v10, v11
    v_mfma_f32_16x16x32_bf16 v[56:59], a[144:147], v[152:155], v[56:59]
    v_exp_f32 v13, v43
    v_mfma_f32_16x16x32_bf16 v[56:59], a[152:155], v[156:159], v[56:59]
    s_add_u32 m0, s65, 69632
    ds_read_b128 a[128:131], v1 offset:16384
    v_lshlrev_b32 v240, 16, v240
    v_lshlrev_b32 v241, 16, v241
    v_mfma_f32_16x16x32_bf16 v[80:83], v[14:17], v[96:99], v[84:87]
    ds_read_b128 a[136:139], v1 offset:18432
    buffer_load_dwordx4 v9, s[4:7], s64 offen offset:0 lds
    v_mfma_f32_16x16x32_bf16 v[52:55], a[132:135], v[128:131], v[72:75]
    v_exp_f32 v10, v44
    v_mfma_f32_16x16x32_bf16 v[52:55], a[140:143], v[132:135], v[52:55]
    v_cvt_pk_bf16_f32 v101, v12, v13
    v_mul_f32_e64 v241, -v241, v240
    v_mfma_f32_16x16x32_bf16 v[52:55], a[148:151], v[136:139], v[52:55]
    v_exp_f32 v11, v45
    v_mfma_f32_16x16x32_bf16 v[52:55], a[156:159], v[140:143], v[52:55]
    ds_read_b128 a[144:147], v1 offset:20480
    ds_write_b64 v169, v[240:241]
    v_mfma_f32_16x16x32_bf16 v[60:63], a[132:135], v[144:147], v[76:79]
    s_waitcnt vmcnt(14)
    v_exp_f32 v12, v46
    v_cvt_f32_i32 v176, v176
    v_mfma_f32_16x16x32_bf16 v[60:63], a[140:143], v[148:151], v[60:63]
    v_cvt_pk_bf16_f32 v102, v10, v11
    v_cvt_f32_i32 v177, v177
    v_mfma_f32_16x16x32_bf16 v[60:63], a[148:151], v[152:155], v[60:63]
    v_exp_f32 v13, v47
    v_cvt_f32_i32 v178, v178
    v_mfma_f32_16x16x32_bf16 v[60:63], a[156:159], v[156:159], v[60:63]
    ds_read_b128 a[152:155], v1 offset:22528
    v_cvt_f32_i32 v179, v179
    v_mfma_f32_16x16x32_bf16 a[64:67], a[192:195], v[120:123], a[64:67]
    v_exp_f32 v10, v48
    v_cvt_f32_i32 v180, v180
    v_mfma_f32_16x16x32_bf16 a[96:99], a[192:195], v[124:127], a[96:99]
    v_cvt_pk_bf16_f32 v103, v12, v13
    v_cvt_f32_i32 v181, v181
    v_mfma_f32_16x16x32_bf16 a[68:71], a[196:199], v[120:123], a[68:71]
    v_exp_f32 v11, v49
    v_cvt_f32_i32 v182, v182
    v_mfma_f32_16x16x32_bf16 a[100:103], a[196:199], v[124:127], a[100:103]
    ds_read_b128 a[132:135], v1 offset:17408
    v_cvt_f32_i32 v183, v183
    v_mfma_f32_16x16x32_bf16 v[80:83], v[18:21], v[100:103], v[80:83]
    ds_read_b128 a[140:143], v1 offset:19456
    v_cvt_f32_i32 v184, v184
    v_mfma_f32_16x16x32_bf16 a[72:75], a[200:203], v[120:123], a[72:75]
    v_exp_f32 v12, v50
    v_cvt_f32_i32 v185, v185
    v_mfma_f32_16x16x32_bf16 a[104:107], a[200:203], v[124:127], a[104:107]
    buffer_load_dwordx4 v9, s[4:7], s64 offen offset:1024 lds
    v_cvt_pk_bf16_f32 v104, v10, v11
    v_mfma_f32_16x16x32_bf16 a[76:79], a[204:207], v[120:123], a[76:79]
    v_exp_f32 v13, v51
    v_mfma_f32_16x16x32_bf16 a[108:111], a[204:207], v[124:127], a[108:111]
    ds_read_b128 a[148:151], v1 offset:21504
    v_cvt_f32_i32 v186, v186
    v_cvt_f32_i32 v187, v187
    v_mfma_f32_16x16x32_bf16 a[80:83], a[208:211], v[120:123], a[80:83]
    v_exp_f32 v10, v52
    v_mfma_f32_16x16x32_bf16 a[112:115], a[208:211], v[124:127], a[112:115]
    v_cvt_pk_bf16_f32 v105, v12, v13
    v_cvt_f32_i32 v188, v188
    v_cvt_f32_i32 v189, v189
    v_mfma_f32_16x16x32_bf16 a[84:87], a[212:215], v[120:123], a[84:87]
    v_exp_f32 v11, v53
    v_mfma_f32_16x16x32_bf16 a[116:119], a[212:215], v[124:127], a[116:119]
    ds_read_b128 a[156:159], v1 offset:23552
    v_cmp_nge_f32 vcc, s66, v82
    v_mfma_f32_16x16x32_bf16 a[88:91], a[216:219], v[120:123], a[88:91]
    v_exp_f32 v12, v54
    v_cvt_f32_i32 v190, v190
    v_mfma_f32_16x16x32_bf16 a[120:123], a[216:219], v[124:127], a[120:123]
    v_cvt_pk_bf16_f32 v106, v10, v11
    v_cvt_f32_i32 v191, v191
    v_mfma_f32_16x16x32_bf16 a[92:95], a[220:223], v[120:123], a[92:95]
    s_waitcnt lgkmcnt(5)
    v_exp_f32 v13, v55
    v_mfma_f32_16x16x32_bf16 a[124:127], a[220:223], v[124:127], a[124:127]
    s_waitcnt lgkmcnt(4)
    s_cbranch_vccnz L_tramp14
L_ret14:
    v_mfma_f32_16x16x32_bf16 v[32:35], a[128:131], a[224:227], v[64:67]
    v_exp_f32 v10, v56
    v_mfma_f32_16x16x32_bf16 v[32:35], a[136:139], a[228:231], v[32:35]
    ds_read_b128 v[192:195], v170 offset:0
    ds_read_b128 v[196:199], v170 offset:16
    v_cvt_pk_bf16_f32 v107, v12, v13
    v_mfma_f32_16x16x32_bf16 v[32:35], a[144:147], a[232:235], v[32:35]
    v_exp_f32 v11, v57
    v_mfma_f32_16x16x32_bf16 v[32:35], a[152:155], a[236:239], v[32:35]
    ds_read_b128 a[192:195], v1 offset:24576
    ds_read_b128 v[200:203], v170 offset:32
    ds_read_b128 v[204:207], v170 offset:48
    v_mfma_f32_16x16x32_bf16 v[40:43], a[128:131], a[240:243], v[68:71]
    s_waitcnt vmcnt(10)
    v_exp_f32 v12, v58
    v_mfma_f32_16x16x32_bf16 v[40:43], a[136:139], a[244:247], v[40:43]
    v_cvt_pk_bf16_f32 v108, v10, v11
    v_cvt_f32_i32 v208, v208
    v_cvt_f32_i32 v209, v209
    v_mfma_f32_16x16x32_bf16 v[40:43], a[144:147], a[248:251], v[40:43]
    v_exp_f32 v13, v59
    v_mfma_f32_16x16x32_bf16 v[40:43], a[152:155], a[252:255], v[40:43]
    ds_read_b128 a[196:199], v1 offset:25600
    v_cvt_f32_i32 v210, v210
    v_cvt_f32_i32 v211, v211
    v_mfma_f32_16x16x32_bf16 v[88:91], v[14:17], v[104:107], v[92:95]
    s_waitcnt lgkmcnt(6)
    buffer_load_dwordx4 v9, s[4:7], s64 offen offset:2048 lds
    v_mfma_f32_16x16x32_bf16 v[36:39], a[132:135], a[224:227], v[64:67]
    v_exp_f32 v10, v60
    v_mfma_f32_16x16x32_bf16 v[36:39], a[140:143], a[228:231], v[36:39]
    v_cvt_pk_bf16_f32 v109, v12, v13
    v_cvt_f32_i32 v212, v212
    v_cvt_f32_i32 v213, v213
    v_mfma_f32_16x16x32_bf16 v[36:39], a[148:151], a[232:235], v[36:39]
    v_exp_f32 v11, v61
    v_mfma_f32_16x16x32_bf16 v[36:39], a[156:159], a[236:239], v[36:39]
    ds_read_b128 a[200:203], v1 offset:26624
    v_cvt_f32_i32 v214, v214
    v_cvt_f32_i32 v215, v215
    v_mfma_f32_16x16x32_bf16 v[44:47], a[132:135], a[240:243], v[68:71]
    v_exp_f32 v12, v62
    v_mfma_f32_16x16x32_bf16 v[44:47], a[140:143], a[244:247], v[44:47]
    v_cvt_pk_bf16_f32 v110, v10, v11
    v_cvt_f32_i32 v216, v216
    v_cvt_f32_i32 v217, v217
    v_mfma_f32_16x16x32_bf16 v[44:47], a[148:151], a[248:251], v[44:47]
    v_exp_f32 v13, v63
    v_mfma_f32_16x16x32_bf16 v[44:47], a[156:159], a[252:255], v[44:47]
    ds_read_b128 a[204:207], v1 offset:27648
    v_cvt_f32_i32 v218, v218
    v_mfma_f32_16x16x32_bf16 a[0:3], a[160:163], v[96:99], a[0:3]
    v_exp_f32 v10, v32
    v_cvt_f32_i32 v219, v219
    v_mfma_f32_16x16x32_bf16 a[32:35], a[160:163], v[100:103], a[32:35]
    v_cvt_pk_bf16_f32 v111, v12, v13
    v_cvt_f32_i32 v220, v220
    v_mfma_f32_16x16x32_bf16 a[4:7], a[164:167], v[96:99], a[4:7]
    v_exp_f32 v11, v33
    v_cvt_f32_i32 v221, v221
    v_mfma_f32_16x16x32_bf16 a[36:39], a[164:167], v[100:103], a[36:39]
    ds_read_b128 a[208:211], v1 offset:28672
    v_cvt_f32_i32 v222, v222
    v_mfma_f32_16x16x32_bf16 v[88:91], v[18:21], v[108:111], v[88:91]
    ds_read_b128 a[220:223], v1 offset:31744
    v_cvt_f32_i32 v223, v223
    v_mfma_f32_16x16x32_bf16 a[8:11], a[168:171], v[96:99], a[8:11]
    s_waitcnt lgkmcnt(5)
    v_exp_f32 v12, v34
    v_fma_f32 v176, v176, v192, v193
    v_mfma_f32_16x16x32_bf16 a[40:43], a[168:171], v[100:103], a[40:43]
    buffer_load_dwordx4 v9, s[4:7], s64 offen offset:3072 lds
    v_cvt_pk_bf16_f32 v112, v10, v11
    v_mfma_f32_16x16x32_bf16 a[12:15], a[172:175], v[96:99], a[12:15]
    v_exp_f32 v13, v35
    v_mfma_f32_16x16x32_bf16 a[44:47], a[172:175], v[100:103], a[44:47]
    ds_read_b128 a[212:215], v1 offset:29696
    v_fma_f32 v177, v177, v192, v193
    v_fma_f32 v178, v178, v192, v193
    v_mfma_f32_16x16x32_bf16 a[16:19], a[176:179], v[96:99], a[16:19]
    v_exp_f32 v10, v36
    v_mfma_f32_16x16x32_bf16 a[48:51], a[176:179], v[100:103], a[48:51]
    v_cvt_pk_bf16_f32 v113, v12, v13
    v_fma_f32 v179, v179, v192, v193
    v_fma_f32 v180, v180, v194, v195
    v_mfma_f32_16x16x32_bf16 a[20:23], a[180:183], v[96:99], a[20:23]
    v_exp_f32 v11, v37
    v_mfma_f32_16x16x32_bf16 a[52:55], a[180:183], v[100:103], a[52:55]
    ds_read_b128 a[216:219], v1 offset:30720
    v_cmp_nge_f32 vcc, s66, v90
    v_fma_f32 v181, v181, v194, v195
    v_mfma_f32_16x16x32_bf16 a[24:27], a[184:187], v[96:99], a[24:27]
    v_exp_f32 v12, v38
    v_mfma_f32_16x16x32_bf16 a[56:59], a[184:187], v[100:103], a[56:59]
    v_cvt_pk_bf16_f32 v114, v10, v11
    v_fma_f32 v182, v182, v194, v195
    v_mfma_f32_16x16x32_bf16 a[28:31], a[188:191], v[96:99], a[28:31]
    v_exp_f32 v13, v39
    v_fma_f32 v183, v183, v194, v195
    v_mfma_f32_16x16x32_bf16 a[60:63], a[188:191], v[100:103], a[60:63]
    s_cbranch_vccnz L_tramp15
L_ret15:
    v_mfma_f32_16x16x32_bf16 v[48:51], a[128:131], v[128:131], v[72:75]
    s_waitcnt vmcnt(10)
    v_exp_f32 v10, v40
    v_mfma_f32_16x16x32_bf16 v[48:51], a[136:139], v[132:135], v[48:51]
    s_barrier
    v_cvt_pk_bf16_f32 v115, v12, v13
    v_cvt_pk_bf16_f32 v224, v176, v180
    v_cvt_pk_bf16_f32 v228, v177, v181
    v_mfma_f32_16x16x32_bf16 v[48:51], a[144:147], v[136:139], v[48:51]
    v_exp_f32 v11, v41
    v_mfma_f32_16x16x32_bf16 v[48:51], a[152:155], v[140:143], v[48:51]
    v_cvt_pk_bf16_f32 v232, v178, v182
    v_cvt_pk_bf16_f32 v236, v179, v183
    v_fma_f32 v184, v184, v196, v197
    v_mfma_f32_16x16x32_bf16 v[56:59], a[128:131], v[144:147], v[76:79]
    v_exp_f32 v12, v42
    v_mfma_f32_16x16x32_bf16 v[56:59], a[136:139], v[148:151], v[56:59]
    v_cvt_pk_bf16_f32 v116, v10, v11
    v_fma_f32 v185, v185, v196, v197
    v_mfma_f32_16x16x32_bf16 v[56:59], a[144:147], v[152:155], v[56:59]
    s_add_u32 s64, s51, s69
    v_exp_f32 v13, v43
    v_fma_f32 v186, v186, v196, v197
    v_mfma_f32_16x16x32_bf16 v[56:59], a[152:155], v[156:159], v[56:59]
    s_add_u32 m0, s65, 98304
    ds_read_b128 a[128:131], v1 offset:32768
    v_fma_f32 v187, v187, v196, v197
    v_mfma_f32_16x16x32_bf16 v[84:87], v[14:17], v[112:115], v[80:83]
    ds_read_b128 a[136:139], v1 offset:34816
    buffer_load_dwordx4 v3, s[4:7], s64 offen offset:0 lds
    v_mfma_f32_16x16x32_bf16 v[52:55], a[132:135], v[128:131], v[72:75]
    v_exp_f32 v10, v44
    v_fma_f32 v188, v188, v198, v199
    v_mfma_f32_16x16x32_bf16 v[52:55], a[140:143], v[132:135], v[52:55]
    v_cvt_pk_bf16_f32 v117, v12, v13
    v_fma_f32 v189, v189, v198, v199
    v_mfma_f32_16x16x32_bf16 v[52:55], a[148:151], v[136:139], v[52:55]
    v_exp_f32 v11, v45
    v_fma_f32 v190, v190, v198, v199
    v_mfma_f32_16x16x32_bf16 v[52:55], a[156:159], v[140:143], v[52:55]
    ds_read_b128 a[144:147], v1 offset:36864
    v_fma_f32 v191, v191, v198, v199
    v_mfma_f32_16x16x32_bf16 v[60:63], a[132:135], v[144:147], v[76:79]
    v_exp_f32 v12, v46
    v_mfma_f32_16x16x32_bf16 v[60:63], a[140:143], v[148:151], v[60:63]
    v_cvt_pk_bf16_f32 v118, v10, v11
    v_cvt_pk_bf16_f32 v225, v184, v188
    v_cvt_pk_bf16_f32 v229, v185, v189
    v_mfma_f32_16x16x32_bf16 v[60:63], a[148:151], v[152:155], v[60:63]
    v_exp_f32 v13, v47
    v_mfma_f32_16x16x32_bf16 v[60:63], a[156:159], v[156:159], v[60:63]
    ds_read_b128 a[152:155], v1 offset:38912
    v_cvt_pk_bf16_f32 v233, v186, v190
    v_cvt_pk_bf16_f32 v237, v187, v191
    v_mfma_f32_16x16x32_bf16 a[64:67], a[160:163], v[104:107], a[64:67]
    v_exp_f32 v10, v48
    v_mfma_f32_16x16x32_bf16 a[96:99], a[160:163], v[108:111], a[96:99]
    v_cvt_pk_bf16_f32 v119, v12, v13
    v_fma_f32 v208, v208, v200, v201
    v_fma_f32 v209, v209, v200, v201
    v_mfma_f32_16x16x32_bf16 a[68:71], a[164:167], v[104:107], a[68:71]
    v_exp_f32 v11, v49
    v_mfma_f32_16x16x32_bf16 a[100:103], a[164:167], v[108:111], a[100:103]
    ds_read_b128 a[132:135], v1 offset:33792
    v_fma_f32 v210, v210, v200, v201
    v_mfma_f32_16x16x32_bf16 v[84:87], v[18:21], v[116:119], v[84:87]
    ds_read_b128 a[140:143], v1 offset:35840
    v_fma_f32 v211, v211, v200, v201
    v_fma_f32 v212, v212, v202, v203
    v_mfma_f32_16x16x32_bf16 a[72:75], a[168:171], v[104:107], a[72:75]
    v_exp_f32 v12, v50
    v_mfma_f32_16x16x32_bf16 a[104:107], a[168:171], v[108:111], a[104:107]
    buffer_load_dwordx4 v3, s[4:7], s64 offen offset:1024 lds
    v_cvt_pk_bf16_f32 v120, v10, v11
    v_mfma_f32_16x16x32_bf16 a[76:79], a[172:175], v[104:107], a[76:79]
    v_exp_f32 v13, v51
    v_fma_f32 v213, v213, v202, v203
    v_mfma_f32_16x16x32_bf16 a[108:111], a[172:175], v[108:111], a[108:111]
    ds_read_b128 a[148:151], v1 offset:37888
    v_fma_f32 v214, v214, v202, v203
    v_mfma_f32_16x16x32_bf16 a[80:83], a[176:179], v[104:107], a[80:83]
    v_exp_f32 v10, v52
    v_fma_f32 v215, v215, v202, v203
    v_mfma_f32_16x16x32_bf16 a[112:115], a[176:179], v[108:111], a[112:115]
    v_cvt_pk_bf16_f32 v121, v12, v13
    v_cvt_pk_bf16_f32 v226, v208, v212
    v_mfma_f32_16x16x32_bf16 a[84:87], a[180:183], v[104:107], a[84:87]
    v_exp_f32 v11, v53
    v_mfma_f32_16x16x32_bf16 a[116:119], a[180:183], v[108:111], a[116:119]
    ds_read_b128 a[156:159], v1 offset:39936
    v_cmp_nge_f32 vcc, s66, v86
    v_cvt_pk_bf16_f32 v230, v209, v213
    v_mfma_f32_16x16x32_bf16 a[88:91], a[184:187], v[104:107], a[88:91]
    v_exp_f32 v12, v54
    v_mfma_f32_16x16x32_bf16 a[120:123], a[184:187], v[108:111], a[120:123]
    v_cvt_pk_bf16_f32 v122, v10, v11
    v_cvt_pk_bf16_f32 v234, v210, v214
    v_cvt_pk_bf16_f32 v238, v211, v215
    v_mfma_f32_16x16x32_bf16 a[92:95], a[188:191], v[104:107], a[92:95]
    v_exp_f32 v13, v55
    v_mfma_f32_16x16x32_bf16 a[124:127], a[188:191], v[108:111], a[124:127]
    s_waitcnt lgkmcnt(4)
    s_cbranch_vccnz L_tramp16
L_ret16:
    v_mfma_f32_16x16x32_bf16 v[32:35], a[128:131], a[224:227], v[64:67]
    v_exp_f32 v10, v56
    v_mfma_f32_16x16x32_bf16 v[32:35], a[136:139], a[228:231], v[32:35]
    v_cvt_pk_bf16_f32 v123, v12, v13
    v_fma_f32 v216, v216, v204, v205
    v_fma_f32 v217, v217, v204, v205
    v_mfma_f32_16x16x32_bf16 v[32:35], a[144:147], a[232:235], v[32:35]
    v_exp_f32 v11, v57
    v_mfma_f32_16x16x32_bf16 v[32:35], a[152:155], a[236:239], v[32:35]
    ds_read_b128 a[160:163], v1 offset:40960
    v_fma_f32 v218, v218, v204, v205
    v_mfma_f32_16x16x32_bf16 v[40:43], a[128:131], a[240:243], v[68:71]
    v_exp_f32 v12, v58
    v_fma_f32 v219, v219, v204, v205
    v_mfma_f32_16x16x32_bf16 v[40:43], a[136:139], a[244:247], v[40:43]
    v_cvt_pk_bf16_f32 v124, v10, v11
    v_fma_f32 v220, v220, v206, v207
    v_mfma_f32_16x16x32_bf16 v[40:43], a[144:147], a[248:251], v[40:43]
    v_exp_f32 v13, v59
    v_fma_f32 v221, v221, v206, v207
    v_mfma_f32_16x16x32_bf16 v[40:43], a[152:155], a[252:255], v[40:43]
    ds_read_b128 a[164:167], v1 offset:41984
    v_fma_f32 v222, v222, v206, v207
    v_mfma_f32_16x16x32_bf16 v[92:95], v[14:17], v[120:123], v[88:91]
    s_waitcnt lgkmcnt(2)
    buffer_load_dwordx4 v3, s[4:7], s64 offen offset:2048 lds
    v_fma_f32 v223, v223, v206, v207
    v_mfma_f32_16x16x32_bf16 v[36:39], a[132:135], a[224:227], v[64:67]
    v_exp_f32 v10, v60
    v_mfma_f32_16x16x32_bf16 v[36:39], a[140:143], a[228:231], v[36:39]
    v_cvt_pk_bf16_f32 v125, v12, v13
    v_cvt_pk_bf16_f32 v227, v216, v220
    v_cvt_pk_bf16_f32 v231, v217, v221
    v_mfma_f32_16x16x32_bf16 v[36:39], a[148:151], a[232:235], v[36:39]
    v_exp_f32 v11, v61
    v_mfma_f32_16x16x32_bf16 v[36:39], a[156:159], a[236:239], v[36:39]
    ds_read_b128 a[168:171], v1 offset:43008
    v_cvt_pk_bf16_f32 v235, v218, v222
    v_mfma_f32_16x16x32_bf16 v[44:47], a[132:135], a[240:243], v[68:71]
    v_exp_f32 v12, v62
    v_cvt_pk_bf16_f32 v239, v219, v223
    v_mfma_f32_16x16x32_bf16 v[44:47], a[140:143], a[244:247], v[44:47]
    buffer_store_dwordx4 v[224:227], v171, s[4:7], s77 offen offset:0 sc1
    v_cvt_pk_bf16_f32 v126, v10, v11
    v_mfma_f32_16x16x32_bf16 v[44:47], a[148:151], a[248:251], v[44:47]
    v_exp_f32 v13, v63
    v_mfma_f32_16x16x32_bf16 v[44:47], a[156:159], a[252:255], v[44:47]
    ds_read_b128 a[172:175], v1 offset:44032
    v_mfma_f32_16x16x32_bf16 a[0:3], a[192:195], v[112:115], a[0:3]
    v_exp_f32 v10, v32
    v_mfma_f32_16x16x32_bf16 a[32:35], a[192:195], v[116:119], a[32:35]
    buffer_store_dwordx4 v[228:231], v171, s[4:7], s77 offen offset:2048 sc1
    v_cvt_pk_bf16_f32 v127, v12, v13
    v_mfma_f32_16x16x32_bf16 a[4:7], a[196:199], v[112:115], a[4:7]
    v_exp_f32 v11, v33
    v_mfma_f32_16x16x32_bf16 a[36:39], a[196:199], v[116:119], a[36:39]
    ds_read_b128 a[176:179], v1 offset:45056
    v_mfma_f32_16x16x32_bf16 v[92:95], v[18:21], v[124:127], v[92:95]
    ds_read_b128 a[188:191], v1 offset:48128
    v_mfma_f32_16x16x32_bf16 a[8:11], a[200:203], v[112:115], a[8:11]
    v_exp_f32 v12, v34
    v_mfma_f32_16x16x32_bf16 a[40:43], a[200:203], v[116:119], a[40:43]
    buffer_load_dwordx4 v3, s[4:7], s64 offen offset:3072 lds
    v_cvt_pk_bf16_f32 v96, v10, v11
    v_mfma_f32_16x16x32_bf16 a[12:15], a[204:207], v[112:115], a[12:15]
    v_exp_f32 v13, v35
    v_mfma_f32_16x16x32_bf16 a[44:47], a[204:207], v[116:119], a[44:47]
    ds_read_b128 a[180:183], v1 offset:46080
    v_mfma_f32_16x16x32_bf16 a[16:19], a[208:211], v[112:115], a[16:19]
    v_exp_f32 v10, v36
    v_mfma_f32_16x16x32_bf16 a[48:51], a[208:211], v[116:119], a[48:51]
    buffer_store_dwordx4 v[232:235], v171, s[4:7], s72 offen offset:0 sc1
    v_cvt_pk_bf16_f32 v97, v12, v13
    v_mfma_f32_16x16x32_bf16 a[20:23], a[212:215], v[112:115], a[20:23]
    v_exp_f32 v11, v37
    v_mfma_f32_16x16x32_bf16 a[52:55], a[212:215], v[116:119], a[52:55]
    ds_read_b128 a[184:187], v1 offset:47104
    v_cmp_nge_f32 vcc, s66, v94
    v_mfma_f32_16x16x32_bf16 a[24:27], a[216:219], v[112:115], a[24:27]
    v_exp_f32 v12, v38
    v_mfma_f32_16x16x32_bf16 a[56:59], a[216:219], v[116:119], a[56:59]
    buffer_store_dwordx4 v[236:239], v171, s[4:7], s72 offen offset:2048 sc1
    v_cvt_pk_bf16_f32 v98, v10, v11
    v_mfma_f32_16x16x32_bf16 a[28:31], a[220:223], v[112:115], a[28:31]
    s_add_u32 s71, s71, 32768
    v_exp_f32 v13, v39
    v_mfma_f32_16x16x32_bf16 a[60:63], a[220:223], v[116:119], a[60:63]
    s_cbranch_vccnz L_tramp17
L_ret17:
    v_mfma_f32_16x16x32_bf16 v[48:51], a[128:131], v[128:131], v[72:75]
    s_add_u32 s73, s73, 16384
    v_exp_f32 v10, v40
    v_mfma_f32_16x16x32_bf16 v[48:51], a[136:139], v[132:135], v[48:51]
    s_add_u32 s74, s74, 512
    v_cvt_pk_bf16_f32 v99, v12, v13
    v_mfma_f32_16x16x32_bf16 v[48:51], a[144:147], v[136:139], v[48:51]
    s_add_u32 s75, s75, 32768
    v_exp_f32 v11, v41
    v_mfma_f32_16x16x32_bf16 v[48:51], a[152:155], v[140:143], v[48:51]
    s_add_u32 s76, s76, 32768
    v_mfma_f32_16x16x32_bf16 v[56:59], a[128:131], v[144:147], v[76:79]
    s_add_u32 s77, s77, 32768
    v_exp_f32 v12, v42
    v_mfma_f32_16x16x32_bf16 v[56:59], a[136:139], v[148:151], v[56:59]
    s_add_u32 s72, s72, 32768
    v_cvt_pk_bf16_f32 v100, v10, v11
    v_mfma_f32_16x16x32_bf16 v[56:59], a[144:147], v[152:155], v[56:59]
    v_exp_f32 v13, v43
    v_mfma_f32_16x16x32_bf16 v[56:59], a[152:155], v[156:159], v[56:59]
    s_add_u32 m0, s65, 102400
    ds_read_b128 a[128:131], v1 offset:49152
    v_mfma_f32_16x16x32_bf16 v[80:83], v[14:17], v[96:99], v[84:87]
    ds_read_b128 a[136:139], v1 offset:51200
    buffer_load_dwordx4 v9, s[4:7], s64 offen offset:0 lds
    v_mfma_f32_16x16x32_bf16 v[52:55], a[132:135], v[128:131], v[72:75]
    v_exp_f32 v10, v44
    v_mfma_f32_16x16x32_bf16 v[52:55], a[140:143], v[132:135], v[52:55]
    v_cvt_pk_bf16_f32 v101, v12, v13
    v_mfma_f32_16x16x32_bf16 v[52:55], a[148:151], v[136:139], v[52:55]
    v_exp_f32 v11, v45
    v_mfma_f32_16x16x32_bf16 v[52:55], a[156:159], v[140:143], v[52:55]
    ds_read_b128 a[144:147], v1 offset:53248
    v_mfma_f32_16x16x32_bf16 v[60:63], a[132:135], v[144:147], v[76:79]
    v_exp_f32 v12, v46
    v_mfma_f32_16x16x32_bf16 v[60:63], a[140:143], v[148:151], v[60:63]
    v_cvt_pk_bf16_f32 v102, v10, v11
    v_mfma_f32_16x16x32_bf16 v[60:63], a[148:151], v[152:155], v[60:63]
    v_exp_f32 v13, v47
    v_mfma_f32_16x16x32_bf16 v[60:63], a[156:159], v[156:159], v[60:63]
    ds_read_b128 a[152:155], v1 offset:55296
    v_mfma_f32_16x16x32_bf16 a[64:67], a[192:195], v[120:123], a[64:67]
    v_exp_f32 v10, v48
    v_mfma_f32_16x16x32_bf16 a[96:99], a[192:195], v[124:127], a[96:99]
    v_cvt_pk_bf16_f32 v103, v12, v13
    v_mfma_f32_16x16x32_bf16 a[68:71], a[196:199], v[120:123], a[68:71]
    v_exp_f32 v11, v49
    v_mfma_f32_16x16x32_bf16 a[100:103], a[196:199], v[124:127], a[100:103]
    ds_read_b128 a[132:135], v1 offset:50176
    v_mfma_f32_16x16x32_bf16 v[80:83], v[18:21], v[100:103], v[80:83]
    ds_read_b128 a[140:143], v1 offset:52224
    v_mfma_f32_16x16x32_bf16 a[72:75], a[200:203], v[120:123], a[72:75]
    v_exp_f32 v12, v50
    v_mfma_f32_16x16x32_bf16 a[104:107], a[200:203], v[124:127], a[104:107]
    buffer_load_dwordx4 v9, s[4:7], s64 offen offset:1024 lds
    v_cvt_pk_bf16_f32 v104, v10, v11
    v_mfma_f32_16x16x32_bf16 a[76:79], a[204:207], v[120:123], a[76:79]
    v_exp_f32 v13, v51
    v_mfma_f32_16x16x32_bf16 a[108:111], a[204:207], v[124:127], a[108:111]
    ds_read_b128 a[148:151], v1 offset:54272
    v_mfma_f32_16x16x32_bf16 a[80:83], a[208:211], v[120:123], a[80:83]
    v_exp_f32 v10, v52
    v_mfma_f32_16x16x32_bf16 a[112:115], a[208:211], v[124:127], a[112:115]
    v_cvt_pk_bf16_f32 v105, v12, v13
    v_mfma_f32_16x16x32_bf16 a[84:87], a[212:215], v[120:123], a[84:87]
    v_exp_f32 v11, v53
    v_mfma_f32_16x16x32_bf16 a[116:119], a[212:215], v[124:127], a[116:119]
    ds_read_b128 a[156:159], v1 offset:56320
    v_cmp_nge_f32 vcc, s66, v82
    v_mfma_f32_16x16x32_bf16 a[88:91], a[216:219], v[120:123], a[88:91]
    v_exp_f32 v12, v54
    v_mfma_f32_16x16x32_bf16 a[120:123], a[216:219], v[124:127], a[120:123]
    v_cvt_pk_bf16_f32 v106, v10, v11
    v_mfma_f32_16x16x32_bf16 a[92:95], a[220:223], v[120:123], a[92:95]
    v_exp_f32 v13, v55
    v_mfma_f32_16x16x32_bf16 a[124:127], a[220:223], v[124:127], a[124:127]
    s_waitcnt lgkmcnt(4)
    s_cbranch_vccnz L_tramp18
L_ret18:
    v_mfma_f32_16x16x32_bf16 v[32:35], a[128:131], a[224:227], v[64:67]
    v_exp_f32 v10, v56
    v_mfma_f32_16x16x32_bf16 v[32:35], a[136:139], a[228:231], v[32:35]
    v_cvt_pk_bf16_f32 v107, v12, v13
    v_mfma_f32_16x16x32_bf16 v[32:35], a[144:147], a[232:235], v[32:35]
    v_exp_f32 v11, v57
    v_mfma_f32_16x16x32_bf16 v[32:35], a[152:155], a[236:239], v[32:35]
    ds_read_b128 a[192:195], v1 offset:57344
    v_mfma_f32_16x16x32_bf16 v[40:43], a[128:131], a[240:243], v[68:71]
    v_exp_f32 v12, v58
    v_mfma_f32_16x16x32_bf16 v[40:43], a[136:139], a[244:247], v[40:43]
    v_cvt_pk_bf16_f32 v108, v10, v11
    v_mfma_f32_16x16x32_bf16 v[40:43], a[144:147], a[248:251], v[40:43]
    v_exp_f32 v13, v59
    v_mfma_f32_16x16x32_bf16 v[40:43], a[152:155], a[252:255], v[40:43]
    ds_read_b128 a[196:199], v1 offset:58368
    v_mfma_f32_16x16x32_bf16 v[88:91], v[14:17], v[104:107], v[92:95]
    s_waitcnt lgkmcnt(2)
    buffer_load_dwordx4 v9, s[4:7], s64 offen offset:2048 lds
    v_mfma_f32_16x16x32_bf16 v[36:39], a[132:135], a[224:227], v[64:67]
    v_exp_f32 v10, v60
    v_mfma_f32_16x16x32_bf16 v[36:39], a[140:143], a[228:231], v[36:39]
    v_cvt_pk_bf16_f32 v109, v12, v13
    v_mfma_f32_16x16x32_bf16 v[36:39], a[148:151], a[232:235], v[36:39]
    v_exp_f32 v11, v61
    v_mfma_f32_16x16x32_bf16 v[36:39], a[156:159], a[236:239], v[36:39]
    ds_read_b128 a[200:203], v1 offset:59392
    v_mfma_f32_16x16x32_bf16 v[44:47], a[132:135], a[240:243], v[68:71]
    v_exp_f32 v12, v62
    v_mfma_f32_16x16x32_bf16 v[44:47], a[140:143], a[244:247], v[44:47]
    v_cvt_pk_bf16_f32 v110, v10, v11
    v_mfma_f32_16x16x32_bf16 v[44:47], a[148:151], a[248:251], v[44:47]
    v_exp_f32 v13, v63
    v_mfma_f32_16x16x32_bf16 v[44:47], a[156:159], a[252:255], v[44:47]
    ds_read_b128 a[204:207], v1 offset:60416
    v_mfma_f32_16x16x32_bf16 a[0:3], a[160:163], v[96:99], a[0:3]
    v_exp_f32 v10, v32
    v_mfma_f32_16x16x32_bf16 a[32:35], a[160:163], v[100:103], a[32:35]
    v_cvt_pk_bf16_f32 v111, v12, v13
    v_mfma_f32_16x16x32_bf16 a[4:7], a[164:167], v[96:99], a[4:7]
    v_exp_f32 v11, v33
    v_mfma_f32_16x16x32_bf16 a[36:39], a[164:167], v[100:103], a[36:39]
    ds_read_b128 a[208:211], v1 offset:61440
    v_mfma_f32_16x16x32_bf16 v[88:91], v[18:21], v[108:111], v[88:91]
    ds_read_b128 a[220:223], v1 offset:64512
    v_mfma_f32_16x16x32_bf16 a[8:11], a[168:171], v[96:99], a[8:11]
    v_exp_f32 v12, v34
    v_mfma_f32_16x16x32_bf16 a[40:43], a[168:171], v[100:103], a[40:43]
    buffer_load_dwordx4 v9, s[4:7], s64 offen offset:3072 lds
    v_cvt_pk_bf16_f32 v112, v10, v11
    v_mfma_f32_16x16x32_bf16 a[12:15], a[172:175], v[96:99], a[12:15]
    v_exp_f32 v13, v35
    v_mfma_f32_16x16x32_bf16 a[44:47], a[172:175], v[100:103], a[44:47]
    ds_read_b128 a[212:215], v1 offset:62464
    v_mfma_f32_16x16x32_bf16 a[16:19], a[176:179], v[96:99], a[16:19]
    v_exp_f32 v10, v36
    v_mfma_f32_16x16x32_bf16 a[48:51], a[176:179], v[100:103], a[48:51]
    v_cvt_pk_bf16_f32 v113, v12, v13
    v_mfma_f32_16x16x32_bf16 a[20:23], a[180:183], v[96:99], a[20:23]
    v_exp_f32 v11, v37
    v_mfma_f32_16x16x32_bf16 a[52:55], a[180:183], v[100:103], a[52:55]
    ds_read_b128 a[216:219], v1 offset:63488
    v_cmp_nge_f32 vcc, s66, v90
    v_mfma_f32_16x16x32_bf16 a[24:27], a[184:187], v[96:99], a[24:27]
    v_exp_f32 v12, v38
    v_mfma_f32_16x16x32_bf16 a[56:59], a[184:187], v[100:103], a[56:59]
    v_cvt_pk_bf16_f32 v114, v10, v11
    v_mfma_f32_16x16x32_bf16 a[28:31], a[188:191], v[96:99], a[28:31]
    v_exp_f32 v13, v39
    v_mfma_f32_16x16x32_bf16 a[60:63], a[188:191], v[100:103], a[60:63]
    s_cbranch_vccnz L_tramp19
L_ret19:
    v_mfma_f32_16x16x32_bf16 v[48:51], a[128:131], v[128:131], v[72:75]
    s_waitcnt vmcnt(12)
    s_waitcnt vmcnt(4)
    v_exp_f32 v10, v40
    v_mfma_f32_16x16x32_bf16 v[48:51], a[136:139], v[132:135], v[48:51]
    s_barrier
    v_cvt_pk_bf16_f32 v115, v12, v13
    v_mfma_f32_16x16x32_bf16 v[48:51], a[144:147], v[136:139], v[48:51]
    v_exp_f32 v11, v41
    v_mfma_f32_16x16x32_bf16 v[48:51], a[152:155], v[140:143], v[48:51]
    v_mfma_f32_16x16x32_bf16 v[56:59], a[128:131], v[144:147], v[76:79]
    v_exp_f32 v12, v42
    v_mfma_f32_16x16x32_bf16 v[56:59], a[136:139], v[148:151], v[56:59]
    v_cvt_pk_bf16_f32 v116, v10, v11
    s_cmp_lg_u32 s62, 0
    s_cbranch_scc1 L_pub3
    s_lshl_b32 s80, s61, 3
    v_mov_b32 v248, s80
    s_mov_b64 exec, 1
    buffer_store_dwordx2 v[6:7], v248, s[8:11], s85 offen sc1
    s_mov_b64 exec, -1
L_pub3:
    s_add_u32 s85, s85, 128
    v_mfma_f32_16x16x32_bf16 v[56:59], a[144:147], v[152:155], v[56:59]
    s_add_u32 s64, s44, s70
    v_exp_f32 v13, v43
    v_mfma_f32_16x16x32_bf16 v[56:59], a[152:155], v[156:159], v[56:59]
    s_add_u32 m0, s65, 0
    ds_read_b128 a[128:131], v2 offset:0
    v_mfma_f32_16x16x32_bf16 v[84:87], v[14:17], v[112:115], v[80:83]
    ds_read_b128 a[136:139], v2 offset:2048
    buffer_load_dwordx4 v3, s[4:7], s64 offen offset:0 lds
    v_mfma_f32_16x16x32_bf16 v[52:55], a[132:135], v[128:131], v[72:75]
    v_exp_f32 v10, v44
    v_mfma_f32_16x16x32_bf16 v[52:55], a[140:143], v[132:135], v[52:55]
    v_cvt_pk_bf16_f32 v117, v12, v13
    v_mfma_f32_16x16x32_bf16 v[52:55], a[148:151], v[136:139], v[52:55]
    v_exp_f32 v11, v45
    v_mfma_f32_16x16x32_bf16 v[52:55], a[156:159], v[140:143], v[52:55]
    ds_read_b128 a[144:147], v2 offset:4096
    v_mfma_f32_16x16x32_bf16 v[60:63], a[132:135], v[144:147], v[76:79]
    v_exp_f32 v12, v46
    v_mfma_f32_16x16x32_bf16 v[60:63], a[140:143], v[148:151], v[60:63]
    v_cvt_pk_bf16_f32 v118, v10, v11
    v_mfma_f32_16x16x32_bf16 v[60:63], a[148:151], v[152:155], v[60:63]
    v_exp_f32 v13, v47
    v_mfma_f32_16x16x32_bf16 v[60:63], a[156:159], v[156:159], v[60:63]
    ds_read_b128 a[152:155], v2 offset:6144
    v_mfma_f32_16x16x32_bf16 a[64:67], a[160:163], v[104:107], a[64:67]
    v_exp_f32 v10, v48
    v_mfma_f32_16x16x32_bf16 a[96:99], a[160:163], v[108:111], a[96:99]
    v_cvt_pk_bf16_f32 v119, v12, v13
    v_mfma_f32_16x16x32_bf16 a[68:71], a[164:167], v[104:107], a[68:71]
    v_exp_f32 v11, v49
    v_mfma_f32_16x16x32_bf16 a[100:103], a[164:167], v[108:111], a[100:103]
    ds_read_b128 a[132:135], v2 offset:1024
    v_mfma_f32_16x16x32_bf16 v[84:87], v[18:21], v[116:119], v[84:87]
    ds_read_b128 a[140:143], v2 offset:3072
    v_mfma_f32_16x16x32_bf16 a[72:75], a[168:171], v[104:107], a[72:75]
    v_exp_f32 v12, v50
    v_mfma_f32_16x16x32_bf16 a[104:107], a[168:171], v[108:111], a[104:107]
    buffer_load_dwordx4 v3, s[4:7], s64 offen offset:1024 lds
    v_cvt_pk_bf16_f32 v120, v10, v11
    v_mfma_f32_16x16x32_bf16 a[76:79], a[172:175], v[104:107], a[76:79]
    v_exp_f32 v13, v51
    v_mfma_f32_16x16x32_bf16 a[108:111], a[172:175], v[108:111], a[108:111]
    ds_read_b128 a[148:151], v2 offset:5120
    v_mfma_f32_16x16x32_bf16 a[80:83], a[176:179], v[104:107], a[80:83]
    v_exp_f32 v10, v52
    v_mfma_f32_16x16x32_bf16 a[112:115], a[176:179], v[108:111], a[112:115]
    v_cvt_pk_bf16_f32 v121, v12, v13
    v_mfma_f32_16x16x32_bf16 a[84:87], a[180:183], v[104:107], a[84:87]
    v_exp_f32 v11, v53
    v_mfma_f32_16x16x32_bf16 a[116:119], a[180:183], v[108:111], a[116:119]
    ds_read_b128 a[156:159], v2 offset:7168
    v_cmp_nge_f32 vcc, s66, v86
    v_mfma_f32_16x16x32_bf16 a[88:91], a[184:187], v[104:107], a[88:91]
    v_exp_f32 v12, v54
    v_mfma_f32_16x16x32_bf16 a[120:123], a[184:187], v[108:111], a[120:123]
    v_cvt_pk_bf16_f32 v122, v10, v11
    v_mfma_f32_16x16x32_bf16 a[92:95], a[188:191], v[104:107], a[92:95]
    v_exp_f32 v13, v55
    v_mfma_f32_16x16x32_bf16 a[124:127], a[188:191], v[108:111], a[124:127]
    s_waitcnt lgkmcnt(4)
    s_cbranch_vccnz L_tramp20
L_ret20:
    v_mfma_f32_16x16x32_bf16 v[32:35], a[128:131], a[224:227], v[64:67]
    v_exp_f32 v10, v56
    v_mfma_f32_16x16x32_bf16 v[32:35], a[136:139], a[228:231], v[32:35]
    v_cvt_pk_bf16_f32 v123, v12, v13
    v_mfma_f32_16x16x32_bf16 v[32:35], a[144:147], a[232:235], v[32:35]
    v_exp_f32 v11, v57
    v_mfma_f32_16x16x32_bf16 v[32:35], a[152:155], a[236:239], v[32:35]
    ds_read_b128 a[160:163], v2 offset:8192
    v_mfma_f32_16x16x32_bf16 v[40:43], a[128:131], a[240:243], v[68:71]
    v_exp_f32 v12, v58
    v_mfma_f32_16x16x32_bf16 v[40:43], a[136:139], a[244:247], v[40:43]
    v_cvt_pk_bf16_f32 v124, v10, v11
    v_mfma_f32_16x16x32_bf16 v[40:43], a[144:147], a[248:251], v[40:43]
    v_exp_f32 v13, v59
    v_mfma_f32_16x16x32_bf16 v[40:43], a[152:155], a[252:255], v[40:43]
    ds_read_b128 a[164:167], v2 offset:9216
    v_mfma_f32_16x16x32_bf16 v[92:95], v[14:17], v[120:123], v[88:91]
    s_waitcnt lgkmcnt(2)
    buffer_load_dwordx4 v3, s[4:7], s64 offen offset:2048 lds
    v_mfma_f32_16x16x32_bf16 v[36:39], a[132:135], a[224:227], v[64:67]
    v_exp_f32 v10, v60
    v_mfma_f32_16x16x32_bf16 v[36:39], a[140:143], a[228:231], v[36:39]
    v_cvt_pk_bf16_f32 v125, v12, v13
    v_mfma_f32_16x16x32_bf16 v[36:39], a[148:151], a[232:235], v[36:39]
    v_exp_f32 v11, v61
    v_mfma_f32_16x16x32_bf16 v[36:39], a[156:159], a[236:239], v[36:39]
    ds_read_b128 a[168:171], v2 offset:10240
    v_mfma_f32_16x16x32_bf16 v[44:47], a[132:135], a[240:243], v[68:71]
    v_exp_f32 v12, v62
    v_mfma_f32_16x16x32_bf16 v[44:47], a[140:143], a[244:247], v[44:47]
    v_cvt_pk_bf16_f32 v126, v10, v11
    v_mfma_f32_16x16x32_bf16 v[44:47], a[148:151], a[248:251], v[44:47]
    v_exp_f32 v13, v63
    v_mfma_f32_16x16x32_bf16 v[44:47], a[156:159], a[252:255], v[44:47]
    ds_read_b128 a[172:175], v2 offset:11264
    v_mfma_f32_16x16x32_bf16 a[0:3], a[192:195], v[112:115], a[0:3]
    v_exp_f32 v10, v32
    v_mfma_f32_16x16x32_bf16 a[32:35], a[192:195], v[116:119], a[32:35]
    v_cvt_pk_bf16_f32 v127, v12, v13
    v_mfma_f32_16x16x32_bf16 a[4:7], a[196:199], v[112:115], a[4:7]
    v_exp_f32 v11, v33
    v_mfma_f32_16x16x32_bf16 a[36:39], a[196:199], v[116:119], a[36:39]
    ds_read_b128 a[176:179], v2 offset:12288
    v_mfma_f32_16x16x32_bf16 v[92:95], v[18:21], v[124:127], v[92:95]
    ds_read_b128 a[188:191], v2 offset:15360
    v_mfma_f32_16x16x32_bf16 a[8:11], a[200:203], v[112:115], a[8:11]
    v_exp_f32 v12, v34
    v_mfma_f32_16x16x32_bf16 a[40:43], a[200:203], v[116:119], a[40:43]
    buffer_load_dwordx4 v3, s[4:7], s64 offen offset:3072 lds
    v_cvt_pk_bf16_f32 v96, v10, v11
    v_mfma_f32_16x16x32_bf16 a[12:15], a[204:207], v[112:115], a[12:15]
    v_exp_f32 v13, v35
    v_mfma_f32_16x16x32_bf16 a[44:47], a[204:207], v[116:119], a[44:47]
    ds_read_b128 a[180:183], v2 offset:13312
    v_mfma_f32_16x16x32_bf16 a[16:19], a[208:211], v[112:115], a[16:19]
    v_exp_f32 v10, v36
    v_mfma_f32_16x16x32_bf16 a[48:51], a[208:211], v[116:119], a[48:51]
    v_cvt_pk_bf16_f32 v97, v12, v13
    v_mfma_f32_16x16x32_bf16 a[20:23], a[212:215], v[112:115], a[20:23]
    v_exp_f32 v11, v37
    v_mfma_f32_16x16x32_bf16 a[52:55], a[212:215], v[116:119], a[52:55]
    ds_read_b128 a[184:187], v2 offset:14336
    v_cmp_nge_f32 vcc, s66, v94
    v_mfma_f32_16x16x32_bf16 a[24:27], a[216:219], v[112:115], a[24:27]
    v_exp_f32 v12, v38
    v_mfma_f32_16x16x32_bf16 a[56:59], a[216:219], v[116:119], a[56:59]
    v_cvt_pk_bf16_f32 v98, v10, v11
    v_mfma_f32_16x16x32_bf16 a[28:31], a[220:223], v[112:115], a[28:31]
    v_exp_f32 v13, v39
    v_mfma_f32_16x16x32_bf16 a[60:63], a[220:223], v[116:119], a[60:63]
    s_cbranch_vccnz L_tramp21
L_ret21:
    v_mfma_f32_16x16x32_bf16 v[48:51], a[128:131], v[128:131], v[72:75]
    v_exp_f32 v10, v40
    v_mfma_f32_16x16x32_bf16 v[48:51], a[136:139], v[132:135], v[48:51]
    v_cvt_pk_bf16_f32 v99, v12, v13
    v_mfma_f32_16x16x32_bf16 v[48:51], a[144:147], v[136:139], v[48:51]
    v_exp_f32 v11, v41
    v_mfma_f32_16x16x32_bf16 v[48:51], a[152:155], v[140:143], v[48:51]
    v_mfma_f32_16x16x32_bf16 v[56:59], a[128:131], v[144:147], v[76:79]
    v_exp_f32 v12, v42
    v_mfma_f32_16x16x32_bf16 v[56:59], a[136:139], v[148:151], v[56:59]
    v_cvt_pk_bf16_f32 v100, v10, v11
    v_mfma_f32_16x16x32_bf16 v[56:59], a[144:147], v[152:155], v[56:59]
    v_exp_f32 v13, v43
    v_mfma_f32_16x16x32_bf16 v[56:59], a[152:155], v[156:159], v[56:59]
    s_add_u32 m0, s65, 4096
    ds_read_b128 a[128:131], v2 offset:16384
    v_mfma_f32_16x16x32_bf16 v[80:83], v[14:17], v[96:99], v[84:87]
    ds_read_b128 a[136:139], v2 offset:18432
    buffer_load_dwordx4 v9, s[4:7], s64 offen offset:0 lds
    v_mfma_f32_16x16x32_bf16 v[52:55], a[132:135], v[128:131], v[72:75]
    v_exp_f32 v10, v44
    v_mfma_f32_16x16x32_bf16 v[52:55], a[140:143], v[132:135], v[52:55]
    v_cvt_pk_bf16_f32 v101, v12, v13
    v_mfma_f32_16x16x32_bf16 v[52:55], a[148:151], v[136:139], v[52:55]
    v_exp_f32 v11, v45
    v_mfma_f32_16x16x32_bf16 v[52:55], a[156:159], v[140:143], v[52:55]
    ds_read_b128 a[144:147], v2 offset:20480
    v_mfma_f32_16x16x32_bf16 v[60:63], a[132:135], v[144:147], v[76:79]
    v_exp_f32 v12, v46
    v_mfma_f32_16x16x32_bf16 v[60:63], a[140:143], v[148:151], v[60:63]
    v_cvt_pk_bf16_f32 v102, v10, v11
    v_mfma_f32_16x16x32_bf16 v[60:63], a[148:151], v[152:155], v[60:63]
    v_exp_f32 v13, v47
    v_mfma_f32_16x16x32_bf16 v[60:63], a[156:159], v[156:159], v[60:63]
    ds_read_b128 a[152:155], v2 offset:22528
    v_mfma_f32_16x16x32_bf16 a[64:67], a[192:195], v[120:123], a[64:67]
    v_exp_f32 v10, v48
    v_mfma_f32_16x16x32_bf16 a[96:99], a[192:195], v[124:127], a[96:99]
    v_cvt_pk_bf16_f32 v103, v12, v13
    v_mfma_f32_16x16x32_bf16 a[68:71], a[196:199], v[120:123], a[68:71]
    v_exp_f32 v11, v49
    v_mfma_f32_16x16x32_bf16 a[100:103], a[196:199], v[124:127], a[100:103]
    ds_read_b128 a[132:135], v2 offset:17408
    v_mfma_f32_16x16x32_bf16 v[80:83], v[18:21], v[100:103], v[80:83]
    ds_read_b128 a[140:143], v2 offset:19456
    v_mfma_f32_16x16x32_bf16 a[72:75], a[200:203], v[120:123], a[72:75]
    v_exp_f32 v12, v50
    v_mfma_f32_16x16x32_bf16 a[104:107], a[200:203], v[124:127], a[104:107]
    buffer_load_dwordx4 v9, s[4:7], s64 offen offset:1024 lds
    v_cvt_pk_bf16_f32 v104, v10, v11
    v_mfma_f32_16x16x32_bf16 a[76:79], a[204:207], v[120:123], a[76:79]
    v_exp_f32 v13, v51
    v_mfma_f32_16x16x32_bf16 a[108:111], a[204:207], v[124:127], a[108:111]
    ds_read_b128 a[148:151], v2 offset:21504
    v_mfma_f32_16x16x32_bf16 a[80:83], a[208:211], v[120:123], a[80:83]
    v_exp_f32 v10, v52
    v_mfma_f32_16x16x32_bf16 a[112:115], a[208:211], v[124:127], a[112:115]
    v_cvt_pk_bf16_f32 v105, v12, v13
    v_mfma_f32_16x16x32_bf16 a[84:87], a[212:215], v[120:123], a[84:87]
    v_exp_f32 v11, v53
    v_mfma_f32_16x16x32_bf16 a[116:119], a[212:215], v[124:127], a[116:119]
    ds_read_b128 a[156:159], v2 offset:23552
    v_cmp_nge_f32 vcc, s66, v82
    v_mfma_f32_16x16x32_bf16 a[88:91], a[216:219], v[120:123], a[88:91]
    v_exp_f32 v12, v54
    v_mfma_f32_16x16x32_bf16 a[120:123], a[216:219], v[124:127], a[120:123]
    v_cvt_pk_bf16_f32 v106, v10, v11
    v_mfma_f32_16x16x32_bf16 a[92:95], a[220:223], v[120:123], a[92:95]
    v_exp_f32 v13, v55
    v_mfma_f32_16x16x32_bf16 a[124:127], a[220:223], v[124:127], a[124:127]
    s_waitcnt lgkmcnt(4)
    s_cbranch_vccnz L_tramp22
L_ret22:
    v_mfma_f32_16x16x32_bf16 v[32:35], a[128:131], a[224:227], v[64:67]
    v_exp_f32 v10, v56
    v_mfma_f32_16x16x32_bf16 v[32:35], a[136:139], a[228:231], v[32:35]
    v_cvt_pk_bf16_f32 v107, v12, v13
    v_mfma_f32_16x16x32_bf16 v[32:35], a[144:147], a[232:235], v[32:35]
    v_exp_f32 v11, v57
    v_mfma_f32_16x16x32_bf16 v[32:35], a[152:155], a[236:239], v[32:35]
    ds_read_b128 a[192:195], v2 offset:24576
    v_mfma_f32_16x16x32_bf16 v[40:43], a[128:131], a[240:243], v[68:71]
    v_exp_f32 v12, v58
    v_mfma_f32_16x16x32_bf16 v[40:43], a[136:139], a[244:247], v[40:43]
    v_cvt_pk_bf16_f32 v108, v10, v11
    v_mfma_f32_16x16x32_bf16 v[40:43], a[144:147], a[248:251], v[40:43]
    v_exp_f32 v13, v59
    v_mfma_f32_16x16x32_bf16 v[40:43], a[152:155], a[252:255], v[40:43]
    ds_read_b128 a[196:199], v2 offset:25600
    v_mfma_f32_16x16x32_bf16 v[88:91], v[14:17], v[104:107], v[92:95]
    s_waitcnt lgkmcnt(2)
    buffer_load_dwordx4 v9, s[4:7], s64 offen offset:2048 lds
    v_mfma_f32_16x16x32_bf16 v[36:39], a[132:135], a[224:227], v[64:67]
    v_exp_f32 v10, v60
    v_mfma_f32_16x16x32_bf16 v[36:39], a[140:143], a[228:231], v[36:39]
    v_cvt_pk_bf16_f32 v109, v12, v13
    v_mfma_f32_16x16x32_bf16 v[36:39], a[148:151], a[232:235], v[36:39]
    v_exp_f32 v11, v61
    v_mfma_f32_16x16x32_bf16 v[36:39], a[156:159], a[236:239], v[36:39]
    ds_read_b128 a[200:203], v2 offset:26624
    v_mfma_f32_16x16x32_bf16 v[44:47], a[132:135], a[240:243], v[68:71]
    v_exp_f32 v12, v62
    v_mfma_f32_16x16x32_bf16 v[44:47], a[140:143], a[244:247], v[44:47]
    v_cvt_pk_bf16_f32 v110, v10, v11
    v_mfma_f32_16x16x32_bf16 v[44:47], a[148:151], a[248:251], v[44:47]
    v_exp_f32 v13, v63
    v_mfma_f32_16x16x32_bf16 v[44:47], a[156:159], a[252:255], v[44:47]
    ds_read_b128 a[204:207], v2 offset:27648
    v_mfma_f32_16x16x32_bf16 a[0:3], a[160:163], v[96:99], a[0:3]
    v_exp_f32 v10, v32
    v_mfma_f32_16x16x32_bf16 a[32:35], a[160:163], v[100:103], a[32:35]
    v_cvt_pk_bf16_f32 v111, v12, v13
    v_mfma_f32_16x16x32_bf16 a[4:7], a[164:167], v[96:99], a[4:7]
    v_exp_f32 v11, v33
    v_mfma_f32_16x16x32_bf16 a[36:39], a[164:167], v[100:103], a[36:39]
    ds_read_b128 a[208:211], v2 offset:28672
    v_mfma_f32_16x16x32_bf16 v[88:91], v[18:21], v[108:111], v[88:91]
    ds_read_b128 a[220:223], v2 offset:31744
    v_mfma_f32_16x16x32_bf16 a[8:11], a[168:171], v[96:99], a[8:11]
    v_exp_f32 v12, v34
    v_mfma_f32_16x16x32_bf16 a[40:43], a[168:171], v[100:103], a[40:43]
    buffer_load_dwordx4 v9, s[4:7], s64 offen offset:3072 lds
    v_cvt_pk_bf16_f32 v112, v10, v11
    v_mfma_f32_16x16x32_bf16 a[12:15], a[172:175], v[96:99], a[12:15]
    v_exp_f32 v13, v35
    v_mfma_f32_16x16x32_bf16 a[44:47], a[172:175], v[100:103], a[44:47]
    ds_read_b128 a[212:215], v2 offset:29696
    v_mfma_f32_16x16x32_bf16 a[16:19], a[176:179], v[96:99], a[16:19]
    v_exp_f32 v10, v36
    v_mfma_f32_16x16x32_bf16 a[48:51], a[176:179], v[100:103], a[48:51]
    v_cvt_pk_bf16_f32 v113, v12, v13
    v_mfma_f32_16x16x32_bf16 a[20:23], a[180:183], v[96:99], a[20:23]
    v_exp_f32 v11, v37
    v_mfma_f32_16x16x32_bf16 a[52:55], a[180:183], v[100:103], a[52:55]
    ds_read_b128 a[216:219], v2 offset:30720
    v_cmp_nge_f32 vcc, s66, v90
    v_mfma_f32_16x16x32_bf16 a[24:27], a[184:187], v[96:99], a[24:27]
    v_exp_f32 v12, v38
    v_mfma_f32_16x16x32_bf16 a[56:59], a[184:187], v[100:103], a[56:59]
    v_cvt_pk_bf16_f32 v114, v10, v11
    v_mfma_f32_16x16x32_bf16 a[28:31], a[188:191], v[96:99], a[28:31]
    v_exp_f32 v13, v39
    v_mfma_f32_16x16x32_bf16 a[60:63], a[188:191], v[100:103], a[60:63]
    s_cbranch_vccnz L_tramp23
L_ret23:
    v_mfma_f32_16x16x32_bf16 v[48:51], a[128:131], v[128:131], v[72:75]
    s_waitcnt vmcnt(8)
    v_exp_f32 v10, v40
    v_mfma_f32_16x16x32_bf16 v[48:51], a[136:139], v[132:135], v[48:51]
    s_barrier
    v_cvt_pk_bf16_f32 v115, v12, v13
    v_mfma_f32_16x16x32_bf16 v[48:51], a[144:147], v[136:139], v[48:51]
    s_add_u32 s88, s88, 128
    v_exp_f32 v11, v41
    v_mfma_f32_16x16x32_bf16 v[48:51], a[152:155], v[140:143], v[48:51]
    v_mfma_f32_16x16x32_bf16 v[56:59], a[128:131], v[144:147], v[76:79]
    v_exp_f32 v12, v42
    v_mfma_f32_16x16x32_bf16 v[56:59], a[136:139], v[148:151], v[56:59]
    v_cvt_pk_bf16_f32 v116, v10, v11
    v_mfma_f32_16x16x32_bf16 v[56:59], a[144:147], v[152:155], v[56:59]
    v_exp_f32 v13, v43
    v_mfma_f32_16x16x32_bf16 v[56:59], a[152:155], v[156:159], v[56:59]
    ds_read_b128 a[128:131], v2 offset:32768
    v_mfma_f32_16x16x32_bf16 v[84:87], v[14:17], v[112:115], v[80:83]
    ds_read_b128 a[136:139], v2 offset:34816
    buffer_load_dwordx2 v[4:5], v8, s[8:11], s88 offen sc1
    v_mfma_f32_16x16x32_bf16 v[52:55], a[132:135], v[128:131], v[72:75]
    v_exp_f32 v10, v44
    v_mfma_f32_16x16x32_bf16 v[52:55], a[140:143], v[132:135], v[52:55]
    v_cvt_pk_bf16_f32 v117, v12, v13
    v_mfma_f32_16x16x32_bf16 v[52:55], a[148:151], v[136:139], v[52:55]
    v_exp_f32 v11, v45
    v_mfma_f32_16x16x32_bf16 v[52:55], a[156:159], v[140:143], v[52:55]
    ds_read_b128 a[144:147], v2 offset:36864
    v_mfma_f32_16x16x32_bf16 v[60:63], a[132:135], v[144:147], v[76:79]
    v_exp_f32 v12, v46
    v_mfma_f32_16x16x32_bf16 v[60:63], a[140:143], v[148:151], v[60:63]
    v_cvt_pk_bf16_f32 v118, v10, v11
    v_mfma_f32_16x16x32_bf16 v[60:63], a[148:151], v[152:155], v[60:63]
    v_exp_f32 v13, v47
    v_mfma_f32_16x16x32_bf16 v[60:63], a[156:159], v[156:159], v[60:63]
    ds_read_b128 a[152:155], v2 offset:38912
    v_mfma_f32_16x16x32_bf16 a[64:67], a[160:163], v[104:107], a[64:67]
    v_exp_f32 v10, v48
    v_mfma_f32_16x16x32_bf16 a[96:99], a[160:163], v[108:111], a[96:99]
    v_cvt_pk_bf16_f32 v119, v12, v13
    v_mfma_f32_16x16x32_bf16 a[68:71], a[164:167], v[104:107], a[68:71]
    v_exp_f32 v11, v49
    v_mfma_f32_16x16x32_bf16 a[100:103], a[164:167], v[108:111], a[100:103]
    ds_read_b128 a[132:135], v2 offset:33792
    v_mfma_f32_16x16x32_bf16 v[84:87], v[18:21], v[116:119], v[84:87]
    ds_read_b128 a[140:143], v2 offset:35840
    v_mfma_f32_16x16x32_bf16 a[72:75], a[168:171], v[104:107], a[72:75]
    v_exp_f32 v12, v50
    v_mfma_f32_16x16x32_bf16 a[104:107], a[168:171], v[108:111], a[104:107]
    v_cvt_pk_bf16_f32 v120, v10, v11
    v_mfma_f32_16x16x32_bf16 a[76:79], a[172:175], v[104:107], a[76:79]
    v_exp_f32 v13, v51
    v_mfma_f32_16x16x32_bf16 a[108:111], a[172:175], v[108:111], a[108:111]
    ds_read_b128 a[148:151], v2 offset:37888
    v_mfma_f32_16x16x32_bf16 a[80:83], a[176:179], v[104:107], a[80:83]
    v_exp_f32 v10, v52
    v_mfma_f32_16x16x32_bf16 a[112:115], a[176:179], v[108:111], a[112:115]
    v_cvt_pk_bf16_f32 v121, v12, v13
    v_mfma_f32_16x16x32_bf16 a[84:87], a[180:183], v[104:107], a[84:87]
    v_exp_f32 v11, v53
    v_mfma_f32_16x16x32_bf16 a[116:119], a[180:183], v[108:111], a[116:119]
    ds_read_b128 a[156:159], v2 offset:39936
    v_cmp_nge_f32 vcc, s66, v86
    v_mfma_f32_16x16x32_bf16 a[88:91], a[184:187], v[104:107], a[88:91]
    v_exp_f32 v12, v54
    v_mfma_f32_16x16x32_bf16 a[120:123], a[184:187], v[108:111], a[120:123]
    v_cvt_pk_bf16_f32 v122, v10, v11
    v_mfma_f32_16x16x32_bf16 a[92:95], a[188:191], v[104:107], a[92:95]
    v_exp_f32 v13, v55
    v_mfma_f32_16x16x32_bf16 a[124:127], a[188:191], v[108:111], a[124:127]
    s_waitcnt lgkmcnt(4)
    s_cbranch_vccnz L_tramp24
L_ret24:
    v_mfma_f32_16x16x32_bf16 v[32:35], a[128:131], a[224:227], v[64:67]
    v_exp_f32 v10, v56
    v_mfma_f32_16x16x32_bf16 v[32:35], a[136:139], a[228:231], v[32:35]
    v_cvt_pk_bf16_f32 v123, v12, v13
    v_mfma_f32_16x16x32_bf16 v[32:35], a[144:147], a[232:235], v[32:35]
    v_exp_f32 v11, v57
    v_mfma_f32_16x16x32_bf16 v[32:35], a[152:155], a[236:239], v[32:35]
    ds_read_b128 a[160:163], v2 offset:40960
    v_mfma_f32_16x16x32_bf16 v[40:43], a[128:131], a[240:243], v[68:71]
    v_exp_f32 v12, v58
    v_mfma_f32_16x16x32_bf16 v[40:43], a[136:139], a[244:247], v[40:43]
    v_cvt_pk_bf16_f32 v124, v10, v11
    v_mfma_f32_16x16x32_bf16 v[40:43], a[144:147], a[248:251], v[40:43]
    v_exp_f32 v13, v59
    v_mfma_f32_16x16x32_bf16 v[40:43], a[152:155], a[252:255], v[40:43]
    ds_read_b128 a[164:167], v2 offset:41984
    v_mfma_f32_16x16x32_bf16 v[92:95], v[14:17], v[120:123], v[88:91]
    s_waitcnt lgkmcnt(2)
    v_mfma_f32_16x16x32_bf16 v[36:39], a[132:135], a[224:227], v[64:67]
    v_exp_f32 v10, v60
    v_mfma_f32_16x16x32_bf16 v[36:39], a[140:143], a[228:231], v[36:39]
    v_cvt_pk_bf16_f32 v125, v12, v13
    v_mfma_f32_16x16x32_bf16 v[36:39], a[148:151], a[232:235], v[36:39]
    v_exp_f32 v11, v61
    v_mfma_f32_16x16x32_bf16 v[36:39], a[156:159], a[236:239], v[36:39]
    ds_read_b128 a[168:171], v2 offset:43008
    v_mfma_f32_16x16x32_bf16 v[44:47], a[132:135], a[240:243], v[68:71]
    v_exp_f32 v12, v62
    v_mfma_f32_16x16x32_bf16 v[44:47], a[140:143], a[244:247], v[44:47]
    v_cvt_pk_bf16_f32 v126, v10, v11
    v_mfma_f32_16x16x32_bf16 v[44:47], a[148:151], a[248:251], v[44:47]
    v_exp_f32 v13, v63
    v_mfma_f32_16x16x32_bf16 v[44:47], a[156:159], a[252:255], v[44:47]
    ds_read_b128 a[172:175], v2 offset:44032
    v_mfma_f32_16x16x32_bf16 a[0:3], a[192:195], v[112:115], a[0:3]
    v_exp_f32 v10, v32
    v_mfma_f32_16x16x32_bf16 a[32:35], a[192:195], v[116:119], a[32:35]
    s_waitcnt vmcnt(0)
    v_cvt_pk_bf16_f32 v127, v12, v13
    v_cmp_eq_u64 vcc, v[4:5], v[6:7]
    v_mfma_f32_16x16x32_bf16 a[4:7], a[196:199], v[112:115], a[4:7]
    v_exp_f32 v11, v33
    v_mfma_f32_16x16x32_bf16 a[36:39], a[196:199], v[116:119], a[36:39]
    s_or_b32 s83, vcc_lo, 15
    ds_read_b128 a[176:179], v2 offset:45056
    v_mfma_f32_16x16x32_bf16 v[92:95], v[18:21], v[124:127], v[92:95]
    ds_read_b128 a[188:191], v2 offset:48128
    v_mfma_f32_16x16x32_bf16 a[8:11], a[200:203], v[112:115], a[8:11]
    s_cmp_eq_u32 s83, -1
    v_exp_f32 v12, v34
    v_mfma_f32_16x16x32_bf16 a[40:43], a[200:203], v[116:119], a[40:43]
    s_cbranch_scc0 L_fh1
L_fhret1:
    v_cvt_pk_bf16_f32 v96, v10, v11
    v_mfma_f32_16x16x32_bf16 a[12:15], a[204:207], v[112:115], a[12:15]
    v_exp_f32 v13, v35
    v_mfma_f32_16x16x32_bf16 a[44:47], a[204:207], v[116:119], a[44:47]
    ds_read_b128 a[180:183], v2 offset:46080
    v_mfma_f32_16x16x32_bf16 a[16:19], a[208:211], v[112:115], a[16:19]
    v_exp_f32 v10, v36
    v_mfma_f32_16x16x32_bf16 a[48:51], a[208:211], v[116:119], a[48:51]
    v_cvt_pk_bf16_f32 v97, v12, v13
    v_mfma_f32_16x16x32_bf16 a[20:23], a[212:215], v[112:115], a[20:23]
    v_exp_f32 v11, v37
    v_mfma_f32_16x16x32_bf16 a[52:55], a[212:215], v[116:119], a[52:55]
    s_add_u32 s64, s45, s70
    ds_read_b128 a[184:187], v2 offset:47104
    v_cmp_nge_f32 vcc, s66, v94
    v_mfma_f32_16x16x32_bf16 a[24:27], a[216:219], v[112:115], a[24:27]
    s_add_u32 m0, s65, 32768
    v_exp_f32 v12, v38
    v_mfma_f32_16x16x32_bf16 a[56:59], a[216:219], v[116:119], a[56:59]
    buffer_load_dwordx4 v3, s[4:7], s64 offen offset:0 lds
    v_cvt_pk_bf16_f32 v98, v10, v11
    v_mfma_f32_16x16x32_bf16 a[28:31], a[220:223], v[112:115], a[28:31]
    v_exp_f32 v13, v39
    v_mfma_f32_16x16x32_bf16 a[60:63], a[220:223], v[116:119], a[60:63]
    s_cbranch_vccnz L_tramp25
L_ret25:
    v_mfma_f32_16x16x32_bf16 v[48:51], a[128:131], v[128:131], v[72:75]
    v_exp_f32 v10, v40
    v_mfma_f32_16x16x32_bf16 v[48:51], a[136:139], v[132:135], v[48:51]
    v_cvt_pk_bf16_f32 v99, v12, v13
    v_mfma_f32_16x16x32_bf16 v[48:51], a[144:147], v[136:139], v[48:51]
    v_exp_f32 v11, v41
    v_mfma_f32_16x16x32_bf16 v[48:51], a[152:155], v[140:143], v[48:51]
    v_mfma_f32_16x16x32_bf16 v[56:59], a[128:131], v[144:147], v[76:79]
    v_exp_f32 v12, v42
    v_mfma_f32_16x16x32_bf16 v[56:59], a[136:139], v[148:151], v[56:59]
    buffer_load_dwordx4 v3, s[4:7], s64 offen offset:1024 lds
    v_cvt_pk_bf16_f32 v100, v10, v11
    v_mfma_f32_16x16x32_bf16 v[56:59], a[144:147], v[152:155], v[56:59]
    v_exp_f32 v13, v43
    v_mfma_f32_16x16x32_bf16 v[56:59], a[152:155], v[156:159], v[56:59]
    ds_read_b128 a[128:131], v2 offset:49152
    v_mfma_f32_16x16x32_bf16 v[80:83], v[14:17], v[96:99], v[84:87]
    ds_read_b128 a[136:139], v2 offset:51200
    buffer_load_dwordx4 v3, s[4:7], s64 offen offset:2048 lds
    v_mfma_f32_16x16x32_bf16 v[52:55], a[132:135], v[128:131], v[72:75]
    v_exp_f32 v10, v44
    v_mfma_f32_16x16x32_bf16 v[52:55], a[140:143], v[132:135], v[52:55]
    v_cvt_pk_bf16_f32 v101, v12, v13
    v_mfma_f32_16x16x32_bf16 v[52:55], a[148:151], v[136:139], v[52:55]
    v_exp_f32 v11, v45
    v_mfma_f32_16x16x32_bf16 v[52:55], a[156:159], v[140:143], v[52:55]
    ds_read_b128 a[144:147], v2 offset:53248
    v_mfma_f32_16x16x32_bf16 v[60:63], a[132:135], v[144:147], v[76:79]
    v_exp_f32 v12, v46
    v_mfma_f32_16x16x32_bf16 v[60:63], a[140:143], v[148:151], v[60:63]
    buffer_load_dwordx4 v3, s[4:7], s64 offen offset:3072 lds
    v_cvt_pk_bf16_f32 v102, v10, v11
    v_mfma_f32_16x16x32_bf16 v[60:63], a[148:151], v[152:155], v[60:63]
    v_exp_f32 v13, v47
    v_mfma_f32_16x16x32_bf16 v[60:63], a[156:159], v[156:159], v[60:63]
    ds_read_b128 a[152:155], v2 offset:55296
    v_mfma_f32_16x16x32_bf16 a[64:67], a[192:195], v[120:123], a[64:67]
    v_exp_f32 v10, v48
    v_mfma_f32_16x16x32_bf16 a[96:99], a[192:195], v[124:127], a[96:99]
    v_cvt_pk_bf16_f32 v103, v12, v13
    v_mfma_f32_16x16x32_bf16 a[68:71], a[196:199], v[120:123], a[68:71]
    v_exp_f32 v11, v49
    v_mfma_f32_16x16x32_bf16 a[100:103], a[196:199], v[124:127], a[100:103]
    ds_read_b128 a[132:135], v2 offset:50176
    v_mfma_f32_16x16x32_bf16 v[80:83], v[18:21], v[100:103], v[80:83]
    ds_read_b128 a[140:143], v2 offset:52224
    v_mfma_f32_16x16x32_bf16 a[72:75], a[200:203], v[120:123], a[72:75]
    s_add_u32 m0, s65, 36864
    v_exp_f32 v12, v50
    v_mfma_f32_16x16x32_bf16 a[104:107], a[200:203], v[124:127], a[104:107]
    buffer_load_dwordx4 v9, s[4:7], s64 offen offset:0 lds
    v_cvt_pk_bf16_f32 v104, v10, v11
    v_mfma_f32_16x16x32_bf16 a[76:79], a[204:207], v[120:123], a[76:79]
    v_exp_f32 v13, v51
    v_mfma_f32_16x16x32_bf16 a[108:111], a[204:207], v[124:127], a[108:111]
    ds_read_b128 a[148:151], v2 offset:54272
    v_mfma_f32_16x16x32_bf16 a[80:83], a[208:211], v[120:123], a[80:83]
    v_exp_f32 v10, v52
    v_mfma_f32_16x16x32_bf16 a[112:115], a[208:211], v[124:127], a[112:115]
    v_cvt_pk_bf16_f32 v105, v12, v13
    v_mfma_f32_16x16x32_bf16 a[84:87], a[212:215], v[120:123], a[84:87]
    v_exp_f32 v11, v53
    v_mfma_f32_16x16x32_bf16 a[116:119], a[212:215], v[124:127], a[116:119]
    ds_read_b128 a[156:159], v2 offset:56320
    v_cmp_nge_f32 vcc, s66, v82
    v_mfma_f32_16x16x32_bf16 a[88:91], a[216:219], v[120:123], a[88:91]
    v_exp_f32 v12, v54
    v_mfma_f32_16x16x32_bf16 a[120:123], a[216:219], v[124:127], a[120:123]
    buffer_load_dwordx4 v9, s[4:7], s64 offen offset:1024 lds
    v_cvt_pk_bf16_f32 v106, v10, v11
    v_mfma_f32_16x16x32_bf16 a[92:95], a[220:223], v[120:123], a[92:95]
    v_exp_f32 v13, v55
    v_mfma_f32_16x16x32_bf16 a[124:127], a[220:223], v[124:127], a[124:127]
    s_waitcnt lgkmcnt(4)
    s_cbranch_vccnz L_tramp26
L_ret26:
    v_mfma_f32_16x16x32_bf16 v[32:35], a[128:131], a[224:227], v[64:67]
    v_exp_f32 v10, v56
    v_mfma_f32_16x16x32_bf16 v[32:35], a[136:139], a[228:231], v[32:35]
    v_cvt_pk_bf16_f32 v107, v12, v13
    v_mfma_f32_16x16x32_bf16 v[32:35], a[144:147], a[232:235], v[32:35]
    v_exp_f32 v11, v57
    v_mfma_f32_16x16x32_bf16 v[32:35], a[152:155], a[236:239], v[32:35]
    ds_read_b128 a[192:195], v2 offset:57344
    v_mfma_f32_16x16x32_bf16 v[40:43], a[128:131], a[240:243], v[68:71]
    v_exp_f32 v12, v58
    v_mfma_f32_16x16x32_bf16 v[40:43], a[136:139], a[244:247], v[40:43]
    v_cvt_pk_bf16_f32 v108, v10, v11
    v_mfma_f32_16x16x32_bf16 v[40:43], a[144:147], a[248:251], v[40:43]
    v_exp_f32 v13, v59
    v_mfma_f32_16x16x32_bf16 v[40:43], a[152:155], a[252:255], v[40:43]
    ds_read_b128 a[196:199], v2 offset:58368
    v_mfma_f32_16x16x32_bf16 v[88:91], v[14:17], v[104:107], v[92:95]
    s_waitcnt lgkmcnt(2)
    buffer_load_dwordx4 v9, s[4:7], s64 offen offset:2048 lds
    v_mfma_f32_16x16x32_bf16 v[36:39], a[132:135], a[224:227], v[64:67]
    v_exp_f32 v10, v60
    v_mfma_f32_16x16x32_bf16 v[36:39], a[140:143], a[228:231], v[36:39]
    v_cvt_pk_bf16_f32 v109, v12, v13
    v_mfma_f32_16x16x32_bf16 v[36:39], a[148:151], a[232:235], v[36:39]
    v_exp_f32 v11, v61
    v_mfma_f32_16x16x32_bf16 v[36:39], a[156:159], a[236:239], v[36:39]
    ds_read_b128 a[200:203], v2 offset:59392
    v_mfma_f32_16x16x32_bf16 v[44:47], a[132:135], a[240:243], v[68:71]
    v_exp_f32 v12, v62
    v_mfma_f32_16x16x32_bf16 v[44:47], a[140:143], a[244:247], v[44:47]
    buffer_load_dwordx4 v9, s[4:7], s64 offen offset:3072 lds
    v_cvt_pk_bf16_f32 v110, v10, v11
    v_mfma_f32_16x16x32_bf16 v[44:47], a[148:151], a[248:251], v[44:47]
    v_exp_f32 v13, v63
    v_mfma_f32_16x16x32_bf16 v[44:47], a[156:159], a[252:255], v[44:47]
    ds_read_b128 a[204:207], v2 offset:60416
    v_mfma_f32_16x16x32_bf16 a[0:3], a[160:163], v[96:99], a[0:3]
    v_exp_f32 v10, v32
    v_mfma_f32_16x16x32_bf16 a[32:35], a[160:163], v[100:103], a[32:35]
    v_cvt_pk_bf16_f32 v111, v12, v13
    v_mfma_f32_16x16x32_bf16 a[4:7], a[164:167], v[96:99], a[4:7]
    v_exp_f32 v11, v33
    v_mfma_f32_16x16x32_bf16 a[36:39], a[164:167], v[100:103], a[36:39]
    ds_read_b128 a[208:211], v2 offset:61440
    v_mfma_f32_16x16x32_bf16 v[88:91], v[18:21], v[108:111], v[88:91]
    ds_read_b128 a[220:223], v2 offset:64512
    v_mfma_f32_16x16x32_bf16 a[8:11], a[168:171], v[96:99], a[8:11]
    v_exp_f32 v12, v34
    v_mfma_f32_16x16x32_bf16 a[40:43], a[168:171], v[100:103], a[40:43]
    v_cvt_pk_bf16_f32 v112, v10, v11
    v_mfma_f32_16x16x32_bf16 a[12:15], a[172:175], v[96:99], a[12:15]
    v_exp_f32 v13, v35
    v_mfma_f32_16x16x32_bf16 a[44:47], a[172:175], v[100:103], a[44:47]
    ds_read_b128 a[212:215], v2 offset:62464
    v_mfma_f32_16x16x32_bf16 a[16:19], a[176:179], v[96:99], a[16:19]
    v_exp_f32 v10, v36
    v_mfma_f32_16x16x32_bf16 a[48:51], a[176:179], v[100:103], a[48:51]
    v_cvt_pk_bf16_f32 v113, v12, v13
    v_mfma_f32_16x16x32_bf16 a[20:23], a[180:183], v[96:99], a[20:23]
    v_exp_f32 v11, v37
    v_mfma_f32_16x16x32_bf16 a[52:55], a[180:183], v[100:103], a[52:55]
    ds_read_b128 a[216:219], v2 offset:63488
    v_cmp_nge_f32 vcc, s66, v90
    v_mfma_f32_16x16x32_bf16 a[24:27], a[184:187], v[96:99], a[24:27]
    v_exp_f32 v12, v38
    v_mfma_f32_16x16x32_bf16 a[56:59], a[184:187], v[100:103], a[56:59]
    v_cvt_pk_bf16_f32 v114, v10, v11
    v_mfma_f32_16x16x32_bf16 a[28:31], a[188:191], v[96:99], a[28:31]
    v_exp_f32 v13, v39
    v_mfma_f32_16x16x32_bf16 a[60:63], a[188:191], v[100:103], a[60:63]
    s_cbranch_vccnz L_tramp27
L_ret27:
    v_mfma_f32_16x16x32_bf16 v[48:51], a[128:131], v[128:131], v[72:75]
    s_waitcnt vmcnt(9)
    v_exp_f32 v10, v40
    v_mfma_f32_16x16x32_bf16 v[48:51], a[136:139], v[132:135], v[48:51]
    s_barrier
    v_cvt_pk_bf16_f32 v115, v12, v13
    v_mfma_f32_16x16x32_bf16 v[48:51], a[144:147], v[136:139], v[48:51]
    v_exp_f32 v11, v41
    v_mfma_f32_16x16x32_bf16 v[48:51], a[152:155], v[140:143], v[48:51]
    v_mfma_f32_16x16x32_bf16 v[56:59], a[128:131], v[144:147], v[76:79]
    v_exp_f32 v12, v42
    v_mfma_f32_16x16x32_bf16 v[56:59], a[136:139], v[148:151], v[56:59]
    v_cvt_pk_bf16_f32 v116, v10, v11
    v_mfma_f32_16x16x32_bf16 v[56:59], a[144:147], v[152:155], v[56:59]
    s_add_u32 s64, s46, s70
    v_exp_f32 v13, v43
    v_mfma_f32_16x16x32_bf16 v[56:59], a[152:155], v[156:159], v[56:59]
    s_add_u32 m0, s65, 65536
    ds_read_b128 a[128:131], v1 offset:0
    v_mfma_f32_16x16x32_bf16 v[84:87], v[14:17], v[112:115], v[80:83]
    ds_read_b128 a[136:139], v1 offset:2048
    buffer_load_dwordx4 v3, s[4:7], s64 offen offset:0 lds
    v_mfma_f32_16x16x32_bf16 v[52:55], a[132:135], v[128:131], v[72:75]
    v_exp_f32 v10, v44
    v_mfma_f32_16x16x32_bf16 v[52:55], a[140:143], v[132:135], v[52:55]
    v_cvt_pk_bf16_f32 v117, v12, v13
    v_mfma_f32_16x16x32_bf16 v[52:55], a[148:151], v[136:139], v[52:55]
    v_exp_f32 v11, v45
    v_mfma_f32_16x16x32_bf16 v[52:55], a[156:159], v[140:143], v[52:55]
    ds_read_b128 a[144:147], v1 offset:4096
    v_mfma_f32_16x16x32_bf16 v[60:63], a[132:135], v[144:147], v[76:79]
    v_exp_f32 v12, v46
    v_mfma_f32_16x16x32_bf16 v[60:63], a[140:143], v[148:151], v[60:63]
    v_cvt_pk_bf16_f32 v118, v10, v11
    v_mfma_f32_16x16x32_bf16 v[60:63], a[148:151], v[152:155], v[60:63]
    v_exp_f32 v13, v47
    v_mfma_f32_16x16x32_bf16 v[60:63], a[156:159], v[156:159], v[60:63]
    ds_read_b128 a[152:155], v1 offset:6144
    v_mfma_f32_16x16x32_bf16 a[64:67], a[160:163], v[104:107], a[64:67]
    v_exp_f32 v10, v48
    v_mfma_f32_16x16x32_bf16 a[96:99], a[160:163], v[108:111], a[96:99]
    v_cvt_pk_bf16_f32 v119, v12, v13
    v_mfma_f32_16x16x32_bf16 a[68:71], a[164:167], v[104:107], a[68:71]
    v_exp_f32 v11, v49
    v_mfma_f32_16x16x32_bf16 a[100:103], a[164:167], v[108:111], a[100:103]
    ds_read_b128 a[132:135], v1 offset:1024
    v_mfma_f32_16x16x32_bf16 v[84:87], v[18:21], v[116:119], v[84:87]
    ds_read_b128 a[140:143], v1 offset:3072
    v_mfma_f32_16x16x32_bf16 a[72:75], a[168:171], v[104:107], a[72:75]
    v_exp_f32 v12, v50
    v_mfma_f32_16x16x32_bf16 a[104:107], a[168:171], v[108:111], a[104:107]
    buffer_load_dwordx4 v3, s[4:7], s64 offen offset:1024 lds
    v_cvt_pk_bf16_f32 v120, v10, v11
    v_mfma_f32_16x16x32_bf16 a[76:79], a[172:175], v[104:107], a[76:79]
    v_exp_f32 v13, v51
    v_mfma_f32_16x16x32_bf16 a[108:111], a[172:175], v[108:111], a[108:111]
    ds_read_b128 a[148:151], v1 offset:5120
    v_mfma_f32_16x16x32_bf16 a[80:83], a[176:179], v[104:107], a[80:83]
    v_exp_f32 v10, v52
    v_mfma_f32_16x16x32_bf16 a[112:115], a[176:179], v[108:111], a[112:115]
    v_cvt_pk_bf16_f32 v121, v12, v13
    v_mfma_f32_16x16x32_bf16 a[84:87], a[180:183], v[104:107], a[84:87]
    v_exp_f32 v11, v53
    v_mfma_f32_16x16x32_bf16 a[116:119], a[180:183], v[108:111], a[116:119]
    ds_read_b128 a[156:159], v1 offset:7168
    v_cmp_nge_f32 vcc, s66, v86
    v_mfma_f32_16x16x32_bf16 a[88:91], a[184:187], v[104:107], a[88:91]
    v_exp_f32 v12, v54
    v_mfma_f32_16x16x32_bf16 a[120:123], a[184:187], v[108:111], a[120:123]
    v_cvt_pk_bf16_f32 v122, v10, v11
    v_mfma_f32_16x16x32_bf16 a[92:95], a[188:191], v[104:107], a[92:95]
    v_exp_f32 v13, v55
    v_mfma_f32_16x16x32_bf16 a[124:127], a[188:191], v[108:111], a[124:127]
    s_waitcnt lgkmcnt(4)
    s_cbranch_vccnz L_tramp28
L_ret28:
    v_mfma_f32_16x16x32_bf16 v[32:35], a[128:131], a[224:227], v[64:67]
    v_exp_f32 v10, v56
    v_mfma_f32_16x16x32_bf16 v[32:35], a[136:139], a[228:231], v[32:35]
    v_cvt_pk_bf16_f32 v123, v12, v13
    v_mfma_f32_16x16x32_bf16 v[32:35], a[144:147], a[232:235], v[32:35]
    v_exp_f32 v11, v57
    v_mfma_f32_16x16x32_bf16 v[32:35], a[152:155], a[236:239], v[32:35]
    ds_read_b128 a[160:163], v1 offset:8192
    v_mfma_f32_16x16x32_bf16 v[40:43], a[128:131], a[240:243], v[68:71]
    v_exp_f32 v12, v58
    v_mfma_f32_16x16x32_bf16 v[40:43], a[136:139], a[244:247], v[40:43]
    v_cvt_pk_bf16_f32 v124, v10, v11
    v_mfma_f32_16x16x32_bf16 v[40:43], a[144:147], a[248:251], v[40:43]
    v_exp_f32 v13, v59
    v_mfma_f32_16x16x32_bf16 v[40:43], a[152:155], a[252:255], v[40:43]
    ds_read_b128 a[164:167], v1 offset:9216
    v_mfma_f32_16x16x32_bf16 v[92:95], v[14:17], v[120:123], v[88:91]
    s_waitcnt lgkmcnt(2)
    buffer_load_dwordx4 v3, s[4:7], s64 offen offset:2048 lds
    v_mfma_f32_16x16x32_bf16 v[36:39], a[132:135], a[224:227], v[64:67]
    v_exp_f32 v10, v60
    v_mfma_f32_16x16x32_bf16 v[36:39], a[140:143], a[228:231], v[36:39]
    v_cvt_pk_bf16_f32 v125, v12, v13
    v_mfma_f32_16x16x32_bf16 v[36:39], a[148:151], a[232:235], v[36:39]
    v_exp_f32 v11, v61
    v_mfma_f32_16x16x32_bf16 v[36:39], a[156:159], a[236:239], v[36:39]
    ds_read_b128 a[168:171], v1 offset:10240
    v_mfma_f32_16x16x32_bf16 v[44:47], a[132:135], a[240:243], v[68:71]
    v_exp_f32 v12, v62
    v_mfma_f32_16x16x32_bf16 v[44:47], a[140:143], a[244:247], v[44:47]
    v_cvt_pk_bf16_f32 v126, v10, v11
    v_mfma_f32_16x16x32_bf16 v[44:47], a[148:151], a[248:251], v[44:47]
    v_exp_f32 v13, v63
    v_mfma_f32_16x16x32_bf16 v[44:47], a[156:159], a[252:255], v[44:47]
    ds_read_b128 a[172:175], v1 offset:11264
    v_mfma_f32_16x16x32_bf16 a[0:3], a[192:195], v[112:115], a[0:3]
    v_exp_f32 v10, v32
    v_mfma_f32_16x16x32_bf16 a[32:35], a[192:195], v[116:119], a[32:35]
    v_cvt_pk_bf16_f32 v127, v12, v13
    v_mfma_f32_16x16x32_bf16 a[4:7], a[196:199], v[112:115], a[4:7]
    v_exp_f32 v11, v33
    v_mfma_f32_16x16x32_bf16 a[36:39], a[196:199], v[116:119], a[36:39]
    ds_read_b128 a[176:179], v1 offset:12288
    v_mfma_f32_16x16x32_bf16 v[92:95], v[18:21], v[124:127], v[92:95]
    ds_read_b128 a[188:191], v1 offset:15360
    v_mfma_f32_16x16x32_bf16 a[8:11], a[200:203], v[112:115], a[8:11]
    v_exp_f32 v12, v34
    v_mfma_f32_16x16x32_bf16 a[40:43], a[200:203], v[116:119], a[40:43]
    buffer_load_dwordx4 v3, s[4:7], s64 offen offset:3072 lds
    v_cvt_pk_bf16_f32 v96, v10, v11
    v_mfma_f32_16x16x32_bf16 a[12:15], a[204:207], v[112:115], a[12:15]
    v_exp_f32 v13, v35
    v_mfma_f32_16x16x32_bf16 a[44:47], a[204:207], v[116:119], a[44:47]
    ds_read_b128 a[180:183], v1 offset:13312
    v_mfma_f32_16x16x32_bf16 a[16:19], a[208:211], v[112:115], a[16:19]
    v_exp_f32 v10, v36
    v_mfma_f32_16x16x32_bf16 a[48:51], a[208:211], v[116:119], a[48:51]
    v_cvt_pk_bf16_f32 v97, v12, v13
    v_mfma_f32_16x16x32_bf16 a[20:23], a[212:215], v[112:115], a[20:23]
    v_exp_f32 v11, v37
    v_mfma_f32_16x16x32_bf16 a[52:55], a[212:215], v[116:119], a[52:55]
    ds_read_b128 a[184:187], v1 offset:14336
    v_cmp_nge_f32 vcc, s66, v94
    v_mfma_f32_16x16x32_bf16 a[24:27], a[216:219], v[112:115], a[24:27]
    v_exp_f32 v12, v38
    v_mfma_f32_16x16x32_bf16 a[56:59], a[216:219], v[116:119], a[56:59]
    v_cvt_pk_bf16_f32 v98, v10, v11
    v_mfma_f32_16x16x32_bf16 a[28:31], a[220:223], v[112:115], a[28:31]
    v_exp_f32 v13, v39
    v_mfma_f32_16x16x32_bf16 a[60:63], a[220:223], v[116:119], a[60:63]
    s_cbranch_vccnz L_tramp29
L_ret29:
    v_mfma_f32_16x16x32_bf16 v[48:51], a[128:131], v[128:131], v[72:75]
    v_exp_f32 v10, v40
    v_mfma_f32_16x16x32_bf16 v[48:51], a[136:139], v[132:135], v[48:51]
    v_cvt_pk_bf16_f32 v99, v12, v13
    v_mfma_f32_16x16x32_bf16 v[48:51], a[144:147], v[136:139], v[48:51]
    v_exp_f32 v11, v41
    v_mfma_f32_16x16x32_bf16 v[48:51], a[152:155], v[140:143], v[48:51]
    v_mfma_f32_16x16x32_bf16 v[56:59], a[128:131], v[144:147], v[76:79]
    v_exp_f32 v12, v42
    v_mfma_f32_16x16x32_bf16 v[56:59], a[136:139], v[148:151], v[56:59]
    v_cvt_pk_bf16_f32 v100, v10, v11
    v_mfma_f32_16x16x32_bf16 v[56:59], a[144:147], v[152:155], v[56:59]
    v_exp_f32 v13, v43
    v_mfma_f32_16x16x32_bf16 v[56:59], a[152:155], v[156:159], v[56:59]
    s_add_u32 m0, s65, 69632
    ds_read_b128 a[128:131], v1 offset:16384
    v_mfma_f32_16x16x32_bf16 v[80:83], v[14:17], v[96:99], v[84:87]
    ds_read_b128 a[136:139], v1 offset:18432
    buffer_load_dwordx4 v9, s[4:7], s64 offen offset:0 lds
    v_mfma_f32_16x16x32_bf16 v[52:55], a[132:135], v[128:131], v[72:75]
    v_exp_f32 v10, v44
    v_mfma_f32_16x16x32_bf16 v[52:55], a[140:143], v[132:135], v[52:55]
    v_cvt_pk_bf16_f32 v101, v12, v13
    v_mfma_f32_16x16x32_bf16 v[52:55], a[148:151], v[136:139], v[52:55]
    v_exp_f32 v11, v45
    v_mfma_f32_16x16x32_bf16 v[52:55], a[156:159], v[140:143], v[52:55]
    ds_read_b128 a[144:147], v1 offset:20480
    v_mfma_f32_16x16x32_bf16 v[60:63], a[132:135], v[144:147], v[76:79]
    v_exp_f32 v12, v46
    v_mfma_f32_16x16x32_bf16 v[60:63], a[140:143], v[148:151], v[60:63]
    v_cvt_pk_bf16_f32 v102, v10, v11
    v_mfma_f32_16x16x32_bf16 v[60:63], a[148:151], v[152:155], v[60:63]
    v_exp_f32 v13, v47
    v_mfma_f32_16x16x32_bf16 v[60:63], a[156:159], v[156:159], v[60:63]
    ds_read_b128 a[152:155], v1 offset:22528
    v_mfma_f32_16x16x32_bf16 a[64:67], a[192:195], v[120:123], a[64:67]
    v_exp_f32 v10, v48
    v_mfma_f32_16x16x32_bf16 a[96:99], a[192:195], v[124:127], a[96:99]
    v_cvt_pk_bf16_f32 v103, v12, v13
    v_mfma_f32_16x16x32_bf16 a[68:71], a[196:199], v[120:123], a[68:71]
    v_exp_f32 v11, v49
    v_mfma_f32_16x16x32_bf16 a[100:103], a[196:199], v[124:127], a[100:103]
    ds_read_b128 a[132:135], v1 offset:17408
    v_mfma_f32_16x16x32_bf16 v[80:83], v[18:21], v[100:103], v[80:83]
    ds_read_b128 a[140:143], v1 offset:19456
    v_mfma_f32_16x16x32_bf16 a[72:75], a[200:203], v[120:123], a[72:75]
    v_exp_f32 v12, v50
    v_mfma_f32_16x16x32_bf16 a[104:107], a[200:203], v[124:127], a[104:107]
    buffer_load_dwordx4 v9, s[4:7], s64 offen offset:1024 lds
    v_cvt_pk_bf16_f32 v104, v10, v11
    v_mfma_f32_16x16x32_bf16 a[76:79], a[204:207], v[120:123], a[76:79]
    v_exp_f32 v13, v51
    v_mfma_f32_16x16x32_bf16 a[108:111], a[204:207], v[124:127], a[108:111]
    ds_read_b128 a[148:151], v1 offset:21504
    v_mfma_f32_16x16x32_bf16 a[80:83], a[208:211], v[120:123], a[80:83]
    v_exp_f32 v10, v52
    v_mfma_f32_16x16x32_bf16 a[112:115], a[208:211], v[124:127], a[112:115]
    v_cvt_pk_bf16_f32 v105, v12, v13
    v_mfma_f32_16x16x32_bf16 a[84:87], a[212:215], v[120:123], a[84:87]
    v_exp_f32 v11, v53
    v_mfma_f32_16x16x32_bf16 a[116:119], a[212:215], v[124:127], a[116:119]
    ds_read_b128 a[156:159], v1 offset:23552
    v_cmp_nge_f32 vcc, s66, v82
    v_mfma_f32_16x16x32_bf16 a[88:91], a[216:219], v[120:123], a[88:91]
    v_exp_f32 v12, v54
    v_mfma_f32_16x16x32_bf16 a[120:123], a[216:219], v[124:127], a[120:123]
    v_cvt_pk_bf16_f32 v106, v10, v11
    v_mfma_f32_16x16x32_bf16 a[92:95], a[220:223], v[120:123], a[92:95]
    v_exp_f32 v13, v55
    v_mfma_f32_16x16x32_bf16 a[124:127], a[220:223], v[124:127], a[124:127]
    s_waitcnt lgkmcnt(4)
    s_cbranch_vccnz L_tramp30
L_ret30:
    v_mfma_f32_16x16x32_bf16 v[32:35], a[128:131], a[224:227], v[64:67]
    v_exp_f32 v10, v56
    v_mfma_f32_16x16x32_bf16 v[32:35], a[136:139], a[228:231], v[32:35]
    v_cvt_pk_bf16_f32 v107, v12, v13
    v_mfma_f32_16x16x32_bf16 v[32:35], a[144:147], a[232:235], v[32:35]
    v_exp_f32 v11, v57
    v_mfma_f32_16x16x32_bf16 v[32:35], a[152:155], a[236:239], v[32:35]
    ds_read_b128 a[192:195], v1 offset:24576
    v_mfma_f32_16x16x32_bf16 v[40:43], a[128:131], a[240:243], v[68:71]
    v_exp_f32 v12, v58
    v_mfma_f32_16x16x32_bf16 v[40:43], a[136:139], a[244:247], v[40:43]
    v_cvt_pk_bf16_f32 v108, v10, v11
    v_mfma_f32_16x16x32_bf16 v[40:43], a[144:147], a[248:251], v[40:43]
    v_exp_f32 v13, v59
    v_mfma_f32_16x16x32_bf16 v[40:43], a[152:155], a[252:255], v[40:43]
    ds_read_b128 a[196:199], v1 offset:25600
    v_mfma_f32_16x16x32_bf16 v[88:91], v[14:17], v[104:107], v[92:95]
    s_waitcnt lgkmcnt(2)
    buffer_load_dwordx4 v9, s[4:7], s64 offen offset:2048 lds
    v_mfma_f32_16x16x32_bf16 v[36:39], a[132:135], a[224:227], v[64:67]
    v_exp_f32 v10, v60
    v_mfma_f32_16x16x32_bf16 v[36:39], a[140:143], a[228:231], v[36:39]
    v_cvt_pk_bf16_f32 v109, v12, v13
    v_mfma_f32_16x16x32_bf16 v[36:39], a[148:151], a[232:235], v[36:39]
    v_exp_f32 v11, v61
    v_mfma_f32_16x16x32_bf16 v[36:39], a[156:159], a[236:239], v[36:39]
    ds_read_b128 a[200:203], v1 offset:26624
    v_mfma_f32_16x16x32_bf16 v[44:47], a[132:135], a[240:243], v[68:71]
    v_exp_f32 v12, v62
    v_mfma_f32_16x16x32_bf16 v[44:47], a[140:143], a[244:247], v[44:47]
    v_cvt_pk_bf16_f32 v110, v10, v11
    v_mfma_f32_16x16x32_bf16 v[44:47], a[148:151], a[248:251], v[44:47]
    v_exp_f32 v13, v63
    v_mfma_f32_16x16x32_bf16 v[44:47], a[156:159], a[252:255], v[44:47]
    ds_read_b128 a[204:207], v1 offset:27648
    v_mfma_f32_16x16x32_bf16 a[0:3], a[160:163], v[96:99], a[0:3]
    v_exp_f32 v10, v32
    v_mfma_f32_16x16x32_bf16 a[32:35], a[160:163], v[100:103], a[32:35]
    v_cvt_pk_bf16_f32 v111, v12, v13
    v_mfma_f32_16x16x32_bf16 a[4:7], a[164:167], v[96:99], a[4:7]
    v_exp_f32 v11, v33
    v_mfma_f32_16x16x32_bf16 a[36:39], a[164:167], v[100:103], a[36:39]
    ds_read_b128 a[208:211], v1 offset:28672
    v_mfma_f32_16x16x32_bf16 v[88:91], v[18:21], v[108:111], v[88:91]
    ds_read_b128 a[220:223], v1 offset:31744
    v_mfma_f32_16x16x32_bf16 a[8:11], a[168:171], v[96:99], a[8:11]
    v_exp_f32 v12, v34
    v_mfma_f32_16x16x32_bf16 a[40:43], a[168:171], v[100:103], a[40:43]
    buffer_load_dwordx4 v9, s[4:7], s64 offen offset:3072 lds
    v_cvt_pk_bf16_f32 v112, v10, v11
    v_mfma_f32_16x16x32_bf16 a[12:15], a[172:175], v[96:99], a[12:15]
    v_exp_f32 v13, v35
    v_mfma_f32_16x16x32_bf16 a[44:47], a[172:175], v[100:103], a[44:47]
    s_add_u32 s69, s69, 32768
    ds_read_b128 a[212:215], v1 offset:29696
    v_mfma_f32_16x16x32_bf16 a[16:19], a[176:179], v[96:99], a[16:19]
    s_add_u32 s70, s70, 32768
    v_exp_f32 v10, v36
    v_mfma_f32_16x16x32_bf16 a[48:51], a[176:179], v[100:103], a[48:51]
    s_add_u32 s63, s63, 1
    v_cvt_pk_bf16_f32 v113, v12, v13
    v_mfma_f32_16x16x32_bf16 a[20:23], a[180:183], v[96:99], a[20:23]
    v_exp_f32 v11, v37
    v_mfma_f32_16x16x32_bf16 a[52:55], a[180:183], v[100:103], a[52:55]
    ds_read_b128 a[216:219], v1 offset:30720
    v_cmp_nge_f32 vcc, s66, v90
    v_mfma_f32_16x16x32_bf16 a[24:27], a[184:187], v[96:99], a[24:27]
    v_exp_f32 v12, v38
    v_mfma_f32_16x16x32_bf16 a[56:59], a[184:187], v[100:103], a[56:59]
    v_cvt_pk_bf16_f32 v114, v10, v11
    v_mfma_f32_16x16x32_bf16 a[28:31], a[188:191], v[96:99], a[28:31]
    v_exp_f32 v13, v39
    v_mfma_f32_16x16x32_bf16 a[60:63], a[188:191], v[100:103], a[60:63]
    s_cbranch_vccnz L_tramp31
L_ret31:
    s_cmp_lt_u32 s63, 3
    s_cbranch_scc1 L_loop
    v_mfma_f32_16x16x32_bf16 v[48:51], a[128:131], v[128:131], v[72:75]
    s_waitcnt vmcnt(8)
    v_exp_f32 v10, v40
    v_mfma_f32_16x16x32_bf16 v[48:51], a[136:139], v[132:135], v[48:51]
    s_barrier
    v_cvt_pk_bf16_f32 v115, v12, v13
    v_mfma_f32_16x16x32_bf16 v[48:51], a[144:147], v[136:139], v[48:51]
    v_exp_f32 v11, v41
    v_mfma_f32_16x16x32_bf16 v[48:51], a[152:155], v[140:143], v[48:51]
    v_mfma_f32_16x16x32_bf16 v[56:59], a[128:131], v[144:147], v[76:79]
    v_exp_f32 v12, v42
    v_mfma_f32_16x16x32_bf16 v[56:59], a[136:139], v[148:151], v[56:59]
    v_cvt_pk_bf16_f32 v116, v10, v11
    v_mfma_f32_16x16x32_bf16 v[56:59], a[144:147], v[152:155], v[56:59]
    s_add_u32 s64, s47, 0x18000
    v_exp_f32 v13, v43
    v_mfma_f32_16x16x32_bf16 v[56:59], a[152:155], v[156:159], v[56:59]
    s_add_u32 m0, s65, 98304
    ds_read_b128 a[128:131], v1 offset:32768
    v_mfma_f32_16x16x32_bf16 v[84:87], v[14:17], v[112:115], v[80:83]
    ds_read_b128 a[136:139], v1 offset:34816
    buffer_load_dwordx4 v3, s[4:7], s64 offen offset:0 lds
    v_mfma_f32_16x16x32_bf16 v[52:55], a[132:135], v[128:131], v[72:75]
    v_exp_f32 v10, v44
    v_mfma_f32_16x16x32_bf16 v[52:55], a[140:143], v[132:135], v[52:55]
    v_cvt_pk_bf16_f32 v117, v12, v13
    v_mfma_f32_16x16x32_bf16 v[52:55], a[148:151], v[136:139], v[52:55]
    v_exp_f32 v11, v45
    v_mfma_f32_16x16x32_bf16 v[52:55], a[156:159], v[140:143], v[52:55]
    ds_read_b128 a[144:147], v1 offset:36864
    v_mfma_f32_16x16x32_bf16 v[60:63], a[132:135], v[144:147], v[76:79]
    v_exp_f32 v12, v46
    v_mfma_f32_16x16x32_bf16 v[60:63], a[140:143], v[148:151], v[60:63]
    v_cvt_pk_bf16_f32 v118, v10, v11
    v_mfma_f32_16x16x32_bf16 v[60:63], a[148:151], v[152:155], v[60:63]
    v_exp_f32 v13, v47
    v_mfma_f32_16x16x32_bf16 v[60:63], a[156:159], v[156:159], v[60:63]
    ds_read_b128 a[152:155], v1 offset:38912
    v_mfma_f32_16x16x32_bf16 a[64:67], a[160:163], v[104:107], a[64:67]
    v_exp_f32 v10, v48
    v_mfma_f32_16x16x32_bf16 a[96:99], a[160:163], v[108:111], a[96:99]
    v_cvt_pk_bf16_f32 v119, v12, v13
    v_mfma_f32_16x16x32_bf16 a[68:71], a[164:167], v[104:107], a[68:71]
    v_exp_f32 v11, v49
    v_mfma_f32_16x16x32_bf16 a[100:103], a[164:167], v[108:111], a[100:103]
    ds_read_b128 a[132:135], v1 offset:33792
    v_mfma_f32_16x16x32_bf16 v[84:87], v[18:21], v[116:119], v[84:87]
    ds_read_b128 a[140:143], v1 offset:35840
    v_mfma_f32_16x16x32_bf16 a[72:75], a[168:171], v[104:107], a[72:75]
    v_exp_f32 v12, v50
    v_mfma_f32_16x16x32_bf16 a[104:107], a[168:171], v[108:111], a[104:107]
    buffer_load_dwordx4 v3, s[4:7], s64 offen offset:1024 lds
    v_cvt_pk_bf16_f32 v120, v10, v11
    v_mfma_f32_16x16x32_bf16 a[76:79], a[172:175], v[104:107], a[76:79]
    v_exp_f32 v13, v51
    v_mfma_f32_16x16x32_bf16 a[108:111], a[172:175], v[108:111], a[108:111]
    ds_read_b128 a[148:151], v1 offset:37888
    v_mfma_f32_16x16x32_bf16 a[80:83], a[176:179], v[104:107], a[80:83]
    v_exp_f32 v10, v52
    v_mfma_f32_16x16x32_bf16 a[112:115], a[176:179], v[108:111], a[112:115]
    v_cvt_pk_bf16_f32 v121, v12, v13
    v_mfma_f32_16x16x32_bf16 a[84:87], a[180:183], v[104:107], a[84:87]
    v_exp_f32 v11, v53
    v_mfma_f32_16x16x32_bf16 a[116:119], a[180:183], v[108:111], a[116:119]
    ds_read_b128 a[156:159], v1 offset:39936
    v_cmp_nge_f32 vcc, s66, v86
    v_mfma_f32_16x16x32_bf16 a[88:91], a[184:187], v[104:107], a[88:91]
    v_exp_f32 v12, v54
    v_mfma_f32_16x16x32_bf16 a[120:123], a[184:187], v[108:111], a[120:123]
    v_cvt_pk_bf16_f32 v122, v10, v11
    v_mfma_f32_16x16x32_bf16 a[92:95], a[188:191], v[104:107], a[92:95]
    v_exp_f32 v13, v55
    v_mfma_f32_16x16x32_bf16 a[124:127], a[188:191], v[108:111], a[124:127]
    s_waitcnt lgkmcnt(4)
    s_cbranch_vccnz L_tramp32
L_ret32:
    v_mfma_f32_16x16x32_bf16 v[32:35], a[128:131], a[224:227], v[64:67]
    v_exp_f32 v10, v56
    v_mfma_f32_16x16x32_bf16 v[32:35], a[136:139], a[228:231], v[32:35]
    v_cvt_pk_bf16_f32 v123, v12, v13
    v_mfma_f32_16x16x32_bf16 v[32:35], a[144:147], a[232:235], v[32:35]
    v_exp_f32 v11, v57
    v_mfma_f32_16x16x32_bf16 v[32:35], a[152:155], a[236:239], v[32:35]
    ds_read_b128 a[160:163], v1 offset:40960
    v_mfma_f32_16x16x32_bf16 v[40:43], a[128:131], a[240:243], v[68:71]
    v_exp_f32 v12, v58
    v_mfma_f32_16x16x32_bf16 v[40:43], a[136:139], a[244:247], v[40:43]
    v_cvt_pk_bf16_f32 v124, v10, v11
    v_mfma_f32_16x16x32_bf16 v[40:43], a[144:147], a[248:251], v[40:43]
    v_exp_f32 v13, v59
    v_mfma_f32_16x16x32_bf16 v[40:43], a[152:155], a[252:255], v[40:43]
    ds_read_b128 a[164:167], v1 offset:41984
    v_mfma_f32_16x16x32_bf16 v[92:95], v[14:17], v[120:123], v[88:91]
    s_waitcnt lgkmcnt(2)
    buffer_load_dwordx4 v3, s[4:7], s64 offen offset:2048 lds
    v_mfma_f32_16x16x32_bf16 v[36:39], a[132:135], a[224:227], v[64:67]
    v_exp_f32 v10, v60
    v_mfma_f32_16x16x32_bf16 v[36:39], a[140:143], a[228:231], v[36:39]
    v_cvt_pk_bf16_f32 v125, v12, v13
    v_mfma_f32_16x16x32_bf16 v[36:39], a[148:151], a[232:235], v[36:39]
    v_exp_f32 v11, v61
    v_mfma_f32_16x16x32_bf16 v[36:39], a[156:159], a[236:239], v[36:39]
    ds_read_b128 a[168:171], v1 offset:43008
    v_mfma_f32_16x16x32_bf16 v[44:47], a[132:135], a[240:243], v[68:71]
    v_exp_f32 v12, v62
    v_mfma_f32_16x16x32_bf16 v[44:47], a[140:143], a[244:247], v[44:47]
    v_cvt_pk_bf16_f32 v126, v10, v11
    v_mfma_f32_16x16x32_bf16 v[44:47], a[148:151], a[248:251], v[44:47]
    v_exp_f32 v13, v63
    v_mfma_f32_16x16x32_bf16 v[44:47], a[156:159], a[252:255], v[44:47]
    ds_read_b128 a[172:175], v1 offset:44032
    v_mfma_f32_16x16x32_bf16 a[0:3], a[192:195], v[112:115], a[0:3]
    v_exp_f32 v10, v32
    v_mfma_f32_16x16x32_bf16 a[32:35], a[192:195], v[116:119], a[32:35]
    v_cvt_pk_bf16_f32 v127, v12, v13
    v_mfma_f32_16x16x32_bf16 a[4:7], a[196:199], v[112:115], a[4:7]
    v_exp_f32 v11, v33
    v_mfma_f32_16x16x32_bf16 a[36:39], a[196:199], v[116:119], a[36:39]
    ds_read_b128 a[176:179], v1 offset:45056
    v_mfma_f32_16x16x32_bf16 v[92:95], v[18:21], v[124:127], v[92:95]
    ds_read_b128 a[188:191], v1 offset:48128
    v_mfma_f32_16x16x32_bf16 a[8:11], a[200:203], v[112:115], a[8:11]
    v_exp_f32 v12, v34
    v_mfma_f32_16x16x32_bf16 a[40:43], a[200:203], v[116:119], a[40:43]
    buffer_load_dwordx4 v3, s[4:7], s64 offen offset:3072 lds
    v_cvt_pk_bf16_f32 v96, v10, v11
    v_mfma_f32_16x16x32_bf16 a[12:15], a[204:207], v[112:115], a[12:15]
    v_exp_f32 v13, v35
    v_mfma_f32_16x16x32_bf16 a[44:47], a[204:207], v[116:119], a[44:47]
    ds_read_b128 a[180:183], v1 offset:46080
    v_mfma_f32_16x16x32_bf16 a[16:19], a[208:211], v[112:115], a[16:19]
    v_exp_f32 v10, v36
    v_mfma_f32_16x16x32_bf16 a[48:51], a[208:211], v[116:119], a[48:51]
    v_cvt_pk_bf16_f32 v97, v12, v13
    v_mfma_f32_16x16x32_bf16 a[20:23], a[212:215], v[112:115], a[20:23]
    v_exp_f32 v11, v37
    v_mfma_f32_16x16x32_bf16 a[52:55], a[212:215], v[116:119], a[52:55]
    ds_read_b128 a[184:187], v1 offset:47104
    v_cmp_nge_f32 vcc, s66, v94
    v_mfma_f32_16x16x32_bf16 a[24:27], a[216:219], v[112:115], a[24:27]
    v_exp_f32 v12, v38
    v_mfma_f32_16x16x32_bf16 a[56:59], a[216:219], v[116:119], a[56:59]
    v_cvt_pk_bf16_f32 v98, v10, v11
    v_mfma_f32_16x16x32_bf16 a[28:31], a[220:223], v[112:115], a[28:31]
    v_exp_f32 v13, v39
    v_mfma_f32_16x16x32_bf16 a[60:63], a[220:223], v[116:119], a[60:63]
    s_cbranch_vccnz L_tramp33
L_ret33:
    v_mfma_f32_16x16x32_bf16 v[48:51], a[128:131], v[128:131], v[72:75]
    v_exp_f32 v10, v40
    v_mfma_f32_16x16x32_bf16 v[48:51], a[136:139], v[132:135], v[48:51]
    v_cvt_pk_bf16_f32 v99, v12, v13
    v_mfma_f32_16x16x32_bf16 v[48:51], a[144:147], v[136:139], v[48:51]
    v_exp_f32 v11, v41
    v_mfma_f32_16x16x32_bf16 v[48:51], a[152:155], v[140:143], v[48:51]
    v_mfma_f32_16x16x32_bf16 v[56:59], a[128:131], v[144:147], v[76:79]
    v_exp_f32 v12, v42
    v_mfma_f32_16x16x32_bf16 v[56:59], a[136:139], v[148:151], v[56:59]
    v_cvt_pk_bf16_f32 v100, v10, v11
    v_mfma_f32_16x16x32_bf16 v[56:59], a[144:147], v[152:155], v[56:59]
    v_exp_f32 v13, v43
    v_mfma_f32_16x16x32_bf16 v[56:59], a[152:155], v[156:159], v[56:59]
    s_add_u32 m0, s65, 102400
    ds_read_b128 a[128:131], v1 offset:49152
    v_mfma_f32_16x16x32_bf16 v[80:83], v[14:17], v[96:99], v[84:87]
    ds_read_b128 a[136:139], v1 offset:51200
    buffer_load_dwordx4 v9, s[4:7], s64 offen offset:0 lds
    v_mfma_f32_16x16x32_bf16 v[52:55], a[132:135], v[128:131], v[72:75]
    v_exp_f32 v10, v44
    v_mfma_f32_16x16x32_bf16 v[52:55], a[140:143], v[132:135], v[52:55]
    v_cvt_pk_bf16_f32 v101, v12, v13
    v_mfma_f32_16x16x32_bf16 v[52:55], a[148:151], v[136:139], v[52:55]
    v_exp_f32 v11, v45
    v_mfma_f32_16x16x32_bf16 v[52:55], a[156:159], v[140:143], v[52:55]
    ds_read_b128 a[144:147], v1 offset:53248
    v_mfma_f32_16x16x32_bf16 v[60:63], a[132:135], v[144:147], v[76:79]
    v_exp_f32 v12, v46
    v_mfma_f32_16x16x32_bf16 v[60:63], a[140:143], v[148:151], v[60:63]
    v_cvt_pk_bf16_f32 v102, v10, v11
    v_mfma_f32_16x16x32_bf16 v[60:63], a[148:151], v[152:155], v[60:63]
    v_exp_f32 v13, v47
    v_mfma_f32_16x16x32_bf16 v[60:63], a[156:159], v[156:159], v[60:63]
    ds_read_b128 a[152:155], v1 offset:55296
    v_mfma_f32_16x16x32_bf16 a[64:67], a[192:195], v[120:123], a[64:67]
    v_exp_f32 v10, v48
    v_mfma_f32_16x16x32_bf16 a[96:99], a[192:195], v[124:127], a[96:99]
    v_cvt_pk_bf16_f32 v103, v12, v13
    v_mfma_f32_16x16x32_bf16 a[68:71], a[196:199], v[120:123], a[68:71]
    v_exp_f32 v11, v49
    v_mfma_f32_16x16x32_bf16 a[100:103], a[196:199], v[124:127], a[100:103]
    ds_read_b128 a[132:135], v1 offset:50176
    v_mfma_f32_16x16x32_bf16 v[80:83], v[18:21], v[100:103], v[80:83]
    ds_read_b128 a[140:143], v1 offset:52224
    v_mfma_f32_16x16x32_bf16 a[72:75], a[200:203], v[120:123], a[72:75]
    v_exp_f32 v12, v50
    v_mfma_f32_16x16x32_bf16 a[104:107], a[200:203], v[124:127], a[104:107]
    buffer_load_dwordx4 v9, s[4:7], s64 offen offset:1024 lds
    v_cvt_pk_bf16_f32 v104, v10, v11
    v_mfma_f32_16x16x32_bf16 a[76:79], a[204:207], v[120:123], a[76:79]
    v_exp_f32 v13, v51
    v_mfma_f32_16x16x32_bf16 a[108:111], a[204:207], v[124:127], a[108:111]
    ds_read_b128 a[148:151], v1 offset:54272
    v_mfma_f32_16x16x32_bf16 a[80:83], a[208:211], v[120:123], a[80:83]
    v_exp_f32 v10, v52
    v_mfma_f32_16x16x32_bf16 a[112:115], a[208:211], v[124:127], a[112:115]
    v_cvt_pk_bf16_f32 v105, v12, v13
    v_mfma_f32_16x16x32_bf16 a[84:87], a[212:215], v[120:123], a[84:87]
    v_exp_f32 v11, v53
    v_mfma_f32_16x16x32_bf16 a[116:119], a[212:215], v[124:127], a[116:119]
    ds_read_b128 a[156:159], v1 offset:56320
    v_cmp_nge_f32 vcc, s66, v82
    v_mfma_f32_16x16x32_bf16 a[88:91], a[216:219], v[120:123], a[88:91]
    v_exp_f32 v12, v54
    v_mfma_f32_16x16x32_bf16 a[120:123], a[216:219], v[124:127], a[120:123]
    v_cvt_pk_bf16_f32 v106, v10, v11
    v_mfma_f32_16x16x32_bf16 a[92:95], a[220:223], v[120:123], a[92:95]
    v_exp_f32 v13, v55
    v_mfma_f32_16x16x32_bf16 a[124:127], a[220:223], v[124:127], a[124:127]
    s_waitcnt lgkmcnt(4)
    s_cbranch_vccnz L_tramp34
L_ret34:
    v_mfma_f32_16x16x32_bf16 v[32:35], a[128:131], a[224:227], v[64:67]
    v_exp_f32 v10, v56
    v_mfma_f32_16x16x32_bf16 v[32:35], a[136:139], a[228:231], v[32:35]
    v_cvt_pk_bf16_f32 v107, v12, v13
    v_mfma_f32_16x16x32_bf16 v[32:35], a[144:147], a[232:235], v[32:35]
    v_exp_f32 v11, v57
    v_mfma_f32_16x16x32_bf16 v[32:35], a[152:155], a[236:239], v[32:35]
    ds_read_b128 a[192:195], v1 offset:57344
    v_mfma_f32_16x16x32_bf16 v[40:43], a[128:131], a[240:243], v[68:71]
    v_exp_f32 v12, v58
    v_mfma_f32_16x16x32_bf16 v[40:43], a[136:139], a[244:247], v[40:43]
    v_cvt_pk_bf16_f32 v108, v10, v11
    v_mfma_f32_16x16x32_bf16 v[40:43], a[144:147], a[248:251], v[40:43]
    v_exp_f32 v13, v59
    v_mfma_f32_16x16x32_bf16 v[40:43], a[152:155], a[252:255], v[40:43]
    ds_read_b128 a[196:199], v1 offset:58368
    v_mfma_f32_16x16x32_bf16 v[88:91], v[14:17], v[104:107], v[92:95]
    s_waitcnt lgkmcnt(2)
    buffer_load_dwordx4 v9, s[4:7], s64 offen offset:2048 lds
    v_mfma_f32_16x16x32_bf16 v[36:39], a[132:135], a[224:227], v[64:67]
    v_exp_f32 v10, v60
    v_mfma_f32_16x16x32_bf16 v[36:39], a[140:143], a[228:231], v[36:39]
    v_cvt_pk_bf16_f32 v109, v12, v13
    v_mfma_f32_16x16x32_bf16 v[36:39], a[148:151], a[232:235], v[36:39]
    v_exp_f32 v11, v61
    v_mfma_f32_16x16x32_bf16 v[36:39], a[156:159], a[236:239], v[36:39]
    ds_read_b128 a[200:203], v1 offset:59392
    v_mfma_f32_16x16x32_bf16 v[44:47], a[132:135], a[240:243], v[68:71]
    v_exp_f32 v12, v62
    v_mfma_f32_16x16x32_bf16 v[44:47], a[140:143], a[244:247], v[44:47]
    v_cvt_pk_bf16_f32 v110, v10, v11
    v_mfma_f32_16x16x32_bf16 v[44:47], a[148:151], a[248:251], v[44:47]
    v_exp_f32 v13, v63
    v_mfma_f32_16x16x32_bf16 v[44:47], a[156:159], a[252:255], v[44:47]
    ds_read_b128 a[204:207], v1 offset:60416
    v_mfma_f32_16x16x32_bf16 a[0:3], a[160:163], v[96:99], a[0:3]
    v_exp_f32 v10, v32
    v_mfma_f32_16x16x32_bf16 a[32:35], a[160:163], v[100:103], a[32:35]
    v_cvt_pk_bf16_f32 v111, v12, v13
    v_mfma_f32_16x16x32_bf16 a[4:7], a[164:167], v[96:99], a[4:7]
    v_exp_f32 v11, v33
    v_mfma_f32_16x16x32_bf16 a[36:39], a[164:167], v[100:103], a[36:39]
    ds_read_b128 a[208:211], v1 offset:61440
    v_mfma_f32_16x16x32_bf16 v[88:91], v[18:21], v[108:111], v[88:91]
    ds_read_b128 a[220:223], v1 offset:64512
    v_mfma_f32_16x16x32_bf16 a[8:11], a[168:171], v[96:99], a[8:11]
    v_exp_f32 v12, v34
    v_mfma_f32_16x16x32_bf16 a[40:43], a[168:171], v[100:103], a[40:43]
    buffer_load_dwordx4 v9, s[4:7], s64 offen offset:3072 lds
    v_cvt_pk_bf16_f32 v112, v10, v11
    v_mfma_f32_16x16x32_bf16 a[12:15], a[172:175], v[96:99], a[12:15]
    v_exp_f32 v13, v35
    v_mfma_f32_16x16x32_bf16 a[44:47], a[172:175], v[100:103], a[44:47]
    ds_read_b128 a[212:215], v1 offset:62464
    v_mfma_f32_16x16x32_bf16 a[16:19], a[176:179], v[96:99], a[16:19]
    v_exp_f32 v10, v36
    v_mfma_f32_16x16x32_bf16 a[48:51], a[176:179], v[100:103], a[48:51]
    v_cvt_pk_bf16_f32 v113, v12, v13
    v_mfma_f32_16x16x32_bf16 a[20:23], a[180:183], v[96:99], a[20:23]
    v_exp_f32 v11, v37
    v_mfma_f32_16x16x32_bf16 a[52:55], a[180:183], v[100:103], a[52:55]
    ds_read_b128 a[216:219], v1 offset:63488
    v_cmp_nge_f32 vcc, s66, v90
    v_mfma_f32_16x16x32_bf16 a[24:27], a[184:187], v[96:99], a[24:27]
    v_exp_f32 v12, v38
    v_mfma_f32_16x16x32_bf16 a[56:59], a[184:187], v[100:103], a[56:59]
    v_cvt_pk_bf16_f32 v114, v10, v11
    v_mfma_f32_16x16x32_bf16 a[28:31], a[188:191], v[96:99], a[28:31]
    v_exp_f32 v13, v39
    v_mfma_f32_16x16x32_bf16 a[60:63], a[188:191], v[100:103], a[60:63]
    s_cbranch_vccnz L_tramp35
L_ret35:
    v_mfma_f32_16x16x32_bf16 v[48:51], a[128:131], v[128:131], v[72:75]
    s_waitcnt vmcnt(8)
    v_exp_f32 v10, v40
    v_mfma_f32_16x16x32_bf16 v[48:51], a[136:139], v[132:135], v[48:51]
    s_barrier
    v_cvt_pk_bf16_f32 v115, v12, v13
    v_mfma_f32_16x16x32_bf16 v[48:51], a[144:147], v[136:139], v[48:51]
    v_exp_f32 v11, v41
    v_mfma_f32_16x16x32_bf16 v[48:51], a[152:155], v[140:143], v[48:51]
    v_mfma_f32_16x16x32_bf16 v[56:59], a[128:131], v[144:147], v[76:79]
    v_exp_f32 v12, v42
    v_mfma_f32_16x16x32_bf16 v[56:59], a[136:139], v[148:151], v[56:59]
    v_cvt_pk_bf16_f32 v116, v10, v11
    v_mfma_f32_16x16x32_bf16 v[56:59], a[144:147], v[152:155], v[56:59]
    s_add_u32 s64, s48, 0x18000
    v_exp_f32 v13, v43
    v_mfma_f32_16x16x32_bf16 v[56:59], a[152:155], v[156:159], v[56:59]
    s_add_u32 m0, s65, 0
    ds_read_b128 a[128:131], v2 offset:0
    v_mfma_f32_16x16x32_bf16 v[84:87], v[14:17], v[112:115], v[80:83]
    ds_read_b128 a[136:139], v2 offset:2048
    buffer_load_dwordx4 v3, s[4:7], s64 offen offset:0 lds
    v_mfma_f32_16x16x32_bf16 v[52:55], a[132:135], v[128:131], v[72:75]
    v_exp_f32 v10, v44
    v_mfma_f32_16x16x32_bf16 v[52:55], a[140:143], v[132:135], v[52:55]
    v_cvt_pk_bf16_f32 v117, v12, v13
    v_mfma_f32_16x16x32_bf16 v[52:55], a[148:151], v[136:139], v[52:55]
    v_exp_f32 v11, v45
    v_mfma_f32_16x16x32_bf16 v[52:55], a[156:159], v[140:143], v[52:55]
    ds_read_b128 a[144:147], v2 offset:4096
    v_mfma_f32_16x16x32_bf16 v[60:63], a[132:135], v[144:147], v[76:79]
    v_exp_f32 v12, v46
    v_mfma_f32_16x16x32_bf16 v[60:63], a[140:143], v[148:151], v[60:63]
    v_cvt_pk_bf16_f32 v118, v10, v11
    v_mfma_f32_16x16x32_bf16 v[60:63], a[148:151], v[152:155], v[60:63]
    v_exp_f32 v13, v47
    v_mfma_f32_16x16x32_bf16 v[60:63], a[156:159], v[156:159], v[60:63]
    ds_read_b128 a[152:155], v2 offset:6144
    v_mfma_f32_16x16x32_bf16 a[64:67], a[160:163], v[104:107], a[64:67]
    v_exp_f32 v10, v48
    v_mfma_f32_16x16x32_bf16 a[96:99], a[160:163], v[108:111], a[96:99]
    v_cvt_pk_bf16_f32 v119, v12, v13
    v_mfma_f32_16x16x32_bf16 a[68:71], a[164:167], v[104:107], a[68:71]
    v_exp_f32 v11, v49
    v_mfma_f32_16x16x32_bf16 a[100:103], a[164:167], v[108:111], a[100:103]
    ds_read_b128 a[132:135], v2 offset:1024
    v_mfma_f32_16x16x32_bf16 v[84:87], v[18:21], v[116:119], v[84:87]
    ds_read_b128 a[140:143], v2 offset:3072
    v_mfma_f32_16x16x32_bf16 a[72:75], a[168:171], v[104:107], a[72:75]
    v_exp_f32 v12, v50
    v_mfma_f32_16x16x32_bf16 a[104:107], a[168:171], v[108:111], a[104:107]
    buffer_load_dwordx4 v3, s[4:7], s64 offen offset:1024 lds
    v_cvt_pk_bf16_f32 v120, v10, v11
    v_mfma_f32_16x16x32_bf16 a[76:79], a[172:175], v[104:107], a[76:79]
    v_exp_f32 v13, v51
    v_mfma_f32_16x16x32_bf16 a[108:111], a[172:175], v[108:111], a[108:111]
    ds_read_b128 a[148:151], v2 offset:5120
    v_mfma_f32_16x16x32_bf16 a[80:83], a[176:179], v[104:107], a[80:83]
    v_exp_f32 v10, v52
    v_mfma_f32_16x16x32_bf16 a[112:115], a[176:179], v[108:111], a[112:115]
    v_cvt_pk_bf16_f32 v121, v12, v13
    v_mfma_f32_16x16x32_bf16 a[84:87], a[180:183], v[104:107], a[84:87]
    v_exp_f32 v11, v53
    v_mfma_f32_16x16x32_bf16 a[116:119], a[180:183], v[108:111], a[116:119]
    ds_read_b128 a[156:159], v2 offset:7168
    v_cmp_nge_f32 vcc, s66, v86
    v_mfma_f32_16x16x32_bf16 a[88:91], a[184:187], v[104:107], a[88:91]
    v_exp_f32 v12, v54
    v_mfma_f32_16x16x32_bf16 a[120:123], a[184:187], v[108:111], a[120:123]
    v_cvt_pk_bf16_f32 v122, v10, v11
    v_mfma_f32_16x16x32_bf16 a[92:95], a[188:191], v[104:107], a[92:95]
    v_exp_f32 v13, v55
    v_mfma_f32_16x16x32_bf16 a[124:127], a[188:191], v[108:111], a[124:127]
    s_waitcnt lgkmcnt(4)
    s_cbranch_vccnz L_tramp36
L_ret36:
    v_mfma_f32_16x16x32_bf16 v[32:35], a[128:131], a[224:227], v[64:67]
    v_exp_f32 v10, v56
    v_mfma_f32_16x16x32_bf16 v[32:35], a[136:139], a[228:231], v[32:35]
    v_cvt_pk_bf16_f32 v123, v12, v13
    v_mfma_f32_16x16x32_bf16 v[32:35], a[144:147], a[232:235], v[32:35]
    v_exp_f32 v11, v57
    v_mfma_f32_16x16x32_bf16 v[32:35], a[152:155], a[236:239], v[32:35]
    ds_read_b128 a[160:163], v2 offset:8192
    v_mfma_f32_16x16x32_bf16 v[40:43], a[128:131], a[240:243], v[68:71]
    v_exp_f32 v12, v58
    v_mfma_f32_16x16x32_bf16 v[40:43], a[136:139], a[244:247], v[40:43]
    v_cvt_pk_bf16_f32 v124, v10, v11
    v_mfma_f32_16x16x32_bf16 v[40:43], a[144:147], a[248:251], v[40:43]
    v_exp_f32 v13, v59
    v_mfma_f32_16x16x32_bf16 v[40:43], a[152:155], a[252:255], v[40:43]
    ds_read_b128 a[164:167], v2 offset:9216
    v_mfma_f32_16x16x32_bf16 v[92:95], v[14:17], v[120:123], v[88:91]
    s_waitcnt lgkmcnt(2)
    buffer_load_dwordx4 v3, s[4:7], s64 offen offset:2048 lds
    v_mfma_f32_16x16x32_bf16 v[36:39], a[132:135], a[224:227], v[64:67]
    v_exp_f32 v10, v60
    v_mfma_f32_16x16x32_bf16 v[36:39], a[140:143], a[228:231], v[36:39]
    v_cvt_pk_bf16_f32 v125, v12, v13
    v_mfma_f32_16x16x32_bf16 v[36:39], a[148:151], a[232:235], v[36:39]
    v_exp_f32 v11, v61
    v_mfma_f32_16x16x32_bf16 v[36:39], a[156:159], a[236:239], v[36:39]
    ds_read_b128 a[168:171], v2 offset:10240
    v_mfma_f32_16x16x32_bf16 v[44:47], a[132:135], a[240:243], v[68:71]
    v_exp_f32 v12, v62
    v_mfma_f32_16x16x32_bf16 v[44:47], a[140:143], a[244:247], v[44:47]
    v_cvt_pk_bf16_f32 v126, v10, v11
    v_mfma_f32_16x16x32_bf16 v[44:47], a[148:151], a[248:251], v[44:47]
    v_exp_f32 v13, v63
    v_mfma_f32_16x16x32_bf16 v[44:47], a[156:159], a[252:255], v[44:47]
    ds_read_b128 a[172:175], v2 offset:11264
    v_mfma_f32_16x16x32_bf16 a[0:3], a[192:195], v[112:115], a[0:3]
    v_exp_f32 v10, v32
    v_mfma_f32_16x16x32_bf16 a[32:35], a[192:195], v[116:119], a[32:35]
    v_cvt_pk_bf16_f32 v127, v12, v13
    v_mfma_f32_16x16x32_bf16 a[4:7], a[196:199], v[112:115], a[4:7]
    v_exp_f32 v11, v33
    v_mfma_f32_16x16x32_bf16 a[36:39], a[196:199], v[116:119], a[36:39]
    ds_read_b128 a[176:179], v2 offset:12288
    v_mfma_f32_16x16x32_bf16 v[92:95], v[18:21], v[124:127], v[92:95]
    ds_read_b128 a[188:191], v2 offset:15360
    v_mfma_f32_16x16x32_bf16 a[8:11], a[200:203], v[112:115], a[8:11]
    v_exp_f32 v12, v34
    v_mfma_f32_16x16x32_bf16 a[40:43], a[200:203], v[116:119], a[40:43]
    buffer_load_dwordx4 v3, s[4:7], s64 offen offset:3072 lds
    v_cvt_pk_bf16_f32 v96, v10, v11
    v_mfma_f32_16x16x32_bf16 a[12:15], a[204:207], v[112:115], a[12:15]
    v_exp_f32 v13, v35
    v_mfma_f32_16x16x32_bf16 a[44:47], a[204:207], v[116:119], a[44:47]
    ds_read_b128 a[180:183], v2 offset:13312
    v_mfma_f32_16x16x32_bf16 a[16:19], a[208:211], v[112:115], a[16:19]
    v_exp_f32 v10, v36
    v_mfma_f32_16x16x32_bf16 a[48:51], a[208:211], v[116:119], a[48:51]
    v_cvt_pk_bf16_f32 v97, v12, v13
    v_mfma_f32_16x16x32_bf16 a[20:23], a[212:215], v[112:115], a[20:23]
    v_exp_f32 v11, v37
    v_mfma_f32_16x16x32_bf16 a[52:55], a[212:215], v[116:119], a[52:55]
    ds_read_b128 a[184:187], v2 offset:14336
    v_cmp_nge_f32 vcc, s66, v94
    v_mfma_f32_16x16x32_bf16 a[24:27], a[216:219], v[112:115], a[24:27]
    v_exp_f32 v12, v38
    v_mfma_f32_16x16x32_bf16 a[56:59], a[216:219], v[116:119], a[56:59]
    v_cvt_pk_bf16_f32 v98, v10, v11
    v_mfma_f32_16x16x32_bf16 a[28:31], a[220:223], v[112:115], a[28:31]
    v_exp_f32 v13, v39
    v_mfma_f32_16x16x32_bf16 a[60:63], a[220:223], v[116:119], a[60:63]
    s_cbranch_vccnz L_tramp37
L_ret37:
    v_mfma_f32_16x16x32_bf16 v[48:51], a[128:131], v[128:131], v[72:75]
    v_exp_f32 v10, v40
    v_mfma_f32_16x16x32_bf16 v[48:51], a[136:139], v[132:135], v[48:51]
    v_cvt_pk_bf16_f32 v99, v12, v13
    v_mfma_f32_16x16x32_bf16 v[48:51], a[144:147], v[136:139], v[48:51]
    v_exp_f32 v11, v41
    v_mfma_f32_16x16x32_bf16 v[48:51], a[152:155], v[140:143], v[48:51]
    v_mfma_f32_16x16x32_bf16 v[56:59], a[128:131], v[144:147], v[76:79]
    v_exp_f32 v12, v42
    v_mfma_f32_16x16x32_bf16 v[56:59], a[136:139], v[148:151], v[56:59]
    v_cvt_pk_bf16_f32 v100, v10, v11
    v_mfma_f32_16x16x32_bf16 v[56:59], a[144:147], v[152:155], v[56:59]
    v_exp_f32 v13, v43
    v_mfma_f32_16x16x32_bf16 v[56:59], a[152:155], v[156:159], v[56:59]
    s_add_u32 m0, s65, 4096
    ds_read_b128 a[128:131], v2 offset:16384
    v_mfma_f32_16x16x32_bf16 v[80:83], v[14:17], v[96:99], v[84:87]
    ds_read_b128 a[136:139], v2 offset:18432
    buffer_load_dwordx4 v9, s[4:7], s64 offen offset:0 lds
    v_mfma_f32_16x16x32_bf16 v[52:55], a[132:135], v[128:131], v[72:75]
    v_exp_f32 v10, v44
    v_mfma_f32_16x16x32_bf16 v[52:55], a[140:143], v[132:135], v[52:55]
    v_cvt_pk_bf16_f32 v101, v12, v13
    v_mfma_f32_16x16x32_bf16 v[52:55], a[148:151], v[136:139], v[52:55]
    v_exp_f32 v11, v45
    v_mfma_f32_16x16x32_bf16 v[52:55], a[156:159], v[140:143], v[52:55]
    ds_read_b128 a[144:147], v2 offset:20480
    v_mfma_f32_16x16x32_bf16 v[60:63], a[132:135], v[144:147], v[76:79]
    v_exp_f32 v12, v46
    v_mfma_f32_16x16x32_bf16 v[60:63], a[140:143], v[148:151], v[60:63]
    v_cvt_pk_bf16_f32 v102, v10, v11
    v_mfma_f32_16x16x32_bf16 v[60:63], a[148:151], v[152:155], v[60:63]
    v_exp_f32 v13, v47
    v_mfma_f32_16x16x32_bf16 v[60:63], a[156:159], v[156:159], v[60:63]
    ds_read_b128 a[152:155], v2 offset:22528
    v_mfma_f32_16x16x32_bf16 a[64:67], a[192:195], v[120:123], a[64:67]
    v_exp_f32 v10, v48
    v_mfma_f32_16x16x32_bf16 a[96:99], a[192:195], v[124:127], a[96:99]
    v_cvt_pk_bf16_f32 v103, v12, v13
    v_mfma_f32_16x16x32_bf16 a[68:71], a[196:199], v[120:123], a[68:71]
    v_exp_f32 v11, v49
    v_mfma_f32_16x16x32_bf16 a[100:103], a[196:199], v[124:127], a[100:103]
    ds_read_b128 a[132:135], v2 offset:17408
    v_mfma_f32_16x16x32_bf16 v[80:83], v[18:21], v[100:103], v[80:83]
    ds_read_b128 a[140:143], v2 offset:19456
    v_mfma_f32_16x16x32_bf16 a[72:75], a[200:203], v[120:123], a[72:75]
    v_exp_f32 v12, v50
    v_mfma_f32_16x16x32_bf16 a[104:107], a[200:203], v[124:127], a[104:107]
    buffer_load_dwordx4 v9, s[4:7], s64 offen offset:1024 lds
    v_cvt_pk_bf16_f32 v104, v10, v11
    v_mfma_f32_16x16x32_bf16 a[76:79], a[204:207], v[120:123], a[76:79]
    v_exp_f32 v13, v51
    v_mfma_f32_16x16x32_bf16 a[108:111], a[204:207], v[124:127], a[108:111]
    ds_read_b128 a[148:151], v2 offset:21504
    v_mfma_f32_16x16x32_bf16 a[80:83], a[208:211], v[120:123], a[80:83]
    v_exp_f32 v10, v52
    v_mfma_f32_16x16x32_bf16 a[112:115], a[208:211], v[124:127], a[112:115]
    v_cvt_pk_bf16_f32 v105, v12, v13
    v_mfma_f32_16x16x32_bf16 a[84:87], a[212:215], v[120:123], a[84:87]
    v_exp_f32 v11, v53
    v_mfma_f32_16x16x32_bf16 a[116:119], a[212:215], v[124:127], a[116:119]
    ds_read_b128 a[156:159], v2 offset:23552
    v_cmp_nge_f32 vcc, s66, v82
    v_mfma_f32_16x16x32_bf16 a[88:91], a[216:219], v[120:123], a[88:91]
    v_exp_f32 v12, v54
    v_mfma_f32_16x16x32_bf16 a[120:123], a[216:219], v[124:127], a[120:123]
    v_cvt_pk_bf16_f32 v106, v10, v11
    v_mfma_f32_16x16x32_bf16 a[92:95], a[220:223], v[120:123], a[92:95]
    v_exp_f32 v13, v55
    v_mfma_f32_16x16x32_bf16 a[124:127], a[220:223], v[124:127], a[124:127]
    s_waitcnt lgkmcnt(4)
    s_cbranch_vccnz L_tramp38
L_ret38:
    v_mfma_f32_16x16x32_bf16 v[32:35], a[128:131], a[224:227], v[64:67]
    v_exp_f32 v10, v56
    v_mfma_f32_16x16x32_bf16 v[32:35], a[136:139], a[228:231], v[32:35]
    v_cvt_pk_bf16_f32 v107, v12, v13
    v_mfma_f32_16x16x32_bf16 v[32:35], a[144:147], a[232:235], v[32:35]
    v_exp_f32 v11, v57
    v_mfma_f32_16x16x32_bf16 v[32:35], a[152:155], a[236:239], v[32:35]
    ds_read_b128 a[192:195], v2 offset:24576
    v_mfma_f32_16x16x32_bf16 v[40:43], a[128:131], a[240:243], v[68:71]
    v_exp_f32 v12, v58
    v_mfma_f32_16x16x32_bf16 v[40:43], a[136:139], a[244:247], v[40:43]
    v_cvt_pk_bf16_f32 v108, v10, v11
    v_mfma_f32_16x16x32_bf16 v[40:43], a[144:147], a[248:251], v[40:43]
    v_exp_f32 v13, v59
    v_mfma_f32_16x16x32_bf16 v[40:43], a[152:155], a[252:255], v[40:43]
    ds_read_b128 a[196:199], v2 offset:25600
    v_mfma_f32_16x16x32_bf16 v[88:91], v[14:17], v[104:107], v[92:95]
    s_waitcnt lgkmcnt(2)
    buffer_load_dwordx4 v9, s[4:7], s64 offen offset:2048 lds
    v_mfma_f32_16x16x32_bf16 v[36:39], a[132:135], a[224:227], v[64:67]
    v_exp_f32 v10, v60
    v_mfma_f32_16x16x32_bf16 v[36:39], a[140:143], a[228:231], v[36:39]
    v_cvt_pk_bf16_f32 v109, v12, v13
    v_mfma_f32_16x16x32_bf16 v[36:39], a[148:151], a[232:235], v[36:39]
    v_exp_f32 v11, v61
    v_mfma_f32_16x16x32_bf16 v[36:39], a[156:159], a[236:239], v[36:39]
    ds_read_b128 a[200:203], v2 offset:26624
    v_mfma_f32_16x16x32_bf16 v[44:47], a[132:135], a[240:243], v[68:71]
    v_exp_f32 v12, v62
    v_mfma_f32_16x16x32_bf16 v[44:47], a[140:143], a[244:247], v[44:47]
    v_cvt_pk_bf16_f32 v110, v10, v11
    v_mfma_f32_16x16x32_bf16 v[44:47], a[148:151], a[248:251], v[44:47]
    v_exp_f32 v13, v63
    v_mfma_f32_16x16x32_bf16 v[44:47], a[156:159], a[252:255], v[44:47]
    ds_read_b128 a[204:207], v2 offset:27648
    v_mfma_f32_16x16x32_bf16 a[0:3], a[160:163], v[96:99], a[0:3]
    v_exp_f32 v10, v32
    v_mfma_f32_16x16x32_bf16 a[32:35], a[160:163], v[100:103], a[32:35]
    v_cvt_pk_bf16_f32 v111, v12, v13
    v_mfma_f32_16x16x32_bf16 a[4:7], a[164:167], v[96:99], a[4:7]
    v_exp_f32 v11, v33
    v_mfma_f32_16x16x32_bf16 a[36:39], a[164:167], v[100:103], a[36:39]
    ds_read_b128 a[208:211], v2 offset:28672
    v_mfma_f32_16x16x32_bf16 v[88:91], v[18:21], v[108:111], v[88:91]
    ds_read_b128 a[220:223], v2 offset:31744
    v_mfma_f32_16x16x32_bf16 a[8:11], a[168:171], v[96:99], a[8:11]
    v_exp_f32 v12, v34
    v_mfma_f32_16x16x32_bf16 a[40:43], a[168:171], v[100:103], a[40:43]
    buffer_load_dwordx4 v9, s[4:7], s64 offen offset:3072 lds
    v_cvt_pk_bf16_f32 v112, v10, v11
    v_mfma_f32_16x16x32_bf16 a[12:15], a[172:175], v[96:99], a[12:15]
    v_exp_f32 v13, v35
    v_mfma_f32_16x16x32_bf16 a[44:47], a[172:175], v[100:103], a[44:47]
    ds_read_b128 a[212:215], v2 offset:29696
    v_mfma_f32_16x16x32_bf16 a[16:19], a[176:179], v[96:99], a[16:19]
    v_exp_f32 v10, v36
    v_mfma_f32_16x16x32_bf16 a[48:51], a[176:179], v[100:103], a[48:51]
    v_cvt_pk_bf16_f32 v113, v12, v13
    v_mfma_f32_16x16x32_bf16 a[20:23], a[180:183], v[96:99], a[20:23]
    v_exp_f32 v11, v37
    v_mfma_f32_16x16x32_bf16 a[52:55], a[180:183], v[100:103], a[52:55]
    ds_read_b128 a[216:219], v2 offset:30720
    v_cmp_nge_f32 vcc, s66, v90
    v_mfma_f32_16x16x32_bf16 a[24:27], a[184:187], v[96:99], a[24:27]
    v_exp_f32 v12, v38
    v_mfma_f32_16x16x32_bf16 a[56:59], a[184:187], v[100:103], a[56:59]
    v_cvt_pk_bf16_f32 v114, v10, v11
    v_mfma_f32_16x16x32_bf16 a[28:31], a[188:191], v[96:99], a[28:31]
    v_exp_f32 v13, v39
    v_mfma_f32_16x16x32_bf16 a[60:63], a[188:191], v[100:103], a[60:63]
    s_cbranch_vccnz L_tramp39
L_ret39:
    v_mfma_f32_16x16x32_bf16 v[48:51], a[128:131], v[128:131], v[72:75]
    s_waitcnt vmcnt(8)
    v_exp_f32 v10, v40
    v_mfma_f32_16x16x32_bf16 v[48:51], a[136:139], v[132:135], v[48:51]
    s_barrier
    v_cvt_pk_bf16_f32 v115, v12, v13
    v_mfma_f32_16x16x32_bf16 v[48:51], a[144:147], v[136:139], v[48:51]
    v_exp_f32 v11, v41
    v_mfma_f32_16x16x32_bf16 v[48:51], a[152:155], v[140:143], v[48:51]
    v_mfma_f32_16x16x32_bf16 v[56:59], a[128:131], v[144:147], v[76:79]
    v_exp_f32 v12, v42
    v_mfma_f32_16x16x32_bf16 v[56:59], a[136:139], v[148:151], v[56:59]
    v_cvt_pk_bf16_f32 v116, v10, v11
    v_mfma_f32_16x16x32_bf16 v[56:59], a[144:147], v[152:155], v[56:59]
    s_add_u32 s64, s49, 0x18000
    v_exp_f32 v13, v43
    v_mfma_f32_16x16x32_bf16 v[56:59], a[152:155], v[156:159], v[56:59]
    s_add_u32 m0, s65, 32768
    ds_read_b128 a[128:131], v2 offset:32768
    v_mfma_f32_16x16x32_bf16 v[84:87], v[14:17], v[112:115], v[80:83]
    ds_read_b128 a[136:139], v2 offset:34816
    buffer_load_dwordx4 v3, s[4:7], s64 offen offset:0 lds
    v_mfma_f32_16x16x32_bf16 v[52:55], a[132:135], v[128:131], v[72:75]
    v_exp_f32 v10, v44
    v_mfma_f32_16x16x32_bf16 v[52:55], a[140:143], v[132:135], v[52:55]
    v_cvt_pk_bf16_f32 v117, v12, v13
    v_mfma_f32_16x16x32_bf16 v[52:55], a[148:151], v[136:139], v[52:55]
    v_exp_f32 v11, v45
    v_mfma_f32_16x16x32_bf16 v[52:55], a[156:159], v[140:143], v[52:55]
    ds_read_b128 a[144:147], v2 offset:36864
    v_mfma_f32_16x16x32_bf16 v[60:63], a[132:135], v[144:147], v[76:79]
    v_exp_f32 v12, v46
    v_mfma_f32_16x16x32_bf16 v[60:63], a[140:143], v[148:151], v[60:63]
    v_cvt_pk_bf16_f32 v118, v10, v11
    v_mfma_f32_16x16x32_bf16 v[60:63], a[148:151], v[152:155], v[60:63]
    v_exp_f32 v13, v47
    v_mfma_f32_16x16x32_bf16 v[60:63], a[156:159], v[156:159], v[60:63]
    ds_read_b128 a[152:155], v2 offset:38912
    v_mfma_f32_16x16x32_bf16 a[64:67], a[160:163], v[104:107], a[64:67]
    v_exp_f32 v10, v48
    v_mfma_f32_16x16x32_bf16 a[96:99], a[160:163], v[108:111], a[96:99]
    v_cvt_pk_bf16_f32 v119, v12, v13
    v_mfma_f32_16x16x32_bf16 a[68:71], a[164:167], v[104:107], a[68:71]
    v_exp_f32 v11, v49
    v_mfma_f32_16x16x32_bf16 a[100:103], a[164:167], v[108:111], a[100:103]
    ds_read_b128 a[132:135], v2 offset:33792
    v_mfma_f32_16x16x32_bf16 v[84:87], v[18:21], v[116:119], v[84:87]
    ds_read_b128 a[140:143], v2 offset:35840
    v_mfma_f32_16x16x32_bf16 a[72:75], a[168:171], v[104:107], a[72:75]
    v_exp_f32 v12, v50
    v_mfma_f32_16x16x32_bf16 a[104:107], a[168:171], v[108:111], a[104:107]
    buffer_load_dwordx4 v3, s[4:7], s64 offen offset:1024 lds
    v_cvt_pk_bf16_f32 v120, v10, v11
    v_mfma_f32_16x16x32_bf16 a[76:79], a[172:175], v[104:107], a[76:79]
    v_exp_f32 v13, v51
    v_mfma_f32_16x16x32_bf16 a[108:111], a[172:175], v[108:111], a[108:111]
    ds_read_b128 a[148:151], v2 offset:37888
    v_mfma_f32_16x16x32_bf16 a[80:83], a[176:179], v[104:107], a[80:83]
    v_exp_f32 v10, v52
    v_mfma_f32_16x16x32_bf16 a[112:115], a[176:179], v[108:111], a[112:115]
    v_cvt_pk_bf16_f32 v121, v12, v13
    v_mfma_f32_16x16x32_bf16 a[84:87], a[180:183], v[104:107], a[84:87]
    v_exp_f32 v11, v53
    v_mfma_f32_16x16x32_bf16 a[116:119], a[180:183], v[108:111], a[116:119]
    ds_read_b128 a[156:159], v2 offset:39936
    v_cmp_nge_f32 vcc, s66, v86
    v_mfma_f32_16x16x32_bf16 a[88:91], a[184:187], v[104:107], a[88:91]
    v_exp_f32 v12, v54
    v_mfma_f32_16x16x32_bf16 a[120:123], a[184:187], v[108:111], a[120:123]
    v_cvt_pk_bf16_f32 v122, v10, v11
    v_mfma_f32_16x16x32_bf16 a[92:95], a[188:191], v[104:107], a[92:95]
    v_exp_f32 v13, v55
    v_mfma_f32_16x16x32_bf16 a[124:127], a[188:191], v[108:111], a[124:127]
    s_waitcnt lgkmcnt(4)
    s_cbranch_vccnz L_tramp40
L_ret40:
    v_mfma_f32_16x16x32_bf16 v[32:35], a[128:131], a[224:227], v[64:67]
    v_exp_f32 v10, v56
    v_mfma_f32_16x16x32_bf16 v[32:35], a[136:139], a[228:231], v[32:35]
    v_cvt_pk_bf16_f32 v123, v12, v13
    v_mfma_f32_16x16x32_bf16 v[32:35], a[144:147], a[232:235], v[32:35]
    v_exp_f32 v11, v57
    v_mfma_f32_16x16x32_bf16 v[32:35], a[152:155], a[236:239], v[32:35]
    ds_read_b128 a[160:163], v2 offset:40960
    v_mfma_f32_16x16x32_bf16 v[40:43], a[128:131], a[240:243], v[68:71]
    v_exp_f32 v12, v58
    v_mfma_f32_16x16x32_bf16 v[40:43], a[136:139], a[244:247], v[40:43]
    v_cvt_pk_bf16_f32 v124, v10, v11
    v_mfma_f32_16x16x32_bf16 v[40:43], a[144:147], a[248:251], v[40:43]
    v_exp_f32 v13, v59
    v_mfma_f32_16x16x32_bf16 v[40:43], a[152:155], a[252:255], v[40:43]
    ds_read_b128 a[164:167], v2 offset:41984
    v_mfma_f32_16x16x32_bf16 v[92:95], v[14:17], v[120:123], v[88:91]
    s_waitcnt lgkmcnt(2)
    buffer_load_dwordx4 v3, s[4:7], s64 offen offset:2048 lds
    v_mfma_f32_16x16x32_bf16 v[36:39], a[132:135], a[224:227], v[64:67]
    v_exp_f32 v10, v60
    v_mfma_f32_16x16x32_bf16 v[36:39], a[140:143], a[228:231], v[36:39]
    v_cvt_pk_bf16_f32 v125, v12, v13
    v_mfma_f32_16x16x32_bf16 v[36:39], a[148:151], a[232:235], v[36:39]
    v_exp_f32 v11, v61
    v_mfma_f32_16x16x32_bf16 v[36:39], a[156:159], a[236:239], v[36:39]
    ds_read_b128 a[168:171], v2 offset:43008
    v_mfma_f32_16x16x32_bf16 v[44:47], a[132:135], a[240:243], v[68:71]
    v_exp_f32 v12, v62
    v_mfma_f32_16x16x32_bf16 v[44:47], a[140:143], a[244:247], v[44:47]
    v_cvt_pk_bf16_f32 v126, v10, v11
    v_mfma_f32_16x16x32_bf16 v[44:47], a[148:151], a[248:251], v[44:47]
    v_exp_f32 v13, v63
    v_mfma_f32_16x16x32_bf16 v[44:47], a[156:159], a[252:255], v[44:47]
    ds_read_b128 a[172:175], v2 offset:44032
    v_mfma_f32_16x16x32_bf16 a[0:3], a[192:195], v[112:115], a[0:3]
    v_exp_f32 v10, v32
    v_mfma_f32_16x16x32_bf16 a[32:35], a[192:195], v[116:119], a[32:35]
    v_cvt_pk_bf16_f32 v127, v12, v13
    v_mfma_f32_16x16x32_bf16 a[4:7], a[196:199], v[112:115], a[4:7]
    v_exp_f32 v11, v33
    v_mfma_f32_16x16x32_bf16 a[36:39], a[196:199], v[116:119], a[36:39]
    ds_read_b128 a[176:179], v2 offset:45056
    v_mfma_f32_16x16x32_bf16 v[92:95], v[18:21], v[124:127], v[92:95]
    ds_read_b128 a[188:191], v2 offset:48128
    v_mfma_f32_16x16x32_bf16 a[8:11], a[200:203], v[112:115], a[8:11]
    v_exp_f32 v12, v34
    v_mfma_f32_16x16x32_bf16 a[40:43], a[200:203], v[116:119], a[40:43]
    buffer_load_dwordx4 v3, s[4:7], s64 offen offset:3072 lds
    v_cvt_pk_bf16_f32 v96, v10, v11
    v_mfma_f32_16x16x32_bf16 a[12:15], a[204:207], v[112:115], a[12:15]
    v_exp_f32 v13, v35
    v_mfma_f32_16x16x32_bf16 a[44:47], a[204:207], v[116:119], a[44:47]
    ds_read_b128 a[180:183], v2 offset:46080
    v_mfma_f32_16x16x32_bf16 a[16:19], a[208:211], v[112:115], a[16:19]
    v_exp_f32 v10, v36
    v_mfma_f32_16x16x32_bf16 a[48:51], a[208:211], v[116:119], a[48:51]
    v_cvt_pk_bf16_f32 v97, v12, v13
    v_mfma_f32_16x16x32_bf16 a[20:23], a[212:215], v[112:115], a[20:23]
    v_exp_f32 v11, v37
    v_mfma_f32_16x16x32_bf16 a[52:55], a[212:215], v[116:119], a[52:55]
    ds_read_b128 a[184:187], v2 offset:47104
    v_cmp_nge_f32 vcc, s66, v94
    v_mfma_f32_16x16x32_bf16 a[24:27], a[216:219], v[112:115], a[24:27]
    v_exp_f32 v12, v38
    v_mfma_f32_16x16x32_bf16 a[56:59], a[216:219], v[116:119], a[56:59]
    v_cvt_pk_bf16_f32 v98, v10, v11
    v_mfma_f32_16x16x32_bf16 a[28:31], a[220:223], v[112:115], a[28:31]
    v_exp_f32 v13, v39
    v_mfma_f32_16x16x32_bf16 a[60:63], a[220:223], v[116:119], a[60:63]
    s_cbranch_vccnz L_tramp41
L_ret41:
    v_mfma_f32_16x16x32_bf16 v[48:51], a[128:131], v[128:131], v[72:75]
    v_exp_f32 v10, v40
    v_mfma_f32_16x16x32_bf16 v[48:51], a[136:139], v[132:135], v[48:51]
    v_cvt_pk_bf16_f32 v99, v12, v13
    v_mfma_f32_16x16x32_bf16 v[48:51], a[144:147], v[136:139], v[48:51]
    v_exp_f32 v11, v41
    v_mfma_f32_16x16x32_bf16 v[48:51], a[152:155], v[140:143], v[48:51]
    v_mfma_f32_16x16x32_bf16 v[56:59], a[128:131], v[144:147], v[76:79]
    v_exp_f32 v12, v42
    v_mfma_f32_16x16x32_bf16 v[56:59], a[136:139], v[148:151], v[56:59]
    v_cvt_pk_bf16_f32 v100, v10, v11
    v_mfma_f32_16x16x32_bf16 v[56:59], a[144:147], v[152:155], v[56:59]
    v_exp_f32 v13, v43
    v_mfma_f32_16x16x32_bf16 v[56:59], a[152:155], v[156:159], v[56:59]
    s_add_u32 m0, s65, 36864
    ds_read_b128 a[128:131], v2 offset:49152
    v_mfma_f32_16x16x32_bf16 v[80:83], v[14:17], v[96:99], v[84:87]
    ds_read_b128 a[136:139], v2 offset:51200
    buffer_load_dwordx4 v9, s[4:7], s64 offen offset:0 lds
    v_mfma_f32_16x16x32_bf16 v[52:55], a[132:135], v[128:131], v[72:75]
    v_exp_f32 v10, v44
    v_mfma_f32_16x16x32_bf16 v[52:55], a[140:143], v[132:135], v[52:55]
    v_cvt_pk_bf16_f32 v101, v12, v13
    v_mfma_f32_16x16x32_bf16 v[52:55], a[148:151], v[136:139], v[52:55]
    v_exp_f32 v11, v45
    v_mfma_f32_16x16x32_bf16 v[52:55], a[156:159], v[140:143], v[52:55]
    ds_read_b128 a[144:147], v2 offset:53248
    v_mfma_f32_16x16x32_bf16 v[60:63], a[132:135], v[144:147], v[76:79]
    v_exp_f32 v12, v46
    v_mfma_f32_16x16x32_bf16 v[60:63], a[140:143], v[148:151], v[60:63]
    v_cvt_pk_bf16_f32 v102, v10, v11
    v_mfma_f32_16x16x32_bf16 v[60:63], a[148:151], v[152:155], v[60:63]
    v_exp_f32 v13, v47
    v_mfma_f32_16x16x32_bf16 v[60:63], a[156:159], v[156:159], v[60:63]
    ds_read_b128 a[152:155], v2 offset:55296
    v_mfma_f32_16x16x32_bf16 a[64:67], a[192:195], v[120:123], a[64:67]
    v_exp_f32 v10, v48
    v_mfma_f32_16x16x32_bf16 a[96:99], a[192:195], v[124:127], a[96:99]
    v_cvt_pk_bf16_f32 v103, v12, v13
    v_mfma_f32_16x16x32_bf16 a[68:71], a[196:199], v[120:123], a[68:71]
    v_exp_f32 v11, v49
    v_mfma_f32_16x16x32_bf16 a[100:103], a[196:199], v[124:127], a[100:103]
    ds_read_b128 a[132:135], v2 offset:50176
    v_mfma_f32_16x16x32_bf16 v[80:83], v[18:21], v[100:103], v[80:83]
    ds_read_b128 a[140:143], v2 offset:52224
    v_mfma_f32_16x16x32_bf16 a[72:75], a[200:203], v[120:123], a[72:75]
    v_exp_f32 v12, v50
    v_mfma_f32_16x16x32_bf16 a[104:107], a[200:203], v[124:127], a[104:107]
    buffer_load_dwordx4 v9, s[4:7], s64 offen offset:1024 lds
    v_cvt_pk_bf16_f32 v104, v10, v11
    v_mfma_f32_16x16x32_bf16 a[76:79], a[204:207], v[120:123], a[76:79]
    v_exp_f32 v13, v51
    v_mfma_f32_16x16x32_bf16 a[108:111], a[204:207], v[124:127], a[108:111]
    ds_read_b128 a[148:151], v2 offset:54272
    v_mfma_f32_16x16x32_bf16 a[80:83], a[208:211], v[120:123], a[80:83]
    v_exp_f32 v10, v52
    v_mfma_f32_16x16x32_bf16 a[112:115], a[208:211], v[124:127], a[112:115]
    v_cvt_pk_bf16_f32 v105, v12, v13
    v_mfma_f32_16x16x32_bf16 a[84:87], a[212:215], v[120:123], a[84:87]
    v_exp_f32 v11, v53
    v_mfma_f32_16x16x32_bf16 a[116:119], a[212:215], v[124:127], a[116:119]
    ds_read_b128 a[156:159], v2 offset:56320
    v_cmp_nge_f32 vcc, s66, v82
    v_mfma_f32_16x16x32_bf16 a[88:91], a[216:219], v[120:123], a[88:91]
    v_exp_f32 v12, v54
    v_mfma_f32_16x16x32_bf16 a[120:123], a[216:219], v[124:127], a[120:123]
    v_cvt_pk_bf16_f32 v106, v10, v11
    v_mfma_f32_16x16x32_bf16 a[92:95], a[220:223], v[120:123], a[92:95]
    v_exp_f32 v13, v55
    v_mfma_f32_16x16x32_bf16 a[124:127], a[220:223], v[124:127], a[124:127]
    s_waitcnt lgkmcnt(4)
    s_cbranch_vccnz L_tramp42
L_ret42:
    v_mfma_f32_16x16x32_bf16 v[32:35], a[128:131], a[224:227], v[64:67]
    v_exp_f32 v10, v56
    v_mfma_f32_16x16x32_bf16 v[32:35], a[136:139], a[228:231], v[32:35]
    v_cvt_pk_bf16_f32 v107, v12, v13
    v_mfma_f32_16x16x32_bf16 v[32:35], a[144:147], a[232:235], v[32:35]
    v_exp_f32 v11, v57
    v_mfma_f32_16x16x32_bf16 v[32:35], a[152:155], a[236:239], v[32:35]
    ds_read_b128 a[192:195], v2 offset:57344
    v_mfma_f32_16x16x32_bf16 v[40:43], a[128:131], a[240:243], v[68:71]
    v_exp_f32 v12, v58
    v_mfma_f32_16x16x32_bf16 v[40:43], a[136:139], a[244:247], v[40:43]
    v_cvt_pk_bf16_f32 v108, v10, v11
    v_mfma_f32_16x16x32_bf16 v[40:43], a[144:147], a[248:251], v[40:43]
    v_exp_f32 v13, v59
    v_mfma_f32_16x16x32_bf16 v[40:43], a[152:155], a[252:255], v[40:43]
    ds_read_b128 a[196:199], v2 offset:58368
    v_mfma_f32_16x16x32_bf16 v[88:91], v[14:17], v[104:107], v[92:95]
    s_waitcnt lgkmcnt(2)
    buffer_load_dwordx4 v9, s[4:7], s64 offen offset:2048 lds
    v_mfma_f32_16x16x32_bf16 v[36:39], a[132:135], a[224:227], v[64:67]
    v_exp_f32 v10, v60
    v_mfma_f32_16x16x32_bf16 v[36:39], a[140:143], a[228:231], v[36:39]
    v_cvt_pk_bf16_f32 v109, v12, v13
    v_mfma_f32_16x16x32_bf16 v[36:39], a[148:151], a[232:235], v[36:39]
    v_exp_f32 v11, v61
    v_mfma_f32_16x16x32_bf16 v[36:39], a[156:159], a[236:239], v[36:39]
    ds_read_b128 a[200:203], v2 offset:59392
    v_mfma_f32_16x16x32_bf16 v[44:47], a[132:135], a[240:243], v[68:71]
    v_exp_f32 v12, v62
    v_mfma_f32_16x16x32_bf16 v[44:47], a[140:143], a[244:247], v[44:47]
    v_cvt_pk_bf16_f32 v110, v10, v11
    v_mfma_f32_16x16x32_bf16 v[44:47], a[148:151], a[248:251], v[44:47]
    v_exp_f32 v13, v63
    v_mfma_f32_16x16x32_bf16 v[44:47], a[156:159], a[252:255], v[44:47]
    ds_read_b128 a[204:207], v2 offset:60416
    v_mfma_f32_16x16x32_bf16 a[0:3], a[160:163], v[96:99], a[0:3]
    v_exp_f32 v10, v32
    v_mfma_f32_16x16x32_bf16 a[32:35], a[160:163], v[100:103], a[32:35]
    v_cvt_pk_bf16_f32 v111, v12, v13
    v_mfma_f32_16x16x32_bf16 a[4:7], a[164:167], v[96:99], a[4:7]
    v_exp_f32 v11, v33
    v_mfma_f32_16x16x32_bf16 a[36:39], a[164:167], v[100:103], a[36:39]
    ds_read_b128 a[208:211], v2 offset:61440
    v_mfma_f32_16x16x32_bf16 v[88:91], v[18:21], v[108:111], v[88:91]
    ds_read_b128 a[220:223], v2 offset:64512
    v_mfma_f32_16x16x32_bf16 a[8:11], a[168:171], v[96:99], a[8:11]
    v_exp_f32 v12, v34
    v_mfma_f32_16x16x32_bf16 a[40:43], a[168:171], v[100:103], a[40:43]
    buffer_load_dwordx4 v9, s[4:7], s64 offen offset:3072 lds
    v_cvt_pk_bf16_f32 v112, v10, v11
    v_mfma_f32_16x16x32_bf16 a[12:15], a[172:175], v[96:99], a[12:15]
    v_exp_f32 v13, v35
    v_mfma_f32_16x16x32_bf16 a[44:47], a[172:175], v[100:103], a[44:47]
    ds_read_b128 a[212:215], v2 offset:62464
    v_mfma_f32_16x16x32_bf16 a[16:19], a[176:179], v[96:99], a[16:19]
    v_exp_f32 v10, v36
    v_mfma_f32_16x16x32_bf16 a[48:51], a[176:179], v[100:103], a[48:51]
    v_cvt_pk_bf16_f32 v113, v12, v13
    v_mfma_f32_16x16x32_bf16 a[20:23], a[180:183], v[96:99], a[20:23]
    v_exp_f32 v11, v37
    v_mfma_f32_16x16x32_bf16 a[52:55], a[180:183], v[100:103], a[52:55]
    ds_read_b128 a[216:219], v2 offset:63488
    v_cmp_nge_f32 vcc, s66, v90
    v_mfma_f32_16x16x32_bf16 a[24:27], a[184:187], v[96:99], a[24:27]
    v_exp_f32 v12, v38
    v_mfma_f32_16x16x32_bf16 a[56:59], a[184:187], v[100:103], a[56:59]
    v_cvt_pk_bf16_f32 v114, v10, v11
    v_mfma_f32_16x16x32_bf16 a[28:31], a[188:191], v[96:99], a[28:31]
    v_exp_f32 v13, v39
    v_mfma_f32_16x16x32_bf16 a[60:63], a[188:191], v[100:103], a[60:63]
    s_cbranch_vccnz L_tramp43
L_ret43:
    v_mfma_f32_16x16x32_bf16 v[48:51], a[128:131], v[128:131], v[72:75]
    s_waitcnt vmcnt(8)
    v_exp_f32 v10, v40
    v_mfma_f32_16x16x32_bf16 v[48:51], a[136:139], v[132:135], v[48:51]
    s_barrier
    v_cvt_pk_bf16_f32 v115, v12, v13
    v_mfma_f32_16x16x32_bf16 v[48:51], a[144:147], v[136:139], v[48:51]
    v_exp_f32 v11, v41
    v_mfma_f32_16x16x32_bf16 v[48:51], a[152:155], v[140:143], v[48:51]
    v_mfma_f32_16x16x32_bf16 v[56:59], a[128:131], v[144:147], v[76:79]
    v_exp_f32 v12, v42
    v_mfma_f32_16x16x32_bf16 v[56:59], a[136:139], v[148:151], v[56:59]
    v_cvt_pk_bf16_f32 v116, v10, v11
    v_mfma_f32_16x16x32_bf16 v[56:59], a[144:147], v[152:155], v[56:59]
    s_add_u32 s64, s50, 0x18000
    v_exp_f32 v13, v43
    v_mfma_f32_16x16x32_bf16 v[56:59], a[152:155], v[156:159], v[56:59]
    s_add_u32 m0, s65, 65536
    ds_read_b128 a[128:131], v1 offset:0
    v_mfma_f32_16x16x32_bf16 v[84:87], v[14:17], v[112:115], v[80:83]
    ds_read_b128 a[136:139], v1 offset:2048
    buffer_load_dwordx4 v3, s[4:7], s64 offen offset:0 lds
    v_mfma_f32_16x16x32_bf16 v[52:55], a[132:135], v[128:131], v[72:75]
    v_exp_f32 v10, v44
    v_mfma_f32_16x16x32_bf16 v[52:55], a[140:143], v[132:135], v[52:55]
    v_cvt_pk_bf16_f32 v117, v12, v13
    v_mfma_f32_16x16x32_bf16 v[52:55], a[148:151], v[136:139], v[52:55]
    v_exp_f32 v11, v45
    v_mfma_f32_16x16x32_bf16 v[52:55], a[156:159], v[140:143], v[52:55]
    ds_read_b128 a[144:147], v1 offset:4096
    v_mfma_f32_16x16x32_bf16 v[60:63], a[132:135], v[144:147], v[76:79]
    v_exp_f32 v12, v46
    v_mfma_f32_16x16x32_bf16 v[60:63], a[140:143], v[148:151], v[60:63]
    v_cvt_pk_bf16_f32 v118, v10, v11
    v_mfma_f32_16x16x32_bf16 v[60:63], a[148:151], v[152:155], v[60:63]
    v_exp_f32 v13, v47
    v_mfma_f32_16x16x32_bf16 v[60:63], a[156:159], v[156:159], v[60:63]
    ds_read_b128 a[152:155], v1 offset:6144
    v_mfma_f32_16x16x32_bf16 a[64:67], a[160:163], v[104:107], a[64:67]
    v_exp_f32 v10, v48
    v_mfma_f32_16x16x32_bf16 a[96:99], a[160:163], v[108:111], a[96:99]
    v_cvt_pk_bf16_f32 v119, v12, v13
    v_mfma_f32_16x16x32_bf16 a[68:71], a[164:167], v[104:107], a[68:71]
    v_exp_f32 v11, v49
    v_mfma_f32_16x16x32_bf16 a[100:103], a[164:167], v[108:111], a[100:103]
    ds_read_b128 a[132:135], v1 offset:1024
    v_mfma_f32_16x16x32_bf16 v[84:87], v[18:21], v[116:119], v[84:87]
    ds_read_b128 a[140:143], v1 offset:3072
    v_mfma_f32_16x16x32_bf16 a[72:75], a[168:171], v[104:107], a[72:75]
    v_exp_f32 v12, v50
    v_mfma_f32_16x16x32_bf16 a[104:107], a[168:171], v[108:111], a[104:107]
    buffer_load_dwordx4 v3, s[4:7], s64 offen offset:1024 lds
    v_cvt_pk_bf16_f32 v120, v10, v11
    v_mfma_f32_16x16x32_bf16 a[76:79], a[172:175], v[104:107], a[76:79]
    v_exp_f32 v13, v51
    v_mfma_f32_16x16x32_bf16 a[108:111], a[172:175], v[108:111], a[108:111]
    ds_read_b128 a[148:151], v1 offset:5120
    v_mfma_f32_16x16x32_bf16 a[80:83], a[176:179], v[104:107], a[80:83]
    v_exp_f32 v10, v52
    v_mfma_f32_16x16x32_bf16 a[112:115], a[176:179], v[108:111], a[112:115]
    v_cvt_pk_bf16_f32 v121, v12, v13
    v_mfma_f32_16x16x32_bf16 a[84:87], a[180:183], v[104:107], a[84:87]
    v_exp_f32 v11, v53
    v_mfma_f32_16x16x32_bf16 a[116:119], a[180:183], v[108:111], a[116:119]
    ds_read_b128 a[156:159], v1 offset:7168
    v_cmp_nge_f32 vcc, s66, v86
    v_mfma_f32_16x16x32_bf16 a[88:91], a[184:187], v[104:107], a[88:91]
    v_exp_f32 v12, v54
    v_mfma_f32_16x16x32_bf16 a[120:123], a[184:187], v[108:111], a[120:123]
    v_cvt_pk_bf16_f32 v122, v10, v11
    v_mfma_f32_16x16x32_bf16 a[92:95], a[188:191], v[104:107], a[92:95]
    v_exp_f32 v13, v55
    v_mfma_f32_16x16x32_bf16 a[124:127], a[188:191], v[108:111], a[124:127]
    s_waitcnt lgkmcnt(4)
    s_cbranch_vccnz L_tramp44
L_ret44:
    v_mfma_f32_16x16x32_bf16 v[32:35], a[128:131], a[224:227], v[64:67]
    v_exp_f32 v10, v56
    v_mfma_f32_16x16x32_bf16 v[32:35], a[136:139], a[228:231], v[32:35]
    v_cvt_pk_bf16_f32 v123, v12, v13
    v_mfma_f32_16x16x32_bf16 v[32:35], a[144:147], a[232:235], v[32:35]
    v_exp_f32 v11, v57
    v_mfma_f32_16x16x32_bf16 v[32:35], a[152:155], a[236:239], v[32:35]
    ds_read_b128 a[160:163], v1 offset:8192
    v_mfma_f32_16x16x32_bf16 v[40:43], a[128:131], a[240:243], v[68:71]
    v_exp_f32 v12, v58
    v_mfma_f32_16x16x32_bf16 v[40:43], a[136:139], a[244:247], v[40:43]
    v_cvt_pk_bf16_f32 v124, v10, v11
    v_mfma_f32_16x16x32_bf16 v[40:43], a[144:147], a[248:251], v[40:43]
    v_exp_f32 v13, v59
    v_mfma_f32_16x16x32_bf16 v[40:43], a[152:155], a[252:255], v[40:43]
    ds_read_b128 a[164:167], v1 offset:9216
    v_mfma_f32_16x16x32_bf16 v[92:95], v[14:17], v[120:123], v[88:91]
    s_waitcnt lgkmcnt(2)
    buffer_load_dwordx4 v3, s[4:7], s64 offen offset:2048 lds
    v_mfma_f32_16x16x32_bf16 v[36:39], a[132:135], a[224:227], v[64:67]
    v_exp_f32 v10, v60
    v_mfma_f32_16x16x32_bf16 v[36:39], a[140:143], a[228:231], v[36:39]
    v_cvt_pk_bf16_f32 v125, v12, v13
    v_mfma_f32_16x16x32_bf16 v[36:39], a[148:151], a[232:235], v[36:39]
    v_exp_f32 v11, v61
    v_mfma_f32_16x16x32_bf16 v[36:39], a[156:159], a[236:239], v[36:39]
    ds_read_b128 a[168:171], v1 offset:10240
    v_mfma_f32_16x16x32_bf16 v[44:47], a[132:135], a[240:243], v[68:71]
    v_exp_f32 v12, v62
    v_mfma_f32_16x16x32_bf16 v[44:47], a[140:143], a[244:247], v[44:47]
    v_cvt_pk_bf16_f32 v126, v10, v11
    v_mfma_f32_16x16x32_bf16 v[44:47], a[148:151], a[248:251], v[44:47]
    v_exp_f32 v13, v63
    v_mfma_f32_16x16x32_bf16 v[44:47], a[156:159], a[252:255], v[44:47]
    ds_read_b128 a[172:175], v1 offset:11264
    v_mfma_f32_16x16x32_bf16 a[0:3], a[192:195], v[112:115], a[0:3]
    v_exp_f32 v10, v32
    v_mfma_f32_16x16x32_bf16 a[32:35], a[192:195], v[116:119], a[32:35]
    v_cvt_pk_bf16_f32 v127, v12, v13
    v_mfma_f32_16x16x32_bf16 a[4:7], a[196:199], v[112:115], a[4:7]
    v_exp_f32 v11, v33
    v_mfma_f32_16x16x32_bf16 a[36:39], a[196:199], v[116:119], a[36:39]
    ds_read_b128 a[176:179], v1 offset:12288
    v_mfma_f32_16x16x32_bf16 v[92:95], v[18:21], v[124:127], v[92:95]
    ds_read_b128 a[188:191], v1 offset:15360
    v_mfma_f32_16x16x32_bf16 a[8:11], a[200:203], v[112:115], a[8:11]
    v_exp_f32 v12, v34
    v_mfma_f32_16x16x32_bf16 a[40:43], a[200:203], v[116:119], a[40:43]
    buffer_load_dwordx4 v3, s[4:7], s64 offen offset:3072 lds
    v_cvt_pk_bf16_f32 v96, v10, v11
    v_mfma_f32_16x16x32_bf16 a[12:15], a[204:207], v[112:115], a[12:15]
    v_exp_f32 v13, v35
    v_mfma_f32_16x16x32_bf16 a[44:47], a[204:207], v[116:119], a[44:47]
    ds_read_b128 a[180:183], v1 offset:13312
    v_mfma_f32_16x16x32_bf16 a[16:19], a[208:211], v[112:115], a[16:19]
    v_exp_f32 v10, v36
    v_mfma_f32_16x16x32_bf16 a[48:51], a[208:211], v[116:119], a[48:51]
    v_cvt_pk_bf16_f32 v97, v12, v13
    v_mfma_f32_16x16x32_bf16 a[20:23], a[212:215], v[112:115], a[20:23]
    v_exp_f32 v11, v37
    v_mfma_f32_16x16x32_bf16 a[52:55], a[212:215], v[116:119], a[52:55]
    ds_read_b128 a[184:187], v1 offset:14336
    v_cmp_nge_f32 vcc, s66, v94
    v_mfma_f32_16x16x32_bf16 a[24:27], a[216:219], v[112:115], a[24:27]
    v_exp_f32 v12, v38
    v_mfma_f32_16x16x32_bf16 a[56:59], a[216:219], v[116:119], a[56:59]
    v_cvt_pk_bf16_f32 v98, v10, v11
    v_mfma_f32_16x16x32_bf16 a[28:31], a[220:223], v[112:115], a[28:31]
    v_exp_f32 v13, v39
    v_mfma_f32_16x16x32_bf16 a[60:63], a[220:223], v[116:119], a[60:63]
    s_cbranch_vccnz L_tramp45
L_ret45:
    v_mfma_f32_16x16x32_bf16 v[48:51], a[128:131], v[128:131], v[72:75]
    v_exp_f32 v10, v40
    v_mfma_f32_16x16x32_bf16 v[48:51], a[136:139], v[132:135], v[48:51]
    v_cvt_pk_bf16_f32 v99, v12, v13
    v_mfma_f32_16x16x32_bf16 v[48:51], a[144:147], v[136:139], v[48:51]
    v_exp_f32 v11, v41
    v_mfma_f32_16x16x32_bf16 v[48:51], a[152:155], v[140:143], v[48:51]
    v_mfma_f32_16x16x32_bf16 v[56:59], a[128:131], v[144:147], v[76:79]
    v_exp_f32 v12, v42
    v_mfma_f32_16x16x32_bf16 v[56:59], a[136:139], v[148:151], v[56:59]
    v_cvt_pk_bf16_f32 v100, v10, v11
    v_mfma_f32_16x16x32_bf16 v[56:59], a[144:147], v[152:155], v[56:59]
    v_exp_f32 v13, v43
    v_mfma_f32_16x16x32_bf16 v[56:59], a[152:155], v[156:159], v[56:59]
    s_add_u32 m0, s65, 69632
    ds_read_b128 a[128:131], v1 offset:16384
    v_mfma_f32_16x16x32_bf16 v[80:83], v[14:17], v[96:99], v[84:87]
    ds_read_b128 a[136:139], v1 offset:18432
    buffer_load_dwordx4 v9, s[4:7], s64 offen offset:0 lds
    v_mfma_f32_16x16x32_bf16 v[52:55], a[132:135], v[128:131], v[72:75]
    v_exp_f32 v10, v44
    v_mfma_f32_16x16x32_bf16 v[52:55], a[140:143], v[132:135], v[52:55]
    v_cvt_pk_bf16_f32 v101, v12, v13
    v_mfma_f32_16x16x32_bf16 v[52:55], a[148:151], v[136:139], v[52:55]
    v_exp_f32 v11, v45
    v_mfma_f32_16x16x32_bf16 v[52:55], a[156:159], v[140:143], v[52:55]
    ds_read_b128 a[144:147], v1 offset:20480
    v_mfma_f32_16x16x32_bf16 v[60:63], a[132:135], v[144:147], v[76:79]
    v_exp_f32 v12, v46
    v_mfma_f32_16x16x32_bf16 v[60:63], a[140:143], v[148:151], v[60:63]
    v_cvt_pk_bf16_f32 v102, v10, v11
    v_mfma_f32_16x16x32_bf16 v[60:63], a[148:151], v[152:155], v[60:63]
    v_exp_f32 v13, v47
    v_mfma_f32_16x16x32_bf16 v[60:63], a[156:159], v[156:159], v[60:63]
    ds_read_b128 a[152:155], v1 offset:22528
    v_mfma_f32_16x16x32_bf16 a[64:67], a[192:195], v[120:123], a[64:67]
    v_exp_f32 v10, v48
    v_mfma_f32_16x16x32_bf16 a[96:99], a[192:195], v[124:127], a[96:99]
    v_cvt_pk_bf16_f32 v103, v12, v13
    v_mfma_f32_16x16x32_bf16 a[68:71], a[196:199], v[120:123], a[68:71]
    v_exp_f32 v11, v49
    v_mfma_f32_16x16x32_bf16 a[100:103], a[196:199], v[124:127], a[100:103]
    ds_read_b128 a[132:135], v1 offset:17408
    v_mfma_f32_16x16x32_bf16 v[80:83], v[18:21], v[100:103], v[80:83]
    ds_read_b128 a[140:143], v1 offset:19456
    v_mfma_f32_16x16x32_bf16 a[72:75], a[200:203], v[120:123], a[72:75]
    v_exp_f32 v12, v50
    v_mfma_f32_16x16x32_bf16 a[104:107], a[200:203], v[124:127], a[104:107]
    buffer_load_dwordx4 v9, s[4:7], s64 offen offset:1024 lds
    v_cvt_pk_bf16_f32 v104, v10, v11
    v_mfma_f32_16x16x32_bf16 a[76:79], a[204:207], v[120:123], a[76:79]
    v_exp_f32 v13, v51
    v_mfma_f32_16x16x32_bf16 a[108:111], a[204:207], v[124:127], a[108:111]
    ds_read_b128 a[148:151], v1 offset:21504
    v_mfma_f32_16x16x32_bf16 a[80:83], a[208:211], v[120:123], a[80:83]
    v_exp_f32 v10, v52
    v_mfma_f32_16x16x32_bf16 a[112:115], a[208:211], v[124:127], a[112:115]
    v_cvt_pk_bf16_f32 v105, v12, v13
    v_mfma_f32_16x16x32_bf16 a[84:87], a[212:215], v[120:123], a[84:87]
    v_exp_f32 v11, v53
    v_mfma_f32_16x16x32_bf16 a[116:119], a[212:215], v[124:127], a[116:119]
    ds_read_b128 a[156:159], v1 offset:23552
    v_cmp_nge_f32 vcc, s66, v82
    v_mfma_f32_16x16x32_bf16 a[88:91], a[216:219], v[120:123], a[88:91]
    v_exp_f32 v12, v54
    v_mfma_f32_16x16x32_bf16 a[120:123], a[216:219], v[124:127], a[120:123]
    v_cvt_pk_bf16_f32 v106, v10, v11
    v_mfma_f32_16x16x32_bf16 a[92:95], a[220:223], v[120:123], a[92:95]
    v_exp_f32 v13, v55
    v_mfma_f32_16x16x32_bf16 a[124:127], a[220:223], v[124:127], a[124:127]
    s_waitcnt lgkmcnt(4)
    s_cbranch_vccnz L_tramp46
L_ret46:
    v_mfma_f32_16x16x32_bf16 v[32:35], a[128:131], a[224:227], v[64:67]
    v_exp_f32 v10, v56
    v_mfma_f32_16x16x32_bf16 v[32:35], a[136:139], a[228:231], v[32:35]
    v_cvt_pk_bf16_f32 v107, v12, v13
    v_mfma_f32_16x16x32_bf16 v[32:35], a[144:147], a[232:235], v[32:35]
    v_exp_f32 v11, v57
    v_mfma_f32_16x16x32_bf16 v[32:35], a[152:155], a[236:239], v[32:35]
    ds_read_b128 a[192:195], v1 offset:24576
    v_mfma_f32_16x16x32_bf16 v[40:43], a[128:131], a[240:243], v[68:71]
    v_exp_f32 v12, v58
    v_mfma_f32_16x16x32_bf16 v[40:43], a[136:139], a[244:247], v[40:43]
    v_cvt_pk_bf16_f32 v108, v10, v11
    v_mfma_f32_16x16x32_bf16 v[40:43], a[144:147], a[248:251], v[40:43]
    v_exp_f32 v13, v59
    v_mfma_f32_16x16x32_bf16 v[40:43], a[152:155], a[252:255], v[40:43]
    ds_read_b128 a[196:199], v1 offset:25600
    v_mfma_f32_16x16x32_bf16 v[88:91], v[14:17], v[104:107], v[92:95]
    s_waitcnt lgkmcnt(2)
    buffer_load_dwordx4 v9, s[4:7], s64 offen offset:2048 lds
    v_mfma_f32_16x16x32_bf16 v[36:39], a[132:135], a[224:227], v[64:67]
    v_exp_f32 v10, v60
    v_mfma_f32_16x16x32_bf16 v[36:39], a[140:143], a[228:231], v[36:39]
    v_cvt_pk_bf16_f32 v109, v12, v13
    v_mfma_f32_16x16x32_bf16 v[36:39], a[148:151], a[232:235], v[36:39]
    v_exp_f32 v11, v61
    v_mfma_f32_16x16x32_bf16 v[36:39], a[156:159], a[236:239], v[36:39]
    ds_read_b128 a[200:203], v1 offset:26624
    v_mfma_f32_16x16x32_bf16 v[44:47], a[132:135], a[240:243], v[68:71]
    v_exp_f32 v12, v62
    v_mfma_f32_16x16x32_bf16 v[44:47], a[140:143], a[244:247], v[44:47]
    v_cvt_pk_bf16_f32 v110, v10, v11
    v_mfma_f32_16x16x32_bf16 v[44:47], a[148:151], a[248:251], v[44:47]
    v_exp_f32 v13, v63
    v_mfma_f32_16x16x32_bf16 v[44:47], a[156:159], a[252:255], v[44:47]
    ds_read_b128 a[204:207], v1 offset:27648
    v_mfma_f32_16x16x32_bf16 a[0:3], a[160:163], v[96:99], a[0:3]
    v_exp_f32 v10, v32
    v_mfma_f32_16x16x32_bf16 a[32:35], a[160:163], v[100:103], a[32:35]
    v_cvt_pk_bf16_f32 v111, v12, v13
    v_mfma_f32_16x16x32_bf16 a[4:7], a[164:167], v[96:99], a[4:7]
    v_exp_f32 v11, v33
    v_mfma_f32_16x16x32_bf16 a[36:39], a[164:167], v[100:103], a[36:39]
    ds_read_b128 a[208:211], v1 offset:28672
    v_mfma_f32_16x16x32_bf16 v[88:91], v[18:21], v[108:111], v[88:91]
    ds_read_b128 a[220:223], v1 offset:31744
    v_mfma_f32_16x16x32_bf16 a[8:11], a[168:171], v[96:99], a[8:11]
    v_exp_f32 v12, v34
    v_mfma_f32_16x16x32_bf16 a[40:43], a[168:171], v[100:103], a[40:43]
    buffer_load_dwordx4 v9, s[4:7], s64 offen offset:3072 lds
    v_cvt_pk_bf16_f32 v112, v10, v11
    v_mfma_f32_16x16x32_bf16 a[12:15], a[172:175], v[96:99], a[12:15]
    v_exp_f32 v13, v35
    v_mfma_f32_16x16x32_bf16 a[44:47], a[172:175], v[100:103], a[44:47]
    ds_read_b128 a[212:215], v1 offset:29696
    v_mfma_f32_16x16x32_bf16 a[16:19], a[176:179], v[96:99], a[16:19]
    v_exp_f32 v10, v36
    v_mfma_f32_16x16x32_bf16 a[48:51], a[176:179], v[100:103], a[48:51]
    v_cvt_pk_bf16_f32 v113, v12, v13
    v_mfma_f32_16x16x32_bf16 a[20:23], a[180:183], v[96:99], a[20:23]
    v_exp_f32 v11, v37
    v_mfma_f32_16x16x32_bf16 a[52:55], a[180:183], v[100:103], a[52:55]
    ds_read_b128 a[216:219], v1 offset:30720
    v_cmp_nge_f32 vcc, s66, v90
    v_mfma_f32_16x16x32_bf16 a[24:27], a[184:187], v[96:99], a[24:27]
    v_exp_f32 v12, v38
    v_mfma_f32_16x16x32_bf16 a[56:59], a[184:187], v[100:103], a[56:59]
    v_cvt_pk_bf16_f32 v114, v10, v11
    v_mfma_f32_16x16x32_bf16 a[28:31], a[188:191], v[96:99], a[28:31]
    v_exp_f32 v13, v39
    v_mfma_f32_16x16x32_bf16 a[60:63], a[188:191], v[100:103], a[60:63]
    s_cbranch_vccnz L_tramp47
L_ret47:
    v_mfma_f32_16x16x32_bf16 v[48:51], a[128:131], v[128:131], v[72:75]
    s_waitcnt vmcnt(8)
    v_exp_f32 v10, v40
    v_mfma_f32_16x16x32_bf16 v[48:51], a[136:139], v[132:135], v[48:51]
    s_barrier
    v_cvt_pk_bf16_f32 v115, v12, v13
    v_mfma_f32_16x16x32_bf16 v[48:51], a[144:147], v[136:139], v[48:51]
    v_exp_f32 v11, v41
    v_mfma_f32_16x16x32_bf16 v[48:51], a[152:155], v[140:143], v[48:51]
    v_mfma_f32_16x16x32_bf16 v[56:59], a[128:131], v[144:147], v[76:79]
    v_exp_f32 v12, v42
    v_mfma_f32_16x16x32_bf16 v[56:59], a[136:139], v[148:151], v[56:59]
    v_cvt_pk_bf16_f32 v116, v10, v11
    v_mfma_f32_16x16x32_bf16 v[56:59], a[144:147], v[152:155], v[56:59]
    s_add_u32 s64, s51, 0x18000
    v_exp_f32 v13, v43
    v_mfma_f32_16x16x32_bf16 v[56:59], a[152:155], v[156:159], v[56:59]
    s_add_u32 m0, s65, 98304
    ds_read_b128 a[128:131], v1 offset:32768
    v_mfma_f32_16x16x32_bf16 v[84:87], v[14:17], v[112:115], v[80:83]
    ds_read_b128 a[136:139], v1 offset:34816
    buffer_load_dwordx4 v3, s[4:7], s64 offen offset:0 lds
    v_mfma_f32_16x16x32_bf16 v[52:55], a[132:135], v[128:131], v[72:75]
    v_exp_f32 v10, v44
    v_mfma_f32_16x16x32_bf16 v[52:55], a[140:143], v[132:135], v[52:55]
    v_cvt_pk_bf16_f32 v117, v12, v13
    v_mfma_f32_16x16x32_bf16 v[52:55], a[148:151], v[136:139], v[52:55]
    v_exp_f32 v11, v45
    v_mfma_f32_16x16x32_bf16 v[52:55], a[156:159], v[140:143], v[52:55]
    ds_read_b128 a[144:147], v1 offset:36864
    v_mfma_f32_16x16x32_bf16 v[60:63], a[132:135], v[144:147], v[76:79]
    v_exp_f32 v12, v46
    v_mfma_f32_16x16x32_bf16 v[60:63], a[140:143], v[148:151], v[60:63]
    v_cvt_pk_bf16_f32 v118, v10, v11
    v_mfma_f32_16x16x32_bf16 v[60:63], a[148:151], v[152:155], v[60:63]
    v_exp_f32 v13, v47
    v_mfma_f32_16x16x32_bf16 v[60:63], a[156:159], v[156:159], v[60:63]
    ds_read_b128 a[152:155], v1 offset:38912
    v_mfma_f32_16x16x32_bf16 a[64:67], a[160:163], v[104:107], a[64:67]
    v_exp_f32 v10, v48
    v_mfma_f32_16x16x32_bf16 a[96:99], a[160:163], v[108:111], a[96:99]
    v_cvt_pk_bf16_f32 v119, v12, v13
    v_mfma_f32_16x16x32_bf16 a[68:71], a[164:167], v[104:107], a[68:71]
    v_exp_f32 v11, v49
    v_mfma_f32_16x16x32_bf16 a[100:103], a[164:167], v[108:111], a[100:103]
    ds_read_b128 a[132:135], v1 offset:33792
    v_mfma_f32_16x16x32_bf16 v[84:87], v[18:21], v[116:119], v[84:87]
    ds_read_b128 a[140:143], v1 offset:35840
    v_mfma_f32_16x16x32_bf16 a[72:75], a[168:171], v[104:107], a[72:75]
    v_exp_f32 v12, v50
    v_mfma_f32_16x16x32_bf16 a[104:107], a[168:171], v[108:111], a[104:107]
    buffer_load_dwordx4 v3, s[4:7], s64 offen offset:1024 lds
    v_cvt_pk_bf16_f32 v120, v10, v11
    v_mfma_f32_16x16x32_bf16 a[76:79], a[172:175], v[104:107], a[76:79]
    v_exp_f32 v13, v51
    v_mfma_f32_16x16x32_bf16 a[108:111], a[172:175], v[108:111], a[108:111]
    ds_read_b128 a[148:151], v1 offset:37888
    v_mfma_f32_16x16x32_bf16 a[80:83], a[176:179], v[104:107], a[80:83]
    v_exp_f32 v10, v52
    v_mfma_f32_16x16x32_bf16 a[112:115], a[176:179], v[108:111], a[112:115]
    v_cvt_pk_bf16_f32 v121, v12, v13
    v_mfma_f32_16x16x32_bf16 a[84:87], a[180:183], v[104:107], a[84:87]
    v_exp_f32 v11, v53
    v_mfma_f32_16x16x32_bf16 a[116:119], a[180:183], v[108:111], a[116:119]
    ds_read_b128 a[156:159], v1 offset:39936
    v_cmp_nge_f32 vcc, s66, v86
    v_mfma_f32_16x16x32_bf16 a[88:91], a[184:187], v[104:107], a[88:91]
    v_exp_f32 v12, v54
    v_mfma_f32_16x16x32_bf16 a[120:123], a[184:187], v[108:111], a[120:123]
    v_cvt_pk_bf16_f32 v122, v10, v11
    v_mfma_f32_16x16x32_bf16 a[92:95], a[188:191], v[104:107], a[92:95]
    v_exp_f32 v13, v55
    v_mfma_f32_16x16x32_bf16 a[124:127], a[188:191], v[108:111], a[124:127]
    s_waitcnt lgkmcnt(4)
    s_cbranch_vccnz L_tramp48
L_ret48:
    v_mfma_f32_16x16x32_bf16 v[32:35], a[128:131], a[224:227], v[64:67]
    v_exp_f32 v10, v56
    v_mfma_f32_16x16x32_bf16 v[32:35], a[136:139], a[228:231], v[32:35]
    v_cvt_pk_bf16_f32 v123, v12, v13
    v_mfma_f32_16x16x32_bf16 v[32:35], a[144:147], a[232:235], v[32:35]
    v_exp_f32 v11, v57
    v_mfma_f32_16x16x32_bf16 v[32:35], a[152:155], a[236:239], v[32:35]
    ds_read_b128 a[160:163], v1 offset:40960
    v_mfma_f32_16x16x32_bf16 v[40:43], a[128:131], a[240:243], v[68:71]
    v_exp_f32 v12, v58
    v_mfma_f32_16x16x32_bf16 v[40:43], a[136:139], a[244:247], v[40:43]
    v_cvt_pk_bf16_f32 v124, v10, v11
    v_mfma_f32_16x16x32_bf16 v[40:43], a[144:147], a[248:251], v[40:43]
    v_exp_f32 v13, v59
    v_mfma_f32_16x16x32_bf16 v[40:43], a[152:155], a[252:255], v[40:43]
    ds_read_b128 a[164:167], v1 offset:41984
    v_mfma_f32_16x16x32_bf16 v[92:95], v[14:17], v[120:123], v[88:91]
    s_waitcnt lgkmcnt(2)
    buffer_load_dwordx4 v3, s[4:7], s64 offen offset:2048 lds
    v_mfma_f32_16x16x32_bf16 v[36:39], a[132:135], a[224:227], v[64:67]
    v_exp_f32 v10, v60
    v_mfma_f32_16x16x32_bf16 v[36:39], a[140:143], a[228:231], v[36:39]
    v_cvt_pk_bf16_f32 v125, v12, v13
    v_mfma_f32_16x16x32_bf16 v[36:39], a[148:151], a[232:235], v[36:39]
    v_exp_f32 v11, v61
    v_mfma_f32_16x16x32_bf16 v[36:39], a[156:159], a[236:239], v[36:39]
    ds_read_b128 a[168:171], v1 offset:43008
    v_mfma_f32_16x16x32_bf16 v[44:47], a[132:135], a[240:243], v[68:71]
    v_exp_f32 v12, v62
    v_mfma_f32_16x16x32_bf16 v[44:47], a[140:143], a[244:247], v[44:47]
    v_cvt_pk_bf16_f32 v126, v10, v11
    v_mfma_f32_16x16x32_bf16 v[44:47], a[148:151], a[248:251], v[44:47]
    v_exp_f32 v13, v63
    v_mfma_f32_16x16x32_bf16 v[44:47], a[156:159], a[252:255], v[44:47]
    ds_read_b128 a[172:175], v1 offset:44032
    v_mfma_f32_16x16x32_bf16 a[0:3], a[192:195], v[112:115], a[0:3]
    v_exp_f32 v10, v32
    v_mfma_f32_16x16x32_bf16 a[32:35], a[192:195], v[116:119], a[32:35]
    v_cvt_pk_bf16_f32 v127, v12, v13
    v_mfma_f32_16x16x32_bf16 a[4:7], a[196:199], v[112:115], a[4:7]
    v_exp_f32 v11, v33
    v_mfma_f32_16x16x32_bf16 a[36:39], a[196:199], v[116:119], a[36:39]
    ds_read_b128 a[176:179], v1 offset:45056
    v_mfma_f32_16x16x32_bf16 v[92:95], v[18:21], v[124:127], v[92:95]
    ds_read_b128 a[188:191], v1 offset:48128
    v_mfma_f32_16x16x32_bf16 a[8:11], a[200:203], v[112:115], a[8:11]
    v_exp_f32 v12, v34
    v_mfma_f32_16x16x32_bf16 a[40:43], a[200:203], v[116:119], a[40:43]
    buffer_load_dwordx4 v3, s[4:7], s64 offen offset:3072 lds
    v_cvt_pk_bf16_f32 v96, v10, v11
    v_mfma_f32_16x16x32_bf16 a[12:15], a[204:207], v[112:115], a[12:15]
    v_exp_f32 v13, v35
    v_mfma_f32_16x16x32_bf16 a[44:47], a[204:207], v[116:119], a[44:47]
    ds_read_b128 a[180:183], v1 offset:46080
    v_mfma_f32_16x16x32_bf16 a[16:19], a[208:211], v[112:115], a[16:19]
    v_exp_f32 v10, v36
    v_mfma_f32_16x16x32_bf16 a[48:51], a[208:211], v[116:119], a[48:51]
    v_cvt_pk_bf16_f32 v97, v12, v13
    v_mfma_f32_16x16x32_bf16 a[20:23], a[212:215], v[112:115], a[20:23]
    v_exp_f32 v11, v37
    v_mfma_f32_16x16x32_bf16 a[52:55], a[212:215], v[116:119], a[52:55]
    ds_read_b128 a[184:187], v1 offset:47104
    v_cmp_nge_f32 vcc, s66, v94
    v_mfma_f32_16x16x32_bf16 a[24:27], a[216:219], v[112:115], a[24:27]
    v_exp_f32 v12, v38
    v_mfma_f32_16x16x32_bf16 a[56:59], a[216:219], v[116:119], a[56:59]
    v_cvt_pk_bf16_f32 v98, v10, v11
    v_mfma_f32_16x16x32_bf16 a[28:31], a[220:223], v[112:115], a[28:31]
    v_exp_f32 v13, v39
    v_mfma_f32_16x16x32_bf16 a[60:63], a[220:223], v[116:119], a[60:63]
    s_cbranch_vccnz L_tramp49
L_ret49:
    v_mfma_f32_16x16x32_bf16 v[48:51], a[128:131], v[128:131], v[72:75]
    v_exp_f32 v10, v40
    v_mfma_f32_16x16x32_bf16 v[48:51], a[136:139], v[132:135], v[48:51]
    v_cvt_pk_bf16_f32 v99, v12, v13
    v_mfma_f32_16x16x32_bf16 v[48:51], a[144:147], v[136:139], v[48:51]
    v_exp_f32 v11, v41
    v_mfma_f32_16x16x32_bf16 v[48:51], a[152:155], v[140:143], v[48:51]
    v_mfma_f32_16x16x32_bf16 v[56:59], a[128:131], v[144:147], v[76:79]
    v_exp_f32 v12, v42
    v_mfma_f32_16x16x32_bf16 v[56:59], a[136:139], v[148:151], v[56:59]
    v_cvt_pk_bf16_f32 v100, v10, v11
    v_mfma_f32_16x16x32_bf16 v[56:59], a[144:147], v[152:155], v[56:59]
    v_exp_f32 v13, v43
    v_mfma_f32_16x16x32_bf16 v[56:59], a[152:155], v[156:159], v[56:59]
    s_add_u32 m0, s65, 102400
    ds_read_b128 a[128:131], v1 offset:49152
    v_mfma_f32_16x16x32_bf16 v[80:83], v[14:17], v[96:99], v[84:87]
    ds_read_b128 a[136:139], v1 offset:51200
    buffer_load_dwordx4 v9, s[4:7], s64 offen offset:0 lds
    v_mfma_f32_16x16x32_bf16 v[52:55], a[132:135], v[128:131], v[72:75]
    v_exp_f32 v10, v44
    v_mfma_f32_16x16x32_bf16 v[52:55], a[140:143], v[132:135], v[52:55]
    v_cvt_pk_bf16_f32 v101, v12, v13
    v_mfma_f32_16x16x32_bf16 v[52:55], a[148:151], v[136:139], v[52:55]
    v_exp_f32 v11, v45
    v_mfma_f32_16x16x32_bf16 v[52:55], a[156:159], v[140:143], v[52:55]
    ds_read_b128 a[144:147], v1 offset:53248
    v_mfma_f32_16x16x32_bf16 v[60:63], a[132:135], v[144:147], v[76:79]
    v_exp_f32 v12, v46
    v_mfma_f32_16x16x32_bf16 v[60:63], a[140:143], v[148:151], v[60:63]
    v_cvt_pk_bf16_f32 v102, v10, v11
    v_mfma_f32_16x16x32_bf16 v[60:63], a[148:151], v[152:155], v[60:63]
    v_exp_f32 v13, v47
    v_mfma_f32_16x16x32_bf16 v[60:63], a[156:159], v[156:159], v[60:63]
    ds_read_b128 a[152:155], v1 offset:55296
    v_mfma_f32_16x16x32_bf16 a[64:67], a[192:195], v[120:123], a[64:67]
    v_exp_f32 v10, v48
    v_mfma_f32_16x16x32_bf16 a[96:99], a[192:195], v[124:127], a[96:99]
    v_cvt_pk_bf16_f32 v103, v12, v13
    v_mfma_f32_16x16x32_bf16 a[68:71], a[196:199], v[120:123], a[68:71]
    v_exp_f32 v11, v49
    v_mfma_f32_16x16x32_bf16 a[100:103], a[196:199], v[124:127], a[100:103]
    ds_read_b128 a[132:135], v1 offset:50176
    v_mfma_f32_16x16x32_bf16 v[80:83], v[18:21], v[100:103], v[80:83]
    ds_read_b128 a[140:143], v1 offset:52224
    v_mfma_f32_16x16x32_bf16 a[72:75], a[200:203], v[120:123], a[72:75]
    v_exp_f32 v12, v50
    v_mfma_f32_16x16x32_bf16 a[104:107], a[200:203], v[124:127], a[104:107]
    buffer_load_dwordx4 v9, s[4:7], s64 offen offset:1024 lds
    v_cvt_pk_bf16_f32 v104, v10, v11
    v_mfma_f32_16x16x32_bf16 a[76:79], a[204:207], v[120:123], a[76:79]
    v_exp_f32 v13, v51
    v_mfma_f32_16x16x32_bf16 a[108:111], a[204:207], v[124:127], a[108:111]
    ds_read_b128 a[148:151], v1 offset:54272
    v_mfma_f32_16x16x32_bf16 a[80:83], a[208:211], v[120:123], a[80:83]
    v_exp_f32 v10, v52
    v_mfma_f32_16x16x32_bf16 a[112:115], a[208:211], v[124:127], a[112:115]
    v_cvt_pk_bf16_f32 v105, v12, v13
    v_mfma_f32_16x16x32_bf16 a[84:87], a[212:215], v[120:123], a[84:87]
    v_exp_f32 v11, v53
    v_mfma_f32_16x16x32_bf16 a[116:119], a[212:215], v[124:127], a[116:119]
    ds_read_b128 a[156:159], v1 offset:56320
    v_cmp_nge_f32 vcc, s66, v82
    v_mfma_f32_16x16x32_bf16 a[88:91], a[216:219], v[120:123], a[88:91]
    v_exp_f32 v12, v54
    v_mfma_f32_16x16x32_bf16 a[120:123], a[216:219], v[124:127], a[120:123]
    v_cvt_pk_bf16_f32 v106, v10, v11
    v_mfma_f32_16x16x32_bf16 a[92:95], a[220:223], v[120:123], a[92:95]
    v_exp_f32 v13, v55
    v_mfma_f32_16x16x32_bf16 a[124:127], a[220:223], v[124:127], a[124:127]
    s_waitcnt lgkmcnt(4)
    s_cbranch_vccnz L_tramp50
L_ret50:
    v_mfma_f32_16x16x32_bf16 v[32:35], a[128:131], a[224:227], v[64:67]
    v_exp_f32 v10, v56
    v_mfma_f32_16x16x32_bf16 v[32:35], a[136:139], a[228:231], v[32:35]
    v_cvt_pk_bf16_f32 v107, v12, v13
    v_mfma_f32_16x16x32_bf16 v[32:35], a[144:147], a[232:235], v[32:35]
    v_exp_f32 v11, v57
    v_mfma_f32_16x16x32_bf16 v[32:35], a[152:155], a[236:239], v[32:35]
    ds_read_b128 a[192:195], v1 offset:57344
    v_mfma_f32_16x16x32_bf16 v[40:43], a[128:131], a[240:243], v[68:71]
    v_exp_f32 v12, v58
    v_mfma_f32_16x16x32_bf16 v[40:43], a[136:139], a[244:247], v[40:43]
    v_cvt_pk_bf16_f32 v108, v10, v11
    v_mfma_f32_16x16x32_bf16 v[40:43], a[144:147], a[248:251], v[40:43]
    v_exp_f32 v13, v59
    v_mfma_f32_16x16x32_bf16 v[40:43], a[152:155], a[252:255], v[40:43]
    ds_read_b128 a[196:199], v1 offset:58368
    v_mfma_f32_16x16x32_bf16 v[88:91], v[14:17], v[104:107], v[92:95]
    s_waitcnt lgkmcnt(2)
    buffer_load_dwordx4 v9, s[4:7], s64 offen offset:2048 lds
    v_mfma_f32_16x16x32_bf16 v[36:39], a[132:135], a[224:227], v[64:67]
    v_exp_f32 v10, v60
    v_mfma_f32_16x16x32_bf16 v[36:39], a[140:143], a[228:231], v[36:39]
    v_cvt_pk_bf16_f32 v109, v12, v13
    v_mfma_f32_16x16x32_bf16 v[36:39], a[148:151], a[232:235], v[36:39]
    v_exp_f32 v11, v61
    v_mfma_f32_16x16x32_bf16 v[36:39], a[156:159], a[236:239], v[36:39]
    ds_read_b128 a[200:203], v1 offset:59392
    v_mfma_f32_16x16x32_bf16 v[44:47], a[132:135], a[240:243], v[68:71]
    v_exp_f32 v12, v62
    v_mfma_f32_16x16x32_bf16 v[44:47], a[140:143], a[244:247], v[44:47]
    v_cvt_pk_bf16_f32 v110, v10, v11
    v_mfma_f32_16x16x32_bf16 v[44:47], a[148:151], a[248:251], v[44:47]
    v_exp_f32 v13, v63
    v_mfma_f32_16x16x32_bf16 v[44:47], a[156:159], a[252:255], v[44:47]
    ds_read_b128 a[204:207], v1 offset:60416
    v_mfma_f32_16x16x32_bf16 a[0:3], a[160:163], v[96:99], a[0:3]
    v_exp_f32 v10, v32
    v_mfma_f32_16x16x32_bf16 a[32:35], a[160:163], v[100:103], a[32:35]
    v_cvt_pk_bf16_f32 v111, v12, v13
    v_mfma_f32_16x16x32_bf16 a[4:7], a[164:167], v[96:99], a[4:7]
    v_exp_f32 v11, v33
    v_mfma_f32_16x16x32_bf16 a[36:39], a[164:167], v[100:103], a[36:39]
    ds_read_b128 a[208:211], v1 offset:61440
    v_mfma_f32_16x16x32_bf16 v[88:91], v[18:21], v[108:111], v[88:91]
    ds_read_b128 a[220:223], v1 offset:64512
    v_mfma_f32_16x16x32_bf16 a[8:11], a[168:171], v[96:99], a[8:11]
    v_exp_f32 v12, v34
    v_mfma_f32_16x16x32_bf16 a[40:43], a[168:171], v[100:103], a[40:43]
    buffer_load_dwordx4 v9, s[4:7], s64 offen offset:3072 lds
    v_cvt_pk_bf16_f32 v112, v10, v11
    v_mfma_f32_16x16x32_bf16 a[12:15], a[172:175], v[96:99], a[12:15]
    v_exp_f32 v13, v35
    v_mfma_f32_16x16x32_bf16 a[44:47], a[172:175], v[100:103], a[44:47]
    ds_read_b128 a[212:215], v1 offset:62464
    v_mfma_f32_16x16x32_bf16 a[16:19], a[176:179], v[96:99], a[16:19]
    v_exp_f32 v10, v36
    v_mfma_f32_16x16x32_bf16 a[48:51], a[176:179], v[100:103], a[48:51]
    v_cvt_pk_bf16_f32 v113, v12, v13
    v_mfma_f32_16x16x32_bf16 a[20:23], a[180:183], v[96:99], a[20:23]
    v_exp_f32 v11, v37
    v_mfma_f32_16x16x32_bf16 a[52:55], a[180:183], v[100:103], a[52:55]
    ds_read_b128 a[216:219], v1 offset:63488
    v_cmp_nge_f32 vcc, s66, v90
    v_mfma_f32_16x16x32_bf16 a[24:27], a[184:187], v[96:99], a[24:27]
    v_exp_f32 v12, v38
    v_mfma_f32_16x16x32_bf16 a[56:59], a[184:187], v[100:103], a[56:59]
    v_cvt_pk_bf16_f32 v114, v10, v11
    v_mfma_f32_16x16x32_bf16 a[28:31], a[188:191], v[96:99], a[28:31]
    v_exp_f32 v13, v39
    v_mfma_f32_16x16x32_bf16 a[60:63], a[188:191], v[100:103], a[60:63]
    s_cbranch_vccnz L_tramp51
L_ret51:
    v_mfma_f32_16x16x32_bf16 v[48:51], a[128:131], v[128:131], v[72:75]
    s_waitcnt vmcnt(8)
    v_exp_f32 v10, v40
    v_mfma_f32_16x16x32_bf16 v[48:51], a[136:139], v[132:135], v[48:51]
    s_barrier
    v_cvt_pk_bf16_f32 v115, v12, v13
    v_mfma_f32_16x16x32_bf16 v[48:51], a[144:147], v[136:139], v[48:51]
    v_exp_f32 v11, v41
    v_mfma_f32_16x16x32_bf16 v[48:51], a[152:155], v[140:143], v[48:51]
    v_mfma_f32_16x16x32_bf16 v[56:59], a[128:131], v[144:147], v[76:79]
    v_exp_f32 v12, v42
    v_mfma_f32_16x16x32_bf16 v[56:59], a[136:139], v[148:151], v[56:59]
    v_cvt_pk_bf16_f32 v116, v10, v11
    v_mfma_f32_16x16x32_bf16 v[56:59], a[144:147], v[152:155], v[56:59]
    v_exp_f32 v13, v43
    v_mfma_f32_16x16x32_bf16 v[56:59], a[152:155], v[156:159], v[56:59]
    ds_read_b128 a[128:131], v2 offset:0
    v_mfma_f32_16x16x32_bf16 v[84:87], v[14:17], v[112:115], v[80:83]
    ds_read_b128 a[136:139], v2 offset:2048
    v_mfma_f32_16x16x32_bf16 v[52:55], a[132:135], v[128:131], v[72:75]
    v_exp_f32 v10, v44
    v_mfma_f32_16x16x32_bf16 v[52:55], a[140:143], v[132:135], v[52:55]
    v_cvt_pk_bf16_f32 v117, v12, v13
    v_mfma_f32_16x16x32_bf16 v[52:55], a[148:151], v[136:139], v[52:55]
    v_exp_f32 v11, v45
    v_mfma_f32_16x16x32_bf16 v[52:55], a[156:159], v[140:143], v[52:55]
    ds_read_b128 a[144:147], v2 offset:4096
    v_mfma_f32_16x16x32_bf16 v[60:63], a[132:135], v[144:147], v[76:79]
    v_exp_f32 v12, v46
    v_mfma_f32_16x16x32_bf16 v[60:63], a[140:143], v[148:151], v[60:63]
    v_cvt_pk_bf16_f32 v118, v10, v11
    v_mfma_f32_16x16x32_bf16 v[60:63], a[148:151], v[152:155], v[60:63]
    v_exp_f32 v13, v47
    v_mfma_f32_16x16x32_bf16 v[60:63], a[156:159], v[156:159], v[60:63]
    ds_read_b128 a[152:155], v2 offset:6144
    v_mfma_f32_16x16x32_bf16 a[64:67], a[160:163], v[104:107], a[64:67]
    v_exp_f32 v10, v48
    v_mfma_f32_16x16x32_bf16 a[96:99], a[160:163], v[108:111], a[96:99]
    v_cvt_pk_bf16_f32 v119, v12, v13
    v_mfma_f32_16x16x32_bf16 a[68:71], a[164:167], v[104:107], a[68:71]
    v_exp_f32 v11, v49
    v_mfma_f32_16x16x32_bf16 a[100:103], a[164:167], v[108:111], a[100:103]
    ds_read_b128 a[132:135], v2 offset:1024
    v_mfma_f32_16x16x32_bf16 v[84:87], v[18:21], v[116:119], v[84:87]
    ds_read_b128 a[140:143], v2 offset:3072
    v_mfma_f32_16x16x32_bf16 a[72:75], a[168:171], v[104:107], a[72:75]
    v_exp_f32 v12, v50
    v_mfma_f32_16x16x32_bf16 a[104:107], a[168:171], v[108:111], a[104:107]
    v_cvt_pk_bf16_f32 v120, v10, v11
    v_mfma_f32_16x16x32_bf16 a[76:79], a[172:175], v[104:107], a[76:79]
    v_exp_f32 v13, v51
    v_mfma_f32_16x16x32_bf16 a[108:111], a[172:175], v[108:111], a[108:111]
    ds_read_b128 a[148:151], v2 offset:5120
    v_mfma_f32_16x16x32_bf16 a[80:83], a[176:179], v[104:107], a[80:83]
    v_exp_f32 v10, v52
    v_mfma_f32_16x16x32_bf16 a[112:115], a[176:179], v[108:111], a[112:115]
    v_cvt_pk_bf16_f32 v121, v12, v13
    v_mfma_f32_16x16x32_bf16 a[84:87], a[180:183], v[104:107], a[84:87]
    v_exp_f32 v11, v53
    v_mfma_f32_16x16x32_bf16 a[116:119], a[180:183], v[108:111], a[116:119]
    ds_read_b128 a[156:159], v2 offset:7168
    v_cmp_nge_f32 vcc, s66, v86
    v_mfma_f32_16x16x32_bf16 a[88:91], a[184:187], v[104:107], a[88:91]
    v_exp_f32 v12, v54
    v_mfma_f32_16x16x32_bf16 a[120:123], a[184:187], v[108:111], a[120:123]
    v_cvt_pk_bf16_f32 v122, v10, v11
    v_mfma_f32_16x16x32_bf16 a[92:95], a[188:191], v[104:107], a[92:95]
    v_exp_f32 v13, v55
    v_mfma_f32_16x16x32_bf16 a[124:127], a[188:191], v[108:111], a[124:127]
    s_waitcnt lgkmcnt(4)
    s_cbranch_vccnz L_tramp52
L_ret52:
    v_mfma_f32_16x16x32_bf16 v[32:35], a[128:131], a[224:227], v[64:67]
    v_exp_f32 v10, v56
    v_mfma_f32_16x16x32_bf16 v[32:35], a[136:139], a[228:231], v[32:35]
    v_cvt_pk_bf16_f32 v123, v12, v13
    v_mfma_f32_16x16x32_bf16 v[32:35], a[144:147], a[232:235], v[32:35]
    v_exp_f32 v11, v57
    v_mfma_f32_16x16x32_bf16 v[32:35], a[152:155], a[236:239], v[32:35]
    ds_read_b128 a[160:163], v2 offset:8192
    v_mfma_f32_16x16x32_bf16 v[40:43], a[128:131], a[240:243], v[68:71]
    v_exp_f32 v12, v58
    v_mfma_f32_16x16x32_bf16 v[40:43], a[136:139], a[244:247], v[40:43]
    v_cvt_pk_bf16_f32 v124, v10, v11
    v_mfma_f32_16x16x32_bf16 v[40:43], a[144:147], a[248:251], v[40:43]
    v_exp_f32 v13, v59
    v_mfma_f32_16x16x32_bf16 v[40:43], a[152:155], a[252:255], v[40:43]
    ds_read_b128 a[164:167], v2 offset:9216
    v_mfma_f32_16x16x32_bf16 v[92:95], v[14:17], v[120:123], v[88:91]
    s_waitcnt lgkmcnt(2)
    v_mfma_f32_16x16x32_bf16 v[36:39], a[132:135], a[224:227], v[64:67]
    v_exp_f32 v10, v60
    v_mfma_f32_16x16x32_bf16 v[36:39], a[140:143], a[228:231], v[36:39]
    v_cvt_pk_bf16_f32 v125, v12, v13
    v_mfma_f32_16x16x32_bf16 v[36:39], a[148:151], a[232:235], v[36:39]
    v_exp_f32 v11, v61
    v_mfma_f32_16x16x32_bf16 v[36:39], a[156:159], a[236:239], v[36:39]
    ds_read_b128 a[168:171], v2 offset:10240
    v_mfma_f32_16x16x32_bf16 v[44:47], a[132:135], a[240:243], v[68:71]
    v_exp_f32 v12, v62
    v_mfma_f32_16x16x32_bf16 v[44:47], a[140:143], a[244:247], v[44:47]
    v_cvt_pk_bf16_f32 v126, v10, v11
    v_mfma_f32_16x16x32_bf16 v[44:47], a[148:151], a[248:251], v[44:47]
    v_exp_f32 v13, v63
    v_mfma_f32_16x16x32_bf16 v[44:47], a[156:159], a[252:255], v[44:47]
    ds_read_b128 a[172:175], v2 offset:11264
    v_mfma_f32_16x16x32_bf16 a[0:3], a[192:195], v[112:115], a[0:3]
    v_exp_f32 v10, v32
    v_mfma_f32_16x16x32_bf16 a[32:35], a[192:195], v[116:119], a[32:35]
    v_cvt_pk_bf16_f32 v127, v12, v13
    v_mfma_f32_16x16x32_bf16 a[4:7], a[196:199], v[112:115], a[4:7]
    v_exp_f32 v11, v33
    v_mfma_f32_16x16x32_bf16 a[36:39], a[196:199], v[116:119], a[36:39]
    ds_read_b128 a[176:179], v2 offset:12288
    v_mfma_f32_16x16x32_bf16 v[92:95], v[18:21], v[124:127], v[92:95]
    ds_read_b128 a[188:191], v2 offset:15360
    v_mfma_f32_16x16x32_bf16 a[8:11], a[200:203], v[112:115], a[8:11]
    v_exp_f32 v12, v34
    v_mfma_f32_16x16x32_bf16 a[40:43], a[200:203], v[116:119], a[40:43]
    v_cvt_pk_bf16_f32 v96, v10, v11
    v_mfma_f32_16x16x32_bf16 a[12:15], a[204:207], v[112:115], a[12:15]
    v_exp_f32 v13, v35
    v_mfma_f32_16x16x32_bf16 a[44:47], a[204:207], v[116:119], a[44:47]
    ds_read_b128 a[180:183], v2 offset:13312
    v_mfma_f32_16x16x32_bf16 a[16:19], a[208:211], v[112:115], a[16:19]
    v_exp_f32 v10, v36
    v_mfma_f32_16x16x32_bf16 a[48:51], a[208:211], v[116:119], a[48:51]
    v_cvt_pk_bf16_f32 v97, v12, v13
    v_mfma_f32_16x16x32_bf16 a[20:23], a[212:215], v[112:115], a[20:23]
    v_exp_f32 v11, v37
    v_mfma_f32_16x16x32_bf16 a[52:55], a[212:215], v[116:119], a[52:55]
    ds_read_b128 a[184:187], v2 offset:14336
    v_cmp_nge_f32 vcc, s66, v94
    v_mfma_f32_16x16x32_bf16 a[24:27], a[216:219], v[112:115], a[24:27]
    v_exp_f32 v12, v38
    v_mfma_f32_16x16x32_bf16 a[56:59], a[216:219], v[116:119], a[56:59]
    v_cvt_pk_bf16_f32 v98, v10, v11
    v_mfma_f32_16x16x32_bf16 a[28:31], a[220:223], v[112:115], a[28:31]
    v_exp_f32 v13, v39
    v_mfma_f32_16x16x32_bf16 a[60:63], a[220:223], v[116:119], a[60:63]
    s_cbranch_vccnz L_tramp53
L_ret53:
    v_mfma_f32_16x16x32_bf16 v[48:51], a[128:131], v[128:131], v[72:75]
    v_exp_f32 v10, v40
    v_mfma_f32_16x16x32_bf16 v[48:51], a[136:139], v[132:135], v[48:51]
    v_cvt_pk_bf16_f32 v99, v12, v13
    v_mfma_f32_16x16x32_bf16 v[48:51], a[144:147], v[136:139], v[48:51]
    v_exp_f32 v11, v41
    v_mfma_f32_16x16x32_bf16 v[48:51], a[152:155], v[140:143], v[48:51]
    v_mfma_f32_16x16x32_bf16 v[56:59], a[128:131], v[144:147], v[76:79]
    v_exp_f32 v12, v42
    v_mfma_f32_16x16x32_bf16 v[56:59], a[136:139], v[148:151], v[56:59]
    v_cvt_pk_bf16_f32 v100, v10, v11
    v_mfma_f32_16x16x32_bf16 v[56:59], a[144:147], v[152:155], v[56:59]
    v_exp_f32 v13, v43
    v_mfma_f32_16x16x32_bf16 v[56:59], a[152:155], v[156:159], v[56:59]
    ds_read_b128 a[128:131], v2 offset:16384
    v_mfma_f32_16x16x32_bf16 v[80:83], v[14:17], v[96:99], v[84:87]
    ds_read_b128 a[136:139], v2 offset:18432
    v_mfma_f32_16x16x32_bf16 v[52:55], a[132:135], v[128:131], v[72:75]
    v_exp_f32 v10, v44
    v_mfma_f32_16x16x32_bf16 v[52:55], a[140:143], v[132:135], v[52:55]
    v_cvt_pk_bf16_f32 v101, v12, v13
    v_mfma_f32_16x16x32_bf16 v[52:55], a[148:151], v[136:139], v[52:55]
    v_exp_f32 v11, v45
    v_mfma_f32_16x16x32_bf16 v[52:55], a[156:159], v[140:143], v[52:55]
    ds_read_b128 a[144:147], v2 offset:20480
    v_mfma_f32_16x16x32_bf16 v[60:63], a[132:135], v[144:147], v[76:79]
    v_exp_f32 v12, v46
    v_mfma_f32_16x16x32_bf16 v[60:63], a[140:143], v[148:151], v[60:63]
    v_cvt_pk_bf16_f32 v102, v10, v11
    v_mfma_f32_16x16x32_bf16 v[60:63], a[148:151], v[152:155], v[60:63]
    v_exp_f32 v13, v47
    v_mfma_f32_16x16x32_bf16 v[60:63], a[156:159], v[156:159], v[60:63]
    ds_read_b128 a[152:155], v2 offset:22528
    v_mfma_f32_16x16x32_bf16 a[64:67], a[192:195], v[120:123], a[64:67]
    v_exp_f32 v10, v48
    v_mfma_f32_16x16x32_bf16 a[96:99], a[192:195], v[124:127], a[96:99]
    v_cvt_pk_bf16_f32 v103, v12, v13
    v_mfma_f32_16x16x32_bf16 a[68:71], a[196:199], v[120:123], a[68:71]
    v_exp_f32 v11, v49
    v_mfma_f32_16x16x32_bf16 a[100:103], a[196:199], v[124:127], a[100:103]
    ds_read_b128 a[132:135], v2 offset:17408
    v_mfma_f32_16x16x32_bf16 v[80:83], v[18:21], v[100:103], v[80:83]
    ds_read_b128 a[140:143], v2 offset:19456
    v_mfma_f32_16x16x32_bf16 a[72:75], a[200:203], v[120:123], a[72:75]
    v_exp_f32 v12, v50
    v_mfma_f32_16x16x32_bf16 a[104:107], a[200:203], v[124:127], a[104:107]
    v_cvt_pk_bf16_f32 v104, v10, v11
    v_mfma_f32_16x16x32_bf16 a[76:79], a[204:207], v[120:123], a[76:79]
    v_exp_f32 v13, v51
    v_mfma_f32_16x16x32_bf16 a[108:111], a[204:207], v[124:127], a[108:111]
    ds_read_b128 a[148:151], v2 offset:21504
    v_mfma_f32_16x16x32_bf16 a[80:83], a[208:211], v[120:123], a[80:83]
    v_exp_f32 v10, v52
    v_mfma_f32_16x16x32_bf16 a[112:115], a[208:211], v[124:127], a[112:115]
    v_cvt_pk_bf16_f32 v105, v12, v13
    v_mfma_f32_16x16x32_bf16 a[84:87], a[212:215], v[120:123], a[84:87]
    v_exp_f32 v11, v53
    v_mfma_f32_16x16x32_bf16 a[116:119], a[212:215], v[124:127], a[116:119]
    ds_read_b128 a[156:159], v2 offset:23552
    v_cmp_nge_f32 vcc, s66, v82
    v_mfma_f32_16x16x32_bf16 a[88:91], a[216:219], v[120:123], a[88:91]
    v_exp_f32 v12, v54
    v_mfma_f32_16x16x32_bf16 a[120:123], a[216:219], v[124:127], a[120:123]
    v_cvt_pk_bf16_f32 v106, v10, v11
    v_mfma_f32_16x16x32_bf16 a[92:95], a[220:223], v[120:123], a[92:95]
    v_exp_f32 v13, v55
    v_mfma_f32_16x16x32_bf16 a[124:127], a[220:223], v[124:127], a[124:127]
    s_waitcnt lgkmcnt(4)
    s_cbranch_vccnz L_tramp54
L_ret54:
    v_mfma_f32_16x16x32_bf16 v[32:35], a[128:131], a[224:227], v[64:67]
    v_exp_f32 v10, v56
    v_mfma_f32_16x16x32_bf16 v[32:35], a[136:139], a[228:231], v[32:35]
    v_cvt_pk_bf16_f32 v107, v12, v13
    v_mfma_f32_16x16x32_bf16 v[32:35], a[144:147], a[232:235], v[32:35]
    v_exp_f32 v11, v57
    v_mfma_f32_16x16x32_bf16 v[32:35], a[152:155], a[236:239], v[32:35]
    ds_read_b128 a[192:195], v2 offset:24576
    v_mfma_f32_16x16x32_bf16 v[40:43], a[128:131], a[240:243], v[68:71]
    v_exp_f32 v12, v58
    v_mfma_f32_16x16x32_bf16 v[40:43], a[136:139], a[244:247], v[40:43]
    v_cvt_pk_bf16_f32 v108, v10, v11
    v_mfma_f32_16x16x32_bf16 v[40:43], a[144:147], a[248:251], v[40:43]
    v_exp_f32 v13, v59
    v_mfma_f32_16x16x32_bf16 v[40:43], a[152:155], a[252:255], v[40:43]
    ds_read_b128 a[196:199], v2 offset:25600
    v_mfma_f32_16x16x32_bf16 v[88:91], v[14:17], v[104:107], v[92:95]
    s_waitcnt lgkmcnt(2)
    v_mfma_f32_16x16x32_bf16 v[36:39], a[132:135], a[224:227], v[64:67]
    v_exp_f32 v10, v60
    v_mfma_f32_16x16x32_bf16 v[36:39], a[140:143], a[228:231], v[36:39]
    v_cvt_pk_bf16_f32 v109, v12, v13
    v_mfma_f32_16x16x32_bf16 v[36:39], a[148:151], a[232:235], v[36:39]
    v_exp_f32 v11, v61
    v_mfma_f32_16x16x32_bf16 v[36:39], a[156:159], a[236:239], v[36:39]
    ds_read_b128 a[200:203], v2 offset:26624
    v_mfma_f32_16x16x32_bf16 v[44:47], a[132:135], a[240:243], v[68:71]
    v_exp_f32 v12, v62
    v_mfma_f32_16x16x32_bf16 v[44:47], a[140:143], a[244:247], v[44:47]
    v_cvt_pk_bf16_f32 v110, v10, v11
    v_mfma_f32_16x16x32_bf16 v[44:47], a[148:151], a[248:251], v[44:47]
    v_exp_f32 v13, v63
    v_mfma_f32_16x16x32_bf16 v[44:47], a[156:159], a[252:255], v[44:47]
    ds_read_b128 a[204:207], v2 offset:27648
    v_mfma_f32_16x16x32_bf16 a[0:3], a[160:163], v[96:99], a[0:3]
    v_exp_f32 v10, v32
    v_mfma_f32_16x16x32_bf16 a[32:35], a[160:163], v[100:103], a[32:35]
    v_cvt_pk_bf16_f32 v111, v12, v13
    v_mfma_f32_16x16x32_bf16 a[4:7], a[164:167], v[96:99], a[4:7]
    v_exp_f32 v11, v33
    v_mfma_f32_16x16x32_bf16 a[36:39], a[164:167], v[100:103], a[36:39]
    ds_read_b128 a[208:211], v2 offset:28672
    v_mfma_f32_16x16x32_bf16 v[88:91], v[18:21], v[108:111], v[88:91]
    ds_read_b128 a[220:223], v2 offset:31744
    v_mfma_f32_16x16x32_bf16 a[8:11], a[168:171], v[96:99], a[8:11]
    v_exp_f32 v12, v34
    v_mfma_f32_16x16x32_bf16 a[40:43], a[168:171], v[100:103], a[40:43]
    v_cvt_pk_bf16_f32 v112, v10, v11
    v_mfma_f32_16x16x32_bf16 a[12:15], a[172:175], v[96:99], a[12:15]
    v_exp_f32 v13, v35
    v_mfma_f32_16x16x32_bf16 a[44:47], a[172:175], v[100:103], a[44:47]
    ds_read_b128 a[212:215], v2 offset:29696
    v_mfma_f32_16x16x32_bf16 a[16:19], a[176:179], v[96:99], a[16:19]
    v_exp_f32 v10, v36
    v_mfma_f32_16x16x32_bf16 a[48:51], a[176:179], v[100:103], a[48:51]
    v_cvt_pk_bf16_f32 v113, v12, v13
    v_mfma_f32_16x16x32_bf16 a[20:23], a[180:183], v[96:99], a[20:23]
    v_exp_f32 v11, v37
    v_mfma_f32_16x16x32_bf16 a[52:55], a[180:183], v[100:103], a[52:55]
    ds_read_b128 a[216:219], v2 offset:30720
    v_cmp_nge_f32 vcc, s66, v90
    v_mfma_f32_16x16x32_bf16 a[24:27], a[184:187], v[96:99], a[24:27]
    v_exp_f32 v12, v38
    v_mfma_f32_16x16x32_bf16 a[56:59], a[184:187], v[100:103], a[56:59]
    v_cvt_pk_bf16_f32 v114, v10, v11
    v_mfma_f32_16x16x32_bf16 a[28:31], a[188:191], v[96:99], a[28:31]
    v_exp_f32 v13, v39
    v_mfma_f32_16x16x32_bf16 a[60:63], a[188:191], v[100:103], a[60:63]
    s_cbranch_vccnz L_tramp55
L_ret55:
    v_mfma_f32_16x16x32_bf16 v[48:51], a[128:131], v[128:131], v[72:75]
    s_waitcnt vmcnt(0)
    v_exp_f32 v10, v40
    v_mfma_f32_16x16x32_bf16 v[48:51], a[136:139], v[132:135], v[48:51]
    s_barrier
    v_cvt_pk_bf16_f32 v115, v12, v13
    v_mfma_f32_16x16x32_bf16 v[48:51], a[144:147], v[136:139], v[48:51]
    v_exp_f32 v11, v41
    v_mfma_f32_16x16x32_bf16 v[48:51], a[152:155], v[140:143], v[48:51]
    v_mfma_f32_16x16x32_bf16 v[56:59], a[128:131], v[144:147], v[76:79]
    v_exp_f32 v12, v42
    v_mfma_f32_16x16x32_bf16 v[56:59], a[136:139], v[148:151], v[56:59]
    v_cvt_pk_bf16_f32 v116, v10, v11
    v_mfma_f32_16x16x32_bf16 v[56:59], a[144:147], v[152:155], v[56:59]
    v_exp_f32 v13, v43
    v_mfma_f32_16x16x32_bf16 v[56:59], a[152:155], v[156:159], v[56:59]
    ds_read_b128 a[128:131], v2 offset:32768
    v_mfma_f32_16x16x32_bf16 v[84:87], v[14:17], v[112:115], v[80:83]
    ds_read_b128 a[136:139], v2 offset:34816
    v_mfma_f32_16x16x32_bf16 v[52:55], a[132:135], v[128:131], v[72:75]
    v_exp_f32 v10, v44
    v_mfma_f32_16x16x32_bf16 v[52:55], a[140:143], v[132:135], v[52:55]
    v_cvt_pk_bf16_f32 v117, v12, v13
    v_mfma_f32_16x16x32_bf16 v[52:55], a[148:151], v[136:139], v[52:55]
    v_exp_f32 v11, v45
    v_mfma_f32_16x16x32_bf16 v[52:55], a[156:159], v[140:143], v[52:55]
    ds_read_b128 a[144:147], v2 offset:36864
    v_mfma_f32_16x16x32_bf16 v[60:63], a[132:135], v[144:147], v[76:79]
    v_exp_f32 v12, v46
    v_mfma_f32_16x16x32_bf16 v[60:63], a[140:143], v[148:151], v[60:63]
    v_cvt_pk_bf16_f32 v118, v10, v11
    v_mfma_f32_16x16x32_bf16 v[60:63], a[148:151], v[152:155], v[60:63]
    v_exp_f32 v13, v47
    v_mfma_f32_16x16x32_bf16 v[60:63], a[156:159], v[156:159], v[60:63]
    ds_read_b128 a[152:155], v2 offset:38912
    v_mfma_f32_16x16x32_bf16 a[64:67], a[160:163], v[104:107], a[64:67]
    v_exp_f32 v10, v48
    v_mfma_f32_16x16x32_bf16 a[96:99], a[160:163], v[108:111], a[96:99]
    v_cvt_pk_bf16_f32 v119, v12, v13
    v_mfma_f32_16x16x32_bf16 a[68:71], a[164:167], v[104:107], a[68:71]
    v_exp_f32 v11, v49
    v_mfma_f32_16x16x32_bf16 a[100:103], a[164:167], v[108:111], a[100:103]
    ds_read_b128 a[132:135], v2 offset:33792
    v_mfma_f32_16x16x32_bf16 v[84:87], v[18:21], v[116:119], v[84:87]
    ds_read_b128 a[140:143], v2 offset:35840
    v_mfma_f32_16x16x32_bf16 a[72:75], a[168:171], v[104:107], a[72:75]
    v_exp_f32 v12, v50
    v_mfma_f32_16x16x32_bf16 a[104:107], a[168:171], v[108:111], a[104:107]
    v_cvt_pk_bf16_f32 v120, v10, v11
    v_mfma_f32_16x16x32_bf16 a[76:79], a[172:175], v[104:107], a[76:79]
    v_exp_f32 v13, v51
    v_mfma_f32_16x16x32_bf16 a[108:111], a[172:175], v[108:111], a[108:111]
    ds_read_b128 a[148:151], v2 offset:37888
    v_mfma_f32_16x16x32_bf16 a[80:83], a[176:179], v[104:107], a[80:83]
    v_exp_f32 v10, v52
    v_mfma_f32_16x16x32_bf16 a[112:115], a[176:179], v[108:111], a[112:115]
    v_cvt_pk_bf16_f32 v121, v12, v13
    v_mfma_f32_16x16x32_bf16 a[84:87], a[180:183], v[104:107], a[84:87]
    v_exp_f32 v11, v53
    v_mfma_f32_16x16x32_bf16 a[116:119], a[180:183], v[108:111], a[116:119]
    ds_read_b128 a[156:159], v2 offset:39936
    v_cmp_nge_f32 vcc, s66, v86
    v_mfma_f32_16x16x32_bf16 a[88:91], a[184:187], v[104:107], a[88:91]
    v_exp_f32 v12, v54
    v_mfma_f32_16x16x32_bf16 a[120:123], a[184:187], v[108:111], a[120:123]
    v_cvt_pk_bf16_f32 v122, v10, v11
    v_mfma_f32_16x16x32_bf16 a[92:95], a[188:191], v[104:107], a[92:95]
    v_exp_f32 v13, v55
    v_mfma_f32_16x16x32_bf16 a[124:127], a[188:191], v[108:111], a[124:127]
    s_waitcnt lgkmcnt(4)
    s_cbranch_vccnz L_tramp56
L_ret56:
    v_mfma_f32_16x16x32_bf16 v[32:35], a[128:131], a[224:227], v[64:67]
    v_exp_f32 v10, v56
    v_mfma_f32_16x16x32_bf16 v[32:35], a[136:139], a[228:231], v[32:35]
    v_cvt_pk_bf16_f32 v123, v12, v13
    v_mfma_f32_16x16x32_bf16 v[32:35], a[144:147], a[232:235], v[32:35]
    v_exp_f32 v11, v57
    v_mfma_f32_16x16x32_bf16 v[32:35], a[152:155], a[236:239], v[32:35]
    ds_read_b128 a[160:163], v2 offset:40960
    v_mfma_f32_16x16x32_bf16 v[40:43], a[128:131], a[240:243], v[68:71]
    v_exp_f32 v12, v58
    v_mfma_f32_16x16x32_bf16 v[40:43], a[136:139], a[244:247], v[40:43]
    v_cvt_pk_bf16_f32 v124, v10, v11
    v_mfma_f32_16x16x32_bf16 v[40:43], a[144:147], a[248:251], v[40:43]
    v_exp_f32 v13, v59
    v_mfma_f32_16x16x32_bf16 v[40:43], a[152:155], a[252:255], v[40:43]
    ds_read_b128 a[164:167], v2 offset:41984
    v_mfma_f32_16x16x32_bf16 v[92:95], v[14:17], v[120:123], v[88:91]
    s_waitcnt lgkmcnt(2)
    v_mfma_f32_16x16x32_bf16 v[36:39], a[132:135], a[224:227], v[64:67]
    v_exp_f32 v10, v60
    v_mfma_f32_16x16x32_bf16 v[36:39], a[140:143], a[228:231], v[36:39]
    v_cvt_pk_bf16_f32 v125, v12, v13
    v_mfma_f32_16x16x32_bf16 v[36:39], a[148:151], a[232:235], v[36:39]
    v_exp_f32 v11, v61
    v_mfma_f32_16x16x32_bf16 v[36:39], a[156:159], a[236:239], v[36:39]
    ds_read_b128 a[168:171], v2 offset:43008
    v_mfma_f32_16x16x32_bf16 v[44:47], a[132:135], a[240:243], v[68:71]
    v_exp_f32 v12, v62
    v_mfma_f32_16x16x32_bf16 v[44:47], a[140:143], a[244:247], v[44:47]
    v_cvt_pk_bf16_f32 v126, v10, v11
    v_mfma_f32_16x16x32_bf16 v[44:47], a[148:151], a[248:251], v[44:47]
    v_exp_f32 v13, v63
    v_mfma_f32_16x16x32_bf16 v[44:47], a[156:159], a[252:255], v[44:47]
    ds_read_b128 a[172:175], v2 offset:44032
    v_mfma_f32_16x16x32_bf16 a[0:3], a[192:195], v[112:115], a[0:3]
    v_exp_f32 v10, v32
    v_mfma_f32_16x16x32_bf16 a[32:35], a[192:195], v[116:119], a[32:35]
    v_cvt_pk_bf16_f32 v127, v12, v13
    v_mfma_f32_16x16x32_bf16 a[4:7], a[196:199], v[112:115], a[4:7]
    v_exp_f32 v11, v33
    v_mfma_f32_16x16x32_bf16 a[36:39], a[196:199], v[116:119], a[36:39]
    ds_read_b128 a[176:179], v2 offset:45056
    v_mfma_f32_16x16x32_bf16 v[92:95], v[18:21], v[124:127], v[92:95]
    ds_read_b128 a[188:191], v2 offset:48128
    v_mfma_f32_16x16x32_bf16 a[8:11], a[200:203], v[112:115], a[8:11]
    v_exp_f32 v12, v34
    v_mfma_f32_16x16x32_bf16 a[40:43], a[200:203], v[116:119], a[40:43]
    v_cvt_pk_bf16_f32 v96, v10, v11
    v_mfma_f32_16x16x32_bf16 a[12:15], a[204:207], v[112:115], a[12:15]
    v_exp_f32 v13, v35
    v_mfma_f32_16x16x32_bf16 a[44:47], a[204:207], v[116:119], a[44:47]
    ds_read_b128 a[180:183], v2 offset:46080
    v_mfma_f32_16x16x32_bf16 a[16:19], a[208:211], v[112:115], a[16:19]
    v_exp_f32 v10, v36
    v_mfma_f32_16x16x32_bf16 a[48:51], a[208:211], v[116:119], a[48:51]
    v_cvt_pk_bf16_f32 v97, v12, v13
    v_mfma_f32_16x16x32_bf16 a[20:23], a[212:215], v[112:115], a[20:23]
    v_exp_f32 v11, v37
    v_mfma_f32_16x16x32_bf16 a[52:55], a[212:215], v[116:119], a[52:55]
    ds_read_b128 a[184:187], v2 offset:47104
    v_cmp_nge_f32 vcc, s66, v94
    v_mfma_f32_16x16x32_bf16 a[24:27], a[216:219], v[112:115], a[24:27]
    v_exp_f32 v12, v38
    v_mfma_f32_16x16x32_bf16 a[56:59], a[216:219], v[116:119], a[56:59]
    v_cvt_pk_bf16_f32 v98, v10, v11
    v_mfma_f32_16x16x32_bf16 a[28:31], a[220:223], v[112:115], a[28:31]
    v_exp_f32 v13, v39
    v_mfma_f32_16x16x32_bf16 a[60:63], a[220:223], v[116:119], a[60:63]
    s_cbranch_vccnz L_tramp57
L_ret57:
    v_mfma_f32_16x16x32_bf16 v[48:51], a[128:131], v[128:131], v[72:75]
    v_exp_f32 v10, v40
    v_mfma_f32_16x16x32_bf16 v[48:51], a[136:139], v[132:135], v[48:51]
    v_cvt_pk_bf16_f32 v99, v12, v13
    v_mfma_f32_16x16x32_bf16 v[48:51], a[144:147], v[136:139], v[48:51]
    v_exp_f32 v11, v41
    v_mfma_f32_16x16x32_bf16 v[48:51], a[152:155], v[140:143], v[48:51]
    v_mfma_f32_16x16x32_bf16 v[56:59], a[128:131], v[144:147], v[76:79]
    v_exp_f32 v12, v42
    v_mfma_f32_16x16x32_bf16 v[56:59], a[136:139], v[148:151], v[56:59]
    v_cvt_pk_bf16_f32 v100, v10, v11
    v_mfma_f32_16x16x32_bf16 v[56:59], a[144:147], v[152:155], v[56:59]
    v_exp_f32 v13, v43
    v_mfma_f32_16x16x32_bf16 v[56:59], a[152:155], v[156:159], v[56:59]
    ds_read_b128 a[128:131], v2 offset:49152
    v_mfma_f32_16x16x32_bf16 v[80:83], v[14:17], v[96:99], v[84:87]
    ds_read_b128 a[136:139], v2 offset:51200
    v_mfma_f32_16x16x32_bf16 v[52:55], a[132:135], v[128:131], v[72:75]
    v_exp_f32 v10, v44
    v_mfma_f32_16x16x32_bf16 v[52:55], a[140:143], v[132:135], v[52:55]
    v_cvt_pk_bf16_f32 v101, v12, v13
    v_mfma_f32_16x16x32_bf16 v[52:55], a[148:151], v[136:139], v[52:55]
    v_exp_f32 v11, v45
    v_mfma_f32_16x16x32_bf16 v[52:55], a[156:159], v[140:143], v[52:55]
    ds_read_b128 a[144:147], v2 offset:53248
    v_mfma_f32_16x16x32_bf16 v[60:63], a[132:135], v[144:147], v[76:79]
    v_exp_f32 v12, v46
    v_mfma_f32_16x16x32_bf16 v[60:63], a[140:143], v[148:151], v[60:63]
    v_cvt_pk_bf16_f32 v102, v10, v11
    v_mfma_f32_16x16x32_bf16 v[60:63], a[148:151], v[152:155], v[60:63]
    v_exp_f32 v13, v47
    v_mfma_f32_16x16x32_bf16 v[60:63], a[156:159], v[156:159], v[60:63]
    ds_read_b128 a[152:155], v2 offset:55296
    v_mfma_f32_16x16x32_bf16 a[64:67], a[192:195], v[120:123], a[64:67]
    v_exp_f32 v10, v48
    v_mfma_f32_16x16x32_bf16 a[96:99], a[192:195], v[124:127], a[96:99]
    v_cvt_pk_bf16_f32 v103, v12, v13
    v_mfma_f32_16x16x32_bf16 a[68:71], a[196:199], v[120:123], a[68:71]
    v_exp_f32 v11, v49
    v_mfma_f32_16x16x32_bf16 a[100:103], a[196:199], v[124:127], a[100:103]
    ds_read_b128 a[132:135], v2 offset:50176
    v_mfma_f32_16x16x32_bf16 v[80:83], v[18:21], v[100:103], v[80:83]
    ds_read_b128 a[140:143], v2 offset:52224
    v_mfma_f32_16x16x32_bf16 a[72:75], a[200:203], v[120:123], a[72:75]
    v_exp_f32 v12, v50
    v_mfma_f32_16x16x32_bf16 a[104:107], a[200:203], v[124:127], a[104:107]
    v_cvt_pk_bf16_f32 v104, v10, v11
    v_mfma_f32_16x16x32_bf16 a[76:79], a[204:207], v[120:123], a[76:79]
    v_exp_f32 v13, v51
    v_mfma_f32_16x16x32_bf16 a[108:111], a[204:207], v[124:127], a[108:111]
    ds_read_b128 a[148:151], v2 offset:54272
    v_mfma_f32_16x16x32_bf16 a[80:83], a[208:211], v[120:123], a[80:83]
    v_exp_f32 v10, v52
    v_mfma_f32_16x16x32_bf16 a[112:115], a[208:211], v[124:127], a[112:115]
    v_cvt_pk_bf16_f32 v105, v12, v13
    v_mfma_f32_16x16x32_bf16 a[84:87], a[212:215], v[120:123], a[84:87]
    v_exp_f32 v11, v53
    v_mfma_f32_16x16x32_bf16 a[116:119], a[212:215], v[124:127], a[116:119]
    ds_read_b128 a[156:159], v2 offset:56320
    v_cmp_nge_f32 vcc, s66, v82
    v_mfma_f32_16x16x32_bf16 a[88:91], a[216:219], v[120:123], a[88:91]
    v_exp_f32 v12, v54
    v_mfma_f32_16x16x32_bf16 a[120:123], a[216:219], v[124:127], a[120:123]
    v_cvt_pk_bf16_f32 v106, v10, v11
    v_mfma_f32_16x16x32_bf16 a[92:95], a[220:223], v[120:123], a[92:95]
    v_exp_f32 v13, v55
    v_mfma_f32_16x16x32_bf16 a[124:127], a[220:223], v[124:127], a[124:127]
    s_waitcnt lgkmcnt(4)
    s_cbranch_vccnz L_tramp58
L_ret58:
    v_mfma_f32_16x16x32_bf16 v[32:35], a[128:131], a[224:227], v[64:67]
    v_exp_f32 v10, v56
    v_mfma_f32_16x16x32_bf16 v[32:35], a[136:139], a[228:231], v[32:35]
    v_cvt_pk_bf16_f32 v107, v12, v13
    v_mfma_f32_16x16x32_bf16 v[32:35], a[144:147], a[232:235], v[32:35]
    v_exp_f32 v11, v57
    v_mfma_f32_16x16x32_bf16 v[32:35], a[152:155], a[236:239], v[32:35]
    ds_read_b128 a[192:195], v2 offset:57344
    v_mfma_f32_16x16x32_bf16 v[40:43], a[128:131], a[240:243], v[68:71]
    v_exp_f32 v12, v58
    v_mfma_f32_16x16x32_bf16 v[40:43], a[136:139], a[244:247], v[40:43]
    v_cvt_pk_bf16_f32 v108, v10, v11
    v_mfma_f32_16x16x32_bf16 v[40:43], a[144:147], a[248:251], v[40:43]
    v_exp_f32 v13, v59
    v_mfma_f32_16x16x32_bf16 v[40:43], a[152:155], a[252:255], v[40:43]
    ds_read_b128 a[196:199], v2 offset:58368
    v_mfma_f32_16x16x32_bf16 v[88:91], v[14:17], v[104:107], v[92:95]
    s_waitcnt lgkmcnt(2)
    v_mfma_f32_16x16x32_bf16 v[36:39], a[132:135], a[224:227], v[64:67]
    v_exp_f32 v10, v60
    v_mfma_f32_16x16x32_bf16 v[36:39], a[140:143], a[228:231], v[36:39]
    v_cvt_pk_bf16_f32 v109, v12, v13
    v_mfma_f32_16x16x32_bf16 v[36:39], a[148:151], a[232:235], v[36:39]
    v_exp_f32 v11, v61
    v_mfma_f32_16x16x32_bf16 v[36:39], a[156:159], a[236:239], v[36:39]
    ds_read_b128 a[200:203], v2 offset:59392
    v_mfma_f32_16x16x32_bf16 v[44:47], a[132:135], a[240:243], v[68:71]
    v_exp_f32 v12, v62
    v_mfma_f32_16x16x32_bf16 v[44:47], a[140:143], a[244:247], v[44:47]
    v_cvt_pk_bf16_f32 v110, v10, v11
    v_mfma_f32_16x16x32_bf16 v[44:47], a[148:151], a[248:251], v[44:47]
    v_exp_f32 v13, v63
    v_mfma_f32_16x16x32_bf16 v[44:47], a[156:159], a[252:255], v[44:47]
    ds_read_b128 a[204:207], v2 offset:60416
    v_mfma_f32_16x16x32_bf16 a[0:3], a[160:163], v[96:99], a[0:3]
    v_exp_f32 v10, v32
    v_mfma_f32_16x16x32_bf16 a[32:35], a[160:163], v[100:103], a[32:35]
    v_cvt_pk_bf16_f32 v111, v12, v13
    v_mfma_f32_16x16x32_bf16 a[4:7], a[164:167], v[96:99], a[4:7]
    v_exp_f32 v11, v33
    v_mfma_f32_16x16x32_bf16 a[36:39], a[164:167], v[100:103], a[36:39]
    ds_read_b128 a[208:211], v2 offset:61440
    v_mfma_f32_16x16x32_bf16 v[88:91], v[18:21], v[108:111], v[88:91]
    ds_read_b128 a[220:223], v2 offset:64512
    v_mfma_f32_16x16x32_bf16 a[8:11], a[168:171], v[96:99], a[8:11]
    v_exp_f32 v12, v34
    v_mfma_f32_16x16x32_bf16 a[40:43], a[168:171], v[100:103], a[40:43]
    v_cvt_pk_bf16_f32 v112, v10, v11
    v_mfma_f32_16x16x32_bf16 a[12:15], a[172:175], v[96:99], a[12:15]
    v_exp_f32 v13, v35
    v_mfma_f32_16x16x32_bf16 a[44:47], a[172:175], v[100:103], a[44:47]
    ds_read_b128 a[212:215], v2 offset:62464
    v_mfma_f32_16x16x32_bf16 a[16:19], a[176:179], v[96:99], a[16:19]
    v_exp_f32 v10, v36
    v_mfma_f32_16x16x32_bf16 a[48:51], a[176:179], v[100:103], a[48:51]
    v_cvt_pk_bf16_f32 v113, v12, v13
    v_mfma_f32_16x16x32_bf16 a[20:23], a[180:183], v[96:99], a[20:23]
    v_exp_f32 v11, v37
    v_mfma_f32_16x16x32_bf16 a[52:55], a[180:183], v[100:103], a[52:55]
    ds_read_b128 a[216:219], v2 offset:63488
    v_cmp_nge_f32 vcc, s66, v90
    v_mfma_f32_16x16x32_bf16 a[24:27], a[184:187], v[96:99], a[24:27]
    v_exp_f32 v12, v38
    v_mfma_f32_16x16x32_bf16 a[56:59], a[184:187], v[100:103], a[56:59]
    v_cvt_pk_bf16_f32 v114, v10, v11
    v_mfma_f32_16x16x32_bf16 a[28:31], a[188:191], v[96:99], a[28:31]
    v_exp_f32 v13, v39
    v_mfma_f32_16x16x32_bf16 a[60:63], a[188:191], v[100:103], a[60:63]
    s_cbranch_vccnz L_tramp59
L_ret59:
    v_mfma_f32_16x16x32_bf16 v[48:51], a[128:131], v[128:131], v[72:75]
    v_exp_f32 v10, v40
    v_mfma_f32_16x16x32_bf16 v[48:51], a[136:139], v[132:135], v[48:51]
    v_cvt_pk_bf16_f32 v115, v12, v13
    v_mfma_f32_16x16x32_bf16 v[48:51], a[144:147], v[136:139], v[48:51]
    v_exp_f32 v11, v41
    v_mfma_f32_16x16x32_bf16 v[48:51], a[152:155], v[140:143], v[48:51]
    v_mfma_f32_16x16x32_bf16 v[56:59], a[128:131], v[144:147], v[76:79]
    v_exp_f32 v12, v42
    v_mfma_f32_16x16x32_bf16 v[56:59], a[136:139], v[148:151], v[56:59]
    v_cvt_pk_bf16_f32 v116, v10, v11
    v_mfma_f32_16x16x32_bf16 v[56:59], a[144:147], v[152:155], v[56:59]
    v_exp_f32 v13, v43
    v_mfma_f32_16x16x32_bf16 v[56:59], a[152:155], v[156:159], v[56:59]
    v_mfma_f32_16x16x32_bf16 v[84:87], v[14:17], v[112:115], v[80:83]
    v_mfma_f32_16x16x32_bf16 v[52:55], a[132:135], v[128:131], v[72:75]
    v_exp_f32 v10, v44
    v_mfma_f32_16x16x32_bf16 v[52:55], a[140:143], v[132:135], v[52:55]
    v_cvt_pk_bf16_f32 v117, v12, v13
    v_mfma_f32_16x16x32_bf16 v[52:55], a[148:151], v[136:139], v[52:55]
    v_exp_f32 v11, v45
    v_mfma_f32_16x16x32_bf16 v[52:55], a[156:159], v[140:143], v[52:55]
    v_mfma_f32_16x16x32_bf16 v[60:63], a[132:135], v[144:147], v[76:79]
    v_exp_f32 v12, v46
    v_mfma_f32_16x16x32_bf16 v[60:63], a[140:143], v[148:151], v[60:63]
    v_cvt_pk_bf16_f32 v118, v10, v11
    v_mfma_f32_16x16x32_bf16 v[60:63], a[148:151], v[152:155], v[60:63]
    v_exp_f32 v13, v47
    v_mfma_f32_16x16x32_bf16 v[60:63], a[156:159], v[156:159], v[60:63]
    v_mfma_f32_16x16x32_bf16 a[64:67], a[160:163], v[104:107], a[64:67]
    v_exp_f32 v10, v48
    v_mfma_f32_16x16x32_bf16 a[96:99], a[160:163], v[108:111], a[96:99]
    v_cvt_pk_bf16_f32 v119, v12, v13
    v_mfma_f32_16x16x32_bf16 a[68:71], a[164:167], v[104:107], a[68:71]
    v_exp_f32 v11, v49
    v_mfma_f32_16x16x32_bf16 a[100:103], a[164:167], v[108:111], a[100:103]
    v_mfma_f32_16x16x32_bf16 v[84:87], v[18:21], v[116:119], v[84:87]
    v_mfma_f32_16x16x32_bf16 a[72:75], a[168:171], v[104:107], a[72:75]
    v_exp_f32 v12, v50
    v_mfma_f32_16x16x32_bf16 a[104:107], a[168:171], v[108:111], a[104:107]
    v_cvt_pk_bf16_f32 v120, v10, v11
    v_mfma_f32_16x16x32_bf16 a[76:79], a[172:175], v[104:107], a[76:79]
    v_exp_f32 v13, v51
    v_mfma_f32_16x16x32_bf16 a[108:111], a[172:175], v[108:111], a[108:111]
    v_mfma_f32_16x16x32_bf16 a[80:83], a[176:179], v[104:107], a[80:83]
    v_exp_f32 v10, v52
    v_mfma_f32_16x16x32_bf16 a[112:115], a[176:179], v[108:111], a[112:115]
    v_cvt_pk_bf16_f32 v121, v12, v13
    v_mfma_f32_16x16x32_bf16 a[84:87], a[180:183], v[104:107], a[84:87]
    v_exp_f32 v11, v53
    v_mfma_f32_16x16x32_bf16 a[116:119], a[180:183], v[108:111], a[116:119]
    v_cmp_nge_f32 vcc, s66, v86
    v_mfma_f32_16x16x32_bf16 a[88:91], a[184:187], v[104:107], a[88:91]
    v_exp_f32 v12, v54
    v_mfma_f32_16x16x32_bf16 a[120:123], a[184:187], v[108:111], a[120:123]
    v_cvt_pk_bf16_f32 v122, v10, v11
    v_mfma_f32_16x16x32_bf16 a[92:95], a[188:191], v[104:107], a[92:95]
    v_exp_f32 v13, v55
    v_mfma_f32_16x16x32_bf16 a[124:127], a[188:191], v[108:111], a[124:127]
    s_waitcnt lgkmcnt(0)
    s_cbranch_vccnz L_tramp60
L_ret60:
    v_mfma_f32_16x16x32_bf16 a[0:3], a[192:195], v[112:115], a[0:3]
    v_exp_f32 v10, v56
    v_mfma_f32_16x16x32_bf16 a[32:35], a[192:195], v[116:119], a[32:35]
    v_cvt_pk_bf16_f32 v123, v12, v13
    v_mfma_f32_16x16x32_bf16 a[4:7], a[196:199], v[112:115], a[4:7]
    v_exp_f32 v11, v57
    v_mfma_f32_16x16x32_bf16 a[36:39], a[196:199], v[116:119], a[36:39]
    v_and_b32 v160, 7, v0
    v_lshlrev_b32 v160, 8, v160
    v_lshrrev_b32 v161, 3, v0
    v_lshl_add_u32 v160, v161, 4, v160
    s_add_u32 s80, s78, 4096
    s_add_u32 s81, s78, 8192
    s_add_u32 s82, s78, 12288
    v_mfma_f32_16x16x32_bf16 a[8:11], a[200:203], v[112:115], a[8:11]
    v_exp_f32 v12, v58
    v_mfma_f32_16x16x32_bf16 a[40:43], a[200:203], v[116:119], a[40:43]
    v_cvt_pk_bf16_f32 v124, v10, v11
    v_mfma_f32_16x16x32_bf16 a[12:15], a[204:207], v[112:115], a[12:15]
    v_exp_f32 v13, v59
    v_mfma_f32_16x16x32_bf16 a[44:47], a[204:207], v[116:119], a[44:47]
    v_mfma_f32_16x16x32_bf16 v[92:95], v[14:17], v[120:123], v[88:91]
    v_mfma_f32_16x16x32_bf16 a[16:19], a[208:211], v[112:115], a[16:19]
    v_exp_f32 v10, v60
    v_mfma_f32_16x16x32_bf16 a[48:51], a[208:211], v[116:119], a[48:51]
    v_cvt_pk_bf16_f32 v125, v12, v13
    v_mfma_f32_16x16x32_bf16 a[20:23], a[212:215], v[112:115], a[20:23]
    v_exp_f32 v11, v61
    v_mfma_f32_16x16x32_bf16 a[52:55], a[212:215], v[116:119], a[52:55]
    v_mfma_f32_16x16x32_bf16 a[24:27], a[216:219], v[112:115], a[24:27]
    v_exp_f32 v12, v62
    v_mfma_f32_16x16x32_bf16 a[56:59], a[216:219], v[116:119], a[56:59]
    v_cvt_pk_bf16_f32 v126, v10, v11
    v_mfma_f32_16x16x32_bf16 a[28:31], a[220:223], v[112:115], a[28:31]
    v_exp_f32 v13, v63
    v_mfma_f32_16x16x32_bf16 a[60:63], a[220:223], v[116:119], a[60:63]
    v_cvt_pk_bf16_f32 v127, v12, v13
    s_nop 1
    v_mfma_f32_16x16x32_bf16 v[92:95], v[18:21], v[124:127], v[92:95]
    v_rcp_f32 v28, v84
    v_rcp_f32 v29, v85
    v_accvgpr_read_b32 v176, a0
    v_accvgpr_read_b32 v180, a1
    v_accvgpr_read_b32 v184, a2
    v_accvgpr_read_b32 v188, a3
    v_accvgpr_read_b32 v177, a8
    v_accvgpr_read_b32 v181, a9
    v_accvgpr_read_b32 v185, a10
    v_accvgpr_read_b32 v189, a11
    v_accvgpr_read_b32 v178, a16
    v_accvgpr_read_b32 v182, a17
    v_accvgpr_read_b32 v186, a18
    v_accvgpr_read_b32 v190, a19
    v_accvgpr_read_b32 v179, a24
    v_accvgpr_read_b32 v183, a25
    v_accvgpr_read_b32 v187, a26
    v_accvgpr_read_b32 v191, a27
    v_mul_f32 v176, v176, v28
    v_mul_f32 v177, v177, v28
    v_mul_f32 v178, v178, v28
    v_mul_f32 v179, v179, v28
    v_mul_f32 v180, v180, v28
    v_mul_f32 v181, v181, v28
    v_mul_f32 v182, v182, v28
    v_mul_f32 v183, v183, v28
    v_mul_f32 v184, v184, v28
    v_mul_f32 v185, v185, v28
    v_mul_f32 v186, v186, v28
    v_mul_f32 v187, v187, v28
    v_mul_f32 v188, v188, v28
    v_mul_f32 v189, v189, v28
    v_mul_f32 v190, v190, v28
    v_mul_f32 v191, v191, v28
    v_cvt_pk_bf16_f32 v192, v176, v177
    v_cvt_pk_bf16_f32 v193, v178, v179
    v_cvt_pk_bf16_f32 v194, v180, v181
    v_cvt_pk_bf16_f32 v195, v182, v183
    v_cvt_pk_bf16_f32 v196, v184, v185
    v_cvt_pk_bf16_f32 v197, v186, v187
    v_cvt_pk_bf16_f32 v198, v188, v189
    v_cvt_pk_bf16_f32 v199, v190, v191
    v_mov_b32_dpp v200, v192 row_ror:8 row_mask:0xf bank_mask:0xf
    v_mov_b32_dpp v201, v193 row_ror:8 row_mask:0xf bank_mask:0xf
    v_mov_b32_dpp v202, v194 row_ror:8 row_mask:0xf bank_mask:0xf
    v_mov_b32_dpp v203, v195 row_ror:8 row_mask:0xf bank_mask:0xf
    v_mov_b32_dpp v192, v196 row_ror:8 row_mask:0xf bank_mask:0xc
    v_mov_b32_dpp v193, v197 row_ror:8 row_mask:0xf bank_mask:0xc
    v_mov_b32_dpp v194, v198 row_ror:8 row_mask:0xf bank_mask:0xc
    v_mov_b32_dpp v195, v199 row_ror:8 row_mask:0xf bank_mask:0xc
    v_mov_b32_dpp v196, v200 quad_perm:[0,1,2,3] row_mask:0xf bank_mask:0x3
    v_mov_b32_dpp v197, v201 quad_perm:[0,1,2,3] row_mask:0xf bank_mask:0x3
    v_mov_b32_dpp v198, v202 quad_perm:[0,1,2,3] row_mask:0xf bank_mask:0x3
    v_mov_b32_dpp v199, v203 quad_perm:[0,1,2,3] row_mask:0xf bank_mask:0x3
    buffer_store_dwordx4 v[192:195], v160, s[56:59], s78 offen offset:0 sc1
    buffer_store_dwordx4 v[196:199], v160, s[56:59], s78 offen offset:2048 sc1
    v_accvgpr_read_b32 v208, a4
    v_accvgpr_read_b32 v212, a5
    v_accvgpr_read_b32 v216, a6
    v_accvgpr_read_b32 v220, a7
    v_accvgpr_read_b32 v209, a12
    v_accvgpr_read_b32 v213, a13
    v_accvgpr_read_b32 v217, a14
    v_accvgpr_read_b32 v221, a15
    v_cmp_nge_f32 vcc, s66, v94
    v_accvgpr_read_b32 v210, a20
    v_accvgpr_read_b32 v214, a21
    v_accvgpr_read_b32 v218, a22
    v_accvgpr_read_b32 v222, a23
    v_accvgpr_read_b32 v211, a28
    v_accvgpr_read_b32 v215, a29
    v_accvgpr_read_b32 v219, a30
    v_accvgpr_read_b32 v223, a31
    v_mul_f32 v208, v208, v28
    v_mul_f32 v209, v209, v28
    v_mul_f32 v210, v210, v28
    v_mul_f32 v211, v211, v28
    v_mul_f32 v212, v212, v28
    v_mul_f32 v213, v213, v28
    v_mul_f32 v214, v214, v28
    v_mul_f32 v215, v215, v28
    v_mul_f32 v216, v216, v28
    v_mul_f32 v217, v217, v28
    v_mul_f32 v218, v218, v28
    v_mul_f32 v219, v219, v28
    v_mul_f32 v220, v220, v28
    v_mul_f32 v221, v221, v28
    v_mul_f32 v222, v222, v28
    v_mul_f32 v223, v223, v28
    s_cbranch_vccnz L_tramp61
L_ret61:
    v_cvt_pk_bf16_f32 v224, v208, v209
    v_cvt_pk_bf16_f32 v225, v210, v211
    v_cvt_pk_bf16_f32 v226, v212, v213
    v_cvt_pk_bf16_f32 v227, v214, v215
    v_cvt_pk_bf16_f32 v228, v216, v217
    v_cvt_pk_bf16_f32 v229, v218, v219
    v_cvt_pk_bf16_f32 v230, v220, v221
    v_cvt_pk_bf16_f32 v231, v222, v223
    v_mov_b32_dpp v232, v224 row_ror:8 row_mask:0xf bank_mask:0xf
    v_mov_b32_dpp v233, v225 row_ror:8 row_mask:0xf bank_mask:0xf
    v_mov_b32_dpp v234, v226 row_ror:8 row_mask:0xf bank_mask:0xf
    v_mov_b32_dpp v235, v227 row_ror:8 row_mask:0xf bank_mask:0xf
    v_mov_b32_dpp v224, v228 row_ror:8 row_mask:0xf bank_mask:0xc
    v_mov_b32_dpp v225, v229 row_ror:8 row_mask:0xf bank_mask:0xc
    v_mov_b32_dpp v226, v230 row_ror:8 row_mask:0xf bank_mask:0xc
    v_mov_b32_dpp v227, v231 row_ror:8 row_mask:0xf bank_mask:0xc
    v_mfma_f32_16x16x32_bf16 a[64:67], a[192:195], v[120:123], a[64:67]
    v_mov_b32_dpp v228, v232 quad_perm:[0,1,2,3] row_mask:0xf bank_mask:0x3
    v_mov_b32_dpp v229, v233 quad_perm:[0,1,2,3] row_mask:0xf bank_mask:0x3
    v_mov_b32_dpp v230, v234 quad_perm:[0,1,2,3] row_mask:0xf bank_mask:0x3
    v_mov_b32_dpp v231, v235 quad_perm:[0,1,2,3] row_mask:0xf bank_mask:0x3
    buffer_store_dwordx4 v[224:227], v160, s[56:59], s78 offen offset:128 sc1
    buffer_store_dwordx4 v[228:231], v160, s[56:59], s78 offen offset:2176 sc1
    v_accvgpr_read_b32 v176, a32
    v_accvgpr_read_b32 v180, a33
    v_mfma_f32_16x16x32_bf16 a[96:99], a[192:195], v[124:127], a[96:99]
    v_accvgpr_read_b32 v184, a34
    v_accvgpr_read_b32 v188, a35
    v_accvgpr_read_b32 v177, a40
    v_accvgpr_read_b32 v181, a41
    v_accvgpr_read_b32 v185, a42
    v_accvgpr_read_b32 v189, a43
    v_accvgpr_read_b32 v178, a48
    v_accvgpr_read_b32 v182, a49
    v_mfma_f32_16x16x32_bf16 a[68:71], a[196:199], v[120:123], a[68:71]
    v_accvgpr_read_b32 v186, a50
    v_accvgpr_read_b32 v190, a51
    v_accvgpr_read_b32 v179, a56
    v_accvgpr_read_b32 v183, a57
    v_accvgpr_read_b32 v187, a58
    v_accvgpr_read_b32 v191, a59
    v_mul_f32 v176, v176, v29
    v_mul_f32 v177, v177, v29
    v_mfma_f32_16x16x32_bf16 a[100:103], a[196:199], v[124:127], a[100:103]
    v_mul_f32 v178, v178, v29
    v_mul_f32 v179, v179, v29
    v_mul_f32 v180, v180, v29
    v_mul_f32 v181, v181, v29
    v_mul_f32 v182, v182, v29
    v_mul_f32 v183, v183, v29
    v_mul_f32 v184, v184, v29
    v_mul_f32 v185, v185, v29
    v_mfma_f32_16x16x32_bf16 a[72:75], a[200:203], v[120:123], a[72:75]
    v_mul_f32 v186, v186, v29
    v_mul_f32 v187, v187, v29
    v_mul_f32 v188, v188, v29
    v_mul_f32 v189, v189, v29
    v_mul_f32 v190, v190, v29
    v_mul_f32 v191, v191, v29
    v_cvt_pk_bf16_f32 v192, v176, v177
    v_cvt_pk_bf16_f32 v193, v178, v179
    v_mfma_f32_16x16x32_bf16 a[104:107], a[200:203], v[124:127], a[104:107]
    v_cvt_pk_bf16_f32 v194, v180, v181
    v_cvt_pk_bf16_f32 v195, v182, v183
    v_cvt_pk_bf16_f32 v196, v184, v185
    v_cvt_pk_bf16_f32 v197, v186, v187
    v_cvt_pk_bf16_f32 v198, v188, v189
    v_cvt_pk_bf16_f32 v199, v190, v191
    v_mov_b32_dpp v200, v192 row_ror:8 row_mask:0xf bank_mask:0xf
    v_mov_b32_dpp v201, v193 row_ror:8 row_mask:0xf bank_mask:0xf
    v_mfma_f32_16x16x32_bf16 a[76:79], a[204:207], v[120:123], a[76:79]
    v_mov_b32_dpp v202, v194 row_ror:8 row_mask:0xf bank_mask:0xf
    v_mov_b32_dpp v203, v195 row_ror:8 row_mask:0xf bank_mask:0xf
    v_mov_b32_dpp v192, v196 row_ror:8 row_mask:0xf bank_mask:0xc
    v_mov_b32_dpp v193, v197 row_ror:8 row_mask:0xf bank_mask:0xc
    v_mov_b32_dpp v194, v198 row_ror:8 row_mask:0xf bank_mask:0xc
    v_mov_b32_dpp v195, v199 row_ror:8 row_mask:0xf bank_mask:0xc
    v_mov_b32_dpp v196, v200 quad_perm:[0,1,2,3] row_mask:0xf bank_mask:0x3
    v_mov_b32_dpp v197, v201 quad_perm:[0,1,2,3] row_mask:0xf bank_mask:0x3
    v_mfma_f32_16x16x32_bf16 a[108:111], a[204:207], v[124:127], a[108:111]
    v_mov_b32_dpp v198, v202 quad_perm:[0,1,2,3] row_mask:0xf bank_mask:0x3
    v_mov_b32_dpp v199, v203 quad_perm:[0,1,2,3] row_mask:0xf bank_mask:0x3
    buffer_store_dwordx4 v[192:195], v160, s[56:59], s80 offen offset:0 sc1
    buffer_store_dwordx4 v[196:199], v160, s[56:59], s80 offen offset:2048 sc1
    v_accvgpr_read_b32 v208, a36
    v_accvgpr_read_b32 v212, a37
    v_accvgpr_read_b32 v216, a38
    v_accvgpr_read_b32 v220, a39
    v_mfma_f32_16x16x32_bf16 a[80:83], a[208:211], v[120:123], a[80:83]
    v_accvgpr_read_b32 v209, a44
    v_accvgpr_read_b32 v213, a45
    v_accvgpr_read_b32 v217, a46
    v_accvgpr_read_b32 v221, a47
    v_accvgpr_read_b32 v210, a52
    v_accvgpr_read_b32 v214, a53
    v_accvgpr_read_b32 v218, a54
    v_accvgpr_read_b32 v222, a55
    v_mfma_f32_16x16x32_bf16 a[112:115], a[208:211], v[124:127], a[112:115]
    v_accvgpr_read_b32 v211, a60
    v_accvgpr_read_b32 v215, a61
    v_accvgpr_read_b32 v219, a62
    v_accvgpr_read_b32 v223, a63
    v_mul_f32 v208, v208, v29
    v_mul_f32 v209, v209, v29
    v_mul_f32 v210, v210, v29
    v_mul_f32 v211, v211, v29
    v_mfma_f32_16x16x32_bf16 a[84:87], a[212:215], v[120:123], a[84:87]
    v_mul_f32 v212, v212, v29
    v_mul_f32 v213, v213, v29
    v_mul_f32 v214, v214, v29
    v_mul_f32 v215, v215, v29
    v_mul_f32 v216, v216, v29
    v_mul_f32 v217, v217, v29
    v_mul_f32 v218, v218, v29
    v_mul_f32 v219, v219, v29
    v_mfma_f32_16x16x32_bf16 a[116:119], a[212:215], v[124:127], a[116:119]
    v_mul_f32 v220, v220, v29
    v_mul_f32 v221, v221, v29
    v_mul_f32 v222, v222, v29
    v_mul_f32 v223, v223, v29
    v_cvt_pk_bf16_f32 v224, v208, v209
    v_cvt_pk_bf16_f32 v225, v210, v211
    v_cvt_pk_bf16_f32 v226, v212, v213
    v_cvt_pk_bf16_f32 v227, v214, v215
    v_mfma_f32_16x16x32_bf16 a[88:91], a[216:219], v[120:123], a[88:91]
    v_cvt_pk_bf16_f32 v228, v216, v217
    v_cvt_pk_bf16_f32 v229, v218, v219
    v_cvt_pk_bf16_f32 v230, v220, v221
    v_cvt_pk_bf16_f32 v231, v222, v223
    v_mov_b32_dpp v232, v224 row_ror:8 row_mask:0xf bank_mask:0xf
    v_mov_b32_dpp v233, v225 row_ror:8 row_mask:0xf bank_mask:0xf
    v_mov_b32_dpp v234, v226 row_ror:8 row_mask:0xf bank_mask:0xf
    v_mov_b32_dpp v235, v227 row_ror:8 row_mask:0xf bank_mask:0xf
    v_mfma_f32_16x16x32_bf16 a[120:123], a[216:219], v[124:127], a[120:123]
    v_mov_b32_dpp v224, v228 row_ror:8 row_mask:0xf bank_mask:0xc
    v_mov_b32_dpp v225, v229 row_ror:8 row_mask:0xf bank_mask:0xc
    v_mov_b32_dpp v226, v230 row_ror:8 row_mask:0xf bank_mask:0xc
    v_mov_b32_dpp v227, v231 row_ror:8 row_mask:0xf bank_mask:0xc
    v_mov_b32_dpp v228, v232 quad_perm:[0,1,2,3] row_mask:0xf bank_mask:0x3
    v_mov_b32_dpp v229, v233 quad_perm:[0,1,2,3] row_mask:0xf bank_mask:0x3
    v_mov_b32_dpp v230, v234 quad_perm:[0,1,2,3] row_mask:0xf bank_mask:0x3
    v_mov_b32_dpp v231, v235 quad_perm:[0,1,2,3] row_mask:0xf bank_mask:0x3
    v_mfma_f32_16x16x32_bf16 a[92:95], a[220:223], v[120:123], a[92:95]
    buffer_store_dwordx4 v[224:227], v160, s[56:59], s80 offen offset:128 sc1
    buffer_store_dwordx4 v[228:231], v160, s[56:59], s80 offen offset:2176 sc1
    v_mfma_f32_16x16x32_bf16 a[124:127], a[220:223], v[124:127], a[124:127]
    s_nop 7
    v_rcp_f32 v28, v92
    v_rcp_f32 v29, v93
    v_accvgpr_read_b32 v176, a64
    v_accvgpr_read_b32 v180, a65
    v_accvgpr_read_b32 v184, a66
    v_accvgpr_read_b32 v188, a67
    v_accvgpr_read_b32 v177, a72
    v_accvgpr_read_b32 v181, a73
    v_accvgpr_read_b32 v185, a74
    v_accvgpr_read_b32 v189, a75
    v_accvgpr_read_b32 v178, a80
    v_accvgpr_read_b32 v182, a81
    v_accvgpr_read_b32 v186, a82
    v_accvgpr_read_b32 v190, a83
    v_accvgpr_read_b32 v179, a88
    v_accvgpr_read_b32 v183, a89
    v_accvgpr_read_b32 v187, a90
    v_accvgpr_read_b32 v191, a91
    v_pk_mul_f32 v[176:177], v[176:177], v[28:29] op_sel:[0,0] op_sel_hi:[1,0]
    v_pk_mul_f32 v[178:179], v[178:179], v[28:29] op_sel:[0,0] op_sel_hi:[1,0]
    v_pk_mul_f32 v[180:181], v[180:181], v[28:29] op_sel:[0,0] op_sel_hi:[1,0]
    v_pk_mul_f32 v[182:183], v[182:183], v[28:29] op_sel:[0,0] op_sel_hi:[1,0]
    v_pk_mul_f32 v[184:185], v[184:185], v[28:29] op_sel:[0,0] op_sel_hi:[1,0]
    v_pk_mul_f32 v[186:187], v[186:187], v[28:29] op_sel:[0,0] op_sel_hi:[1,0]
    v_pk_mul_f32 v[188:189], v[188:189], v[28:29] op_sel:[0,0] op_sel_hi:[1,0]
    v_pk_mul_f32 v[190:191], v[190:191], v[28:29] op_sel:[0,0] op_sel_hi:[1,0]
    v_cvt_pk_bf16_f32 v192, v176, v177
    v_cvt_pk_bf16_f32 v193, v178, v179
    v_cvt_pk_bf16_f32 v194, v180, v181
    v_cvt_pk_bf16_f32 v195, v182, v183
    v_cvt_pk_bf16_f32 v196, v184, v185
    v_cvt_pk_bf16_f32 v197, v186, v187
    v_cvt_pk_bf16_f32 v198, v188, v189
    v_cvt_pk_bf16_f32 v199, v190, v191
    v_mov_b32_dpp v200, v192 row_ror:8 row_mask:0xf bank_mask:0xf
    v_mov_b32_dpp v201, v193 row_ror:8 row_mask:0xf bank_mask:0xf
    v_mov_b32_dpp v202, v194 row_ror:8 row_mask:0xf bank_mask:0xf
    v_mov_b32_dpp v203, v195 row_ror:8 row_mask:0xf bank_mask:0xf
    v_mov_b32_dpp v192, v196 row_ror:8 row_mask:0xf bank_mask:0xc
    v_mov_b32_dpp v193, v197 row_ror:8 row_mask:0xf bank_mask:0xc
    v_mov_b32_dpp v194, v198 row_ror:8 row_mask:0xf bank_mask:0xc
    v_mov_b32_dpp v195, v199 row_ror:8 row_mask:0xf bank_mask:0xc
    v_mov_b32_dpp v196, v200 quad_perm:[0,1,2,3] row_mask:0xf bank_mask:0x3
    v_mov_b32_dpp v197, v201 quad_perm:[0,1,2,3] row_mask:0xf bank_mask:0x3
    v_mov_b32_dpp v198, v202 quad_perm:[0,1,2,3] row_mask:0xf bank_mask:0x3
    v_mov_b32_dpp v199, v203 quad_perm:[0,1,2,3] row_mask:0xf bank_mask:0x3
    buffer_store_dwordx4 v[192:195], v160, s[56:59], s81 offen offset:0 sc1
    buffer_store_dwordx4 v[196:199], v160, s[56:59], s81 offen offset:2048 sc1
    v_accvgpr_read_b32 v208, a68
    v_accvgpr_read_b32 v212, a69
    v_accvgpr_read_b32 v216, a70
    v_accvgpr_read_b32 v220, a71
    v_accvgpr_read_b32 v209, a76
    v_accvgpr_read_b32 v213, a77
    v_accvgpr_read_b32 v217, a78
    v_accvgpr_read_b32 v221, a79
    v_accvgpr_read_b32 v210, a84
    v_accvgpr_read_b32 v214, a85
    v_accvgpr_read_b32 v218, a86
    v_accvgpr_read_b32 v222, a87
    v_accvgpr_read_b32 v211, a92
    v_accvgpr_read_b32 v215, a93
    v_accvgpr_read_b32 v219, a94
    v_accvgpr_read_b32 v223, a95
    v_pk_mul_f32 v[208:209], v[208:209], v[28:29] op_sel:[0,0] op_sel_hi:[1,0]
    v_pk_mul_f32 v[210:211], v[210:211], v[28:29] op_sel:[0,0] op_sel_hi:[1,0]
    v_pk_mul_f32 v[212:213], v[212:213], v[28:29] op_sel:[0,0] op_sel_hi:[1,0]
    v_pk_mul_f32 v[214:215], v[214:215], v[28:29] op_sel:[0,0] op_sel_hi:[1,0]
    v_pk_mul_f32 v[216:217], v[216:217], v[28:29] op_sel:[0,0] op_sel_hi:[1,0]
    v_pk_mul_f32 v[218:219], v[218:219], v[28:29] op_sel:[0,0] op_sel_hi:[1,0]
    v_pk_mul_f32 v[220:221], v[220:221], v[28:29] op_sel:[0,0] op_sel_hi:[1,0]
    v_pk_mul_f32 v[222:223], v[222:223], v[28:29] op_sel:[0,0] op_sel_hi:[1,0]
    v_cvt_pk_bf16_f32 v224, v208, v209
    v_cvt_pk_bf16_f32 v225, v210, v211
    v_cvt_pk_bf16_f32 v226, v212, v213
    v_cvt_pk_bf16_f32 v227, v214, v215
    v_cvt_pk_bf16_f32 v228, v216, v217
    v_cvt_pk_bf16_f32 v229, v218, v219
    v_cvt_pk_bf16_f32 v230, v220, v221
    v_cvt_pk_bf16_f32 v231, v222, v223
    v_mov_b32_dpp v232, v224 row_ror:8 row_mask:0xf bank_mask:0xf
    v_mov_b32_dpp v233, v225 row_ror:8 row_mask:0xf bank_mask:0xf
    v_mov_b32_dpp v234, v226 row_ror:8 row_mask:0xf bank_mask:0xf
    v_mov_b32_dpp v235, v227 row_ror:8 row_mask:0xf bank_mask:0xf
    v_mov_b32_dpp v224, v228 row_ror:8 row_mask:0xf bank_mask:0xc
    v_mov_b32_dpp v225, v229 row_ror:8 row_mask:0xf bank_mask:0xc
    v_mov_b32_dpp v226, v230 row_ror:8 row_mask:0xf bank_mask:0xc
    v_mov_b32_dpp v227, v231 row_ror:8 row_mask:0xf bank_mask:0xc
    v_mov_b32_dpp v228, v232 quad_perm:[0,1,2,3] row_mask:0xf bank_mask:0x3
    v_mov_b32_dpp v229, v233 quad_perm:[0,1,2,3] row_mask:0xf bank_mask:0x3
    v_mov_b32_dpp v230, v234 quad_perm:[0,1,2,3] row_mask:0xf bank_mask:0x3
    v_mov_b32_dpp v231, v235 quad_perm:[0,1,2,3] row_mask:0xf bank_mask:0x3
    buffer_store_dwordx4 v[224:227], v160, s[56:59], s81 offen offset:128 sc1
    buffer_store_dwordx4 v[228:231], v160, s[56:59], s81 offen offset:2176 sc1
    v_accvgpr_read_b32 v176, a96
    v_accvgpr_read_b32 v180, a97
    v_accvgpr_read_b32 v184, a98
    v_accvgpr_read_b32 v188, a99
    v_accvgpr_read_b32 v177, a104
    v_accvgpr_read_b32 v181, a105
    v_accvgpr_read_b32 v185, a106
    v_accvgpr_read_b32 v189, a107
    v_accvgpr_read_b32 v178, a112
    v_accvgpr_read_b32 v182, a113
    v_accvgpr_read_b32 v186, a114
    v_accvgpr_read_b32 v190, a115
    v_accvgpr_read_b32 v179, a120
    v_accvgpr_read_b32 v183, a121
    v_accvgpr_read_b32 v187, a122
    v_accvgpr_read_b32 v191, a123
    v_pk_mul_f32 v[176:177], v[176:177], v[28:29] op_sel:[0,1] op_sel_hi:[1,1]
    v_pk_mul_f32 v[178:179], v[178:179], v[28:29] op_sel:[0,1] op_sel_hi:[1,1]
    v_pk_mul_f32 v[180:181], v[180:181], v[28:29] op_sel:[0,1] op_sel_hi:[1,1]
    v_pk_mul_f32 v[182:183], v[182:183], v[28:29] op_sel:[0,1] op_sel_hi:[1,1]
    v_pk_mul_f32 v[184:185], v[184:185], v[28:29] op_sel:[0,1] op_sel_hi:[1,1]
    v_pk_mul_f32 v[186:187], v[186:187], v[28:29] op_sel:[0,1] op_sel_hi:[1,1]
    v_pk_mul_f32 v[188:189], v[188:189], v[28:29] op_sel:[0,1] op_sel_hi:[1,1]
    v_pk_mul_f32 v[190:191], v[190:191], v[28:29] op_sel:[0,1] op_sel_hi:[1,1]
    v_cvt_pk_bf16_f32 v192, v176, v177
    v_cvt_pk_bf16_f32 v193, v178, v179
    v_cvt_pk_bf16_f32 v194, v180, v181
    v_cvt_pk_bf16_f32 v195, v182, v183
    v_cvt_pk_bf16_f32 v196, v184, v185
    v_cvt_pk_bf16_f32 v197, v186, v187
    v_cvt_pk_bf16_f32 v198, v188, v189
    v_cvt_pk_bf16_f32 v199, v190, v191
    v_mov_b32_dpp v200, v192 row_ror:8 row_mask:0xf bank_mask:0xf
    v_mov_b32_dpp v201, v193 row_ror:8 row_mask:0xf bank_mask:0xf
    v_mov_b32_dpp v202, v194 row_ror:8 row_mask:0xf bank_mask:0xf
    v_mov_b32_dpp v203, v195 row_ror:8 row_mask:0xf bank_mask:0xf
    v_mov_b32_dpp v192, v196 row_ror:8 row_mask:0xf bank_mask:0xc
    v_mov_b32_dpp v193, v197 row_ror:8 row_mask:0xf bank_mask:0xc
    v_mov_b32_dpp v194, v198 row_ror:8 row_mask:0xf bank_mask:0xc
    v_mov_b32_dpp v195, v199 row_ror:8 row_mask:0xf bank_mask:0xc
    v_mov_b32_dpp v196, v200 quad_perm:[0,1,2,3] row_mask:0xf bank_mask:0x3
    v_mov_b32_dpp v197, v201 quad_perm:[0,1,2,3] row_mask:0xf bank_mask:0x3
    v_mov_b32_dpp v198, v202 quad_perm:[0,1,2,3] row_mask:0xf bank_mask:0x3
    v_mov_b32_dpp v199, v203 quad_perm:[0,1,2,3] row_mask:0xf bank_mask:0x3
    buffer_store_dwordx4 v[192:195], v160, s[56:59], s82 offen offset:0 sc1
    buffer_store_dwordx4 v[196:199], v160, s[56:59], s82 offen offset:2048 sc1
    v_accvgpr_read_b32 v208, a100
    v_accvgpr_read_b32 v212, a101
    v_accvgpr_read_b32 v216, a102
    v_accvgpr_read_b32 v220, a103
    v_accvgpr_read_b32 v209, a108
    v_accvgpr_read_b32 v213, a109
    v_accvgpr_read_b32 v217, a110
    v_accvgpr_read_b32 v221, a111
    v_accvgpr_read_b32 v210, a116
    v_accvgpr_read_b32 v214, a117
    v_accvgpr_read_b32 v218, a118
    v_accvgpr_read_b32 v222, a119
    v_accvgpr_read_b32 v211, a124
    v_accvgpr_read_b32 v215, a125
    v_accvgpr_read_b32 v219, a126
    v_accvgpr_read_b32 v223, a127
    v_pk_mul_f32 v[208:209], v[208:209], v[28:29] op_sel:[0,1] op_sel_hi:[1,1]
    v_pk_mul_f32 v[210:211], v[210:211], v[28:29] op_sel:[0,1] op_sel_hi:[1,1]
    v_pk_mul_f32 v[212:213], v[212:213], v[28:29] op_sel:[0,1] op_sel_hi:[1,1]
    v_pk_mul_f32 v[214:215], v[214:215], v[28:29] op_sel:[0,1] op_sel_hi:[1,1]
    v_pk_mul_f32 v[216:217], v[216:217], v[28:29] op_sel:[0,1] op_sel_hi:[1,1]
    v_pk_mul_f32 v[218:219], v[218:219], v[28:29] op_sel:[0,1] op_sel_hi:[1,1]
    v_pk_mul_f32 v[220:221], v[220:221], v[28:29] op_sel:[0,1] op_sel_hi:[1,1]
    v_pk_mul_f32 v[222:223], v[222:223], v[28:29] op_sel:[0,1] op_sel_hi:[1,1]
    v_cvt_pk_bf16_f32 v224, v208, v209
    v_cvt_pk_bf16_f32 v225, v210, v211
    v_cvt_pk_bf16_f32 v226, v212, v213
    v_cvt_pk_bf16_f32 v227, v214, v215
    v_cvt_pk_bf16_f32 v228, v216, v217
    v_cvt_pk_bf16_f32 v229, v218, v219
    v_cvt_pk_bf16_f32 v230, v220, v221
    v_cvt_pk_bf16_f32 v231, v222, v223
    v_mov_b32_dpp v232, v224 row_ror:8 row_mask:0xf bank_mask:0xf
    v_mov_b32_dpp v233, v225 row_ror:8 row_mask:0xf bank_mask:0xf
    v_mov_b32_dpp v234, v226 row_ror:8 row_mask:0xf bank_mask:0xf
    v_mov_b32_dpp v235, v227 row_ror:8 row_mask:0xf bank_mask:0xf
    v_mov_b32_dpp v224, v228 row_ror:8 row_mask:0xf bank_mask:0xc
    v_mov_b32_dpp v225, v229 row_ror:8 row_mask:0xf bank_mask:0xc
    v_mov_b32_dpp v226, v230 row_ror:8 row_mask:0xf bank_mask:0xc
    v_mov_b32_dpp v227, v231 row_ror:8 row_mask:0xf bank_mask:0xc
    v_mov_b32_dpp v228, v232 quad_perm:[0,1,2,3] row_mask:0xf bank_mask:0x3
    v_mov_b32_dpp v229, v233 quad_perm:[0,1,2,3] row_mask:0xf bank_mask:0x3
    v_mov_b32_dpp v230, v234 quad_perm:[0,1,2,3] row_mask:0xf bank_mask:0x3
    v_mov_b32_dpp v231, v235 quad_perm:[0,1,2,3] row_mask:0xf bank_mask:0x3
    buffer_store_dwordx4 v[224:227], v160, s[56:59], s82 offen offset:128 sc1
    buffer_store_dwordx4 v[228:231], v160, s[56:59], s82 offen offset:2176 sc1
L_done:
    s_endpgm
L_fh0:
    s_mov_b32 s84, 0x40000
L_spin4:
    buffer_load_dwordx2 v[4:5], v8, s[8:11], s88 offen sc1
    s_waitcnt vmcnt(0)
    v_cmp_eq_u64 vcc, v[4:5], v[6:7]
    s_nop 3
    s_andn2_b32 s83, 0xfffffff0, vcc_lo
    s_cbranch_scc0 L_spun4
    s_sleep 8
    s_sub_u32 s84, s84, 1
    s_cmp_lg_u32 s84, 0
    s_cbranch_scc1 L_spin4
L_spun4:
    s_branch L_fhret0
L_fh1:
    s_mov_b32 s84, 0x40000
L_spin5:
    buffer_load_dwordx2 v[4:5], v8, s[8:11], s88 offen sc1
    s_waitcnt vmcnt(0)
    v_cmp_eq_u64 vcc, v[4:5], v[6:7]
    s_nop 3
    s_andn2_b32 s83, 0xfffffff0, vcc_lo
    s_cbranch_scc0 L_spun5
    s_sleep 8
    s_sub_u32 s84, s84, 1
    s_cmp_lg_u32 s84, 0
    s_cbranch_scc1 L_spin5
L_spun5:
    s_branch L_fhret1
L_tramp0:
    s_mov_b32 s67, 0
    s_branch L_rare01
L_tramp4:
    s_mov_b32 s67, 4
    s_branch L_rare01
L_tramp8:
    s_mov_b32 s67, 8
    s_branch L_rare01
L_tramp12:
    s_mov_b32 s67, 12
    s_branch L_rare01
L_tramp16:
    s_mov_b32 s67, 16
    s_branch L_rare01
L_tramp20:
    s_mov_b32 s67, 20
    s_branch L_rare01
L_tramp24:
    s_mov_b32 s67, 24
    s_branch L_rare01
L_tramp28:
    s_mov_b32 s67, 28
    s_branch L_rare01
L_tramp32:
    s_mov_b32 s67, 32
    s_branch L_rare01
L_tramp36:
    s_mov_b32 s67, 36
    s_branch L_rare01
L_tramp40:
    s_mov_b32 s67, 40
    s_branch L_rare01
L_tramp44:
    s_mov_b32 s67, 44
    s_branch L_rare01
L_tramp48:
    s_mov_b32 s67, 48
    s_branch L_rare01
L_tramp52:
    s_mov_b32 s67, 52
    s_branch L_rare01
L_tramp56:
    s_mov_b32 s67, 56
    s_branch L_rare01
L_tramp60:
    s_mov_b32 s67, 60
    s_branch L_rare01
L_tramp1:
    s_mov_b32 s67, 1
    s_branch L_rare11
L_tramp5:
    s_mov_b32 s67, 5
    s_branch L_rare11
L_tramp9:
    s_mov_b32 s67, 9
    s_branch L_rare11
L_tramp13:
    s_mov_b32 s67, 13
    s_branch L_rare11
L_tramp17:
    s_mov_b32 s67, 17
    s_branch L_rare11
L_tramp21:
    s_mov_b32 s67, 21
    s_branch L_rare11
L_tramp25:
    s_mov_b32 s67, 25
    s_branch L_rare11
L_tramp29:
    s_mov_b32 s67, 29
    s_branch L_rare11
L_tramp33:
    s_mov_b32 s67, 33
    s_branch L_rare11
L_tramp37:
    s_mov_b32 s67, 37
    s_branch L_rare11
L_tramp41:
    s_mov_b32 s67, 41
    s_branch L_rare11
L_tramp45:
    s_mov_b32 s67, 45
    s_branch L_rare11
L_tramp49:
    s_mov_b32 s67, 49
    s_branch L_rare11
L_tramp53:
    s_mov_b32 s67, 53
    s_branch L_rare11
L_tramp57:
    s_mov_b32 s67, 57
    s_branch L_rare11
L_tramp61:
    s_mov_b32 s67, 61
    s_branch L_rare11
L_tramp2:
    s_mov_b32 s67, 2
    s_branch L_rare00
L_tramp6:
    s_mov_b32 s67, 6
    s_branch L_rare00
L_tramp10:
    s_mov_b32 s67, 10
    s_branch L_rare00
L_tramp14:
    s_mov_b32 s67, 14
    s_branch L_rare00
L_tramp18:
    s_mov_b32 s67, 18
    s_branch L_rare00
L_tramp22:
    s_mov_b32 s67, 22
    s_branch L_rare00
L_tramp26:
    s_mov_b32 s67, 26
    s_branch L_rare00
L_tramp30:
    s_mov_b32 s67, 30
    s_branch L_rare00
L_tramp34:
    s_mov_b32 s67, 34
    s_branch L_rare00
L_tramp38:
    s_mov_b32 s67, 38
    s_branch L_rare00
L_tramp42:
    s_mov_b32 s67, 42
    s_branch L_rare00
L_tramp46:
    s_mov_b32 s67, 46
    s_branch L_rare00
L_tramp50:
    s_mov_b32 s67, 50
    s_branch L_rare00
L_tramp54:
    s_mov_b32 s67, 54
    s_branch L_rare00
L_tramp58:
    s_mov_b32 s67, 58
    s_branch L_rare00
L_tramp3:
    s_mov_b32 s67, 3
    s_branch L_rare10
L_tramp7:
    s_mov_b32 s67, 7
    s_branch L_rare10
L_tramp11:
    s_mov_b32 s67, 11
    s_branch L_rare10
L_tramp15:
    s_mov_b32 s67, 15
    s_branch L_rare10
L_tramp19:
    s_mov_b32 s67, 19
    s_branch L_rare10
L_tramp23:
    s_mov_b32 s67, 23
    s_branch L_rare10
L_tramp27:
    s_mov_b32 s67, 27
    s_branch L_rare10
L_tramp31:
    s_mov_b32 s67, 31
    s_branch L_rare10
L_tramp35:
    s_mov_b32 s67, 35
    s_branch L_rare10
L_tramp39:
    s_mov_b32 s67, 39
    s_branch L_rare10
L_tramp43:
    s_mov_b32 s67, 43
    s_branch L_rare10
L_tramp47:
    s_mov_b32 s67, 47
    s_branch L_rare10
L_tramp51:
    s_mov_b32 s67, 51
    s_branch L_rare10
L_tramp55:
    s_mov_b32 s67, 55
    s_branch L_rare10
L_tramp59:
    s_mov_b32 s67, 59
    s_branch L_rare10
L_rare01:
    s_nop 7
    v_max3_f32 v22, v32, v33, v34
    v_max3_f32 v22, v22, v35, v36
    v_max3_f32 v22, v22, v37, v38
    v_max_f32 v22, v22, v39
    v_mov_b32 v23, v22
    s_nop 1
    v_permlane32_swap_b32 v22, v23
    v_max_f32 v22, v22, v23
    v_mov_b32 v23, v22
    s_nop 1
    v_permlane16_swap_b32 v22, v23
    v_max_f32 v22, v22, v23
    v_max_f32 v22, 0, v22
    v_exp_f32_e64 v23, -v22
    v_sub_f32 v32, v32, v22
    v_sub_f32 v33, v33, v22
    v_sub_f32 v34, v34, v22
    v_sub_f32 v35, v35, v22
    v_sub_f32 v36, v36, v22
    v_sub_f32 v37, v37, v22
    v_sub_f32 v38, v38, v22
    v_sub_f32 v39, v39, v22
    v_sub_f32 v64, v64, v22
    v_sub_f32 v65, v65, v22
    v_sub_f32 v66, v66, v22
    v_sub_f32 v67, v67, v22
    v_mul_f32 v80, v80, v23
    v_accvgpr_read_b32 v24, a0
    v_accvgpr_read_b32 v25, a1
    v_accvgpr_read_b32 v26, a2
    v_accvgpr_read_b32 v27, a3
    v_mul_f32 v24, v24, v23
    v_mul_f32 v25, v25, v23
    v_mul_f32 v26, v26, v23
    v_mul_f32 v27, v27, v23
    v_accvgpr_write_b32 a0, v24
    v_accvgpr_write_b32 a1, v25
    v_accvgpr_write_b32 a2, v26
    v_accvgpr_write_b32 a3, v27
    v_accvgpr_read_b32 v24, a4
    v_accvgpr_read_b32 v25, a5
    v_accvgpr_read_b32 v26, a6
    v_accvgpr_read_b32 v27, a7
    v_mul_f32 v24, v24, v23
    v_mul_f32 v25, v25, v23
    v_mul_f32 v26, v26, v23
    v_mul_f32 v27, v27, v23
    v_accvgpr_write_b32 a4, v24
    v_accvgpr_write_b32 a5, v25
    v_accvgpr_write_b32 a6, v26
    v_accvgpr_write_b32 a7, v27
    v_accvgpr_read_b32 v24, a8
    v_accvgpr_read_b32 v25, a9
    v_accvgpr_read_b32 v26, a10
    v_accvgpr_read_b32 v27, a11
    v_mul_f32 v24, v24, v23
    v_mul_f32 v25, v25, v23
    v_mul_f32 v26, v26, v23
    v_mul_f32 v27, v27, v23
    v_accvgpr_write_b32 a8, v24
    v_accvgpr_write_b32 a9, v25
    v_accvgpr_write_b32 a10, v26
    v_accvgpr_write_b32 a11, v27
    v_accvgpr_read_b32 v24, a12
    v_accvgpr_read_b32 v25, a13
    v_accvgpr_read_b32 v26, a14
    v_accvgpr_read_b32 v27, a15
    v_mul_f32 v24, v24, v23
    v_mul_f32 v25, v25, v23
    v_mul_f32 v26, v26, v23
    v_mul_f32 v27, v27, v23
    v_accvgpr_write_b32 a12, v24
    v_accvgpr_write_b32 a13, v25
    v_accvgpr_write_b32 a14, v26
    v_accvgpr_write_b32 a15, v27
    v_accvgpr_read_b32 v24, a16
    v_accvgpr_read_b32 v25, a17
    v_accvgpr_read_b32 v26, a18
    v_accvgpr_read_b32 v27, a19
    v_mul_f32 v24, v24, v23
    v_mul_f32 v25, v25, v23
    v_mul_f32 v26, v26, v23
    v_mul_f32 v27, v27, v23
    v_accvgpr_write_b32 a16, v24
    v_accvgpr_write_b32 a17, v25
    v_accvgpr_write_b32 a18, v26
    v_accvgpr_write_b32 a19, v27
    v_accvgpr_read_b32 v24, a20
    v_accvgpr_read_b32 v25, a21
    v_accvgpr_read_b32 v26, a22
    v_accvgpr_read_b32 v27, a23
    v_mul_f32 v24, v24, v23
    v_mul_f32 v25, v25, v23
    v_mul_f32 v26, v26, v23
    v_mul_f32 v27, v27, v23
    v_accvgpr_write_b32 a20, v24
    v_accvgpr_write_b32 a21, v25
    v_accvgpr_write_b32 a22, v26
    v_accvgpr_write_b32 a23, v27
    v_accvgpr_read_b32 v24, a24
    v_accvgpr_read_b32 v25, a25
    v_accvgpr_read_b32 v26, a26
    v_accvgpr_read_b32 v27, a27
    v_mul_f32 v24, v24, v23
    v_mul_f32 v25, v25, v23
    v_mul_f32 v26, v26, v23
    v_mul_f32 v27, v27, v23
    v_accvgpr_write_b32 a24, v24
    v_accvgpr_write_b32 a25, v25
    v_accvgpr_write_b32 a26, v26
    v_accvgpr_write_b32 a27, v27
    v_accvgpr_read_b32 v24, a28
    v_accvgpr_read_b32 v25, a29
    v_accvgpr_read_b32 v26, a30
    v_accvgpr_read_b32 v27, a31
    v_mul_f32 v24, v24, v23
    v_mul_f32 v25, v25, v23
    v_mul_f32 v26, v26, v23
    v_mul_f32 v27, v27, v23
    v_accvgpr_write_b32 a28, v24
    v_accvgpr_write_b32 a29, v25
    v_accvgpr_write_b32 a30, v26
    v_accvgpr_write_b32 a31, v27
    v_exp_f32 v24, v32
    v_exp_f32 v25, v33
    s_nop 0
    v_cvt_pk_bf16_f32 v112, v24, v25
    v_exp_f32 v26, v34
    v_exp_f32 v27, v35
    s_nop 0
    v_cvt_pk_bf16_f32 v113, v26, v27
    v_exp_f32 v24, v36
    v_exp_f32 v25, v37
    s_nop 0
    v_cvt_pk_bf16_f32 v114, v24, v25
    v_exp_f32 v26, v38
    v_exp_f32 v27, v39
    s_nop 0
    v_cvt_pk_bf16_f32 v115, v26, v27
    v_max3_f32 v22, v40, v41, v42
    v_max3_f32 v22, v22, v43, v44
    v_max3_f32 v22, v22, v45, v46
    v_max_f32 v22, v22, v47
    v_mov_b32 v23, v22
    s_nop 1
    v_permlane32_swap_b32 v22, v23
    v_max_f32 v22, v22, v23
    v_mov_b32 v23, v22
    s_nop 1
    v_permlane16_swap_b32 v22, v23
    v_max_f32 v22, v22, v23
    v_max_f32 v22, 0, v22
    v_exp_f32_e64 v23, -v22
    v_sub_f32 v40, v40, v22
    v_sub_f32 v41, v41, v22
    v_sub_f32 v42, v42, v22
    v_sub_f32 v43, v43, v22
    v_sub_f32 v44, v44, v22
    v_sub_f32 v45, v45, v22
    v_sub_f32 v46, v46, v22
    v_sub_f32 v47, v47, v22
    v_sub_f32 v68, v68, v22
    v_sub_f32 v69, v69, v22
    v_sub_f32 v70, v70, v22
    v_sub_f32 v71, v71, v22
    v_mul_f32 v81, v81, v23
    v_accvgpr_read_b32 v24, a32
    v_accvgpr_read_b32 v25, a33
    v_accvgpr_read_b32 v26, a34
    v_accvgpr_read_b32 v27, a35
    v_mul_f32 v24, v24, v23
    v_mul_f32 v25, v25, v23
    v_mul_f32 v26, v26, v23
    v_mul_f32 v27, v27, v23
    v_accvgpr_write_b32 a32, v24
    v_accvgpr_write_b32 a33, v25
    v_accvgpr_write_b32 a34, v26
    v_accvgpr_write_b32 a35, v27
    v_accvgpr_read_b32 v24, a36
    v_accvgpr_read_b32 v25, a37
    v_accvgpr_read_b32 v26, a38
    v_accvgpr_read_b32 v27, a39
    v_mul_f32 v24, v24, v23
    v_mul_f32 v25, v25, v23
    v_mul_f32 v26, v26, v23
    v_mul_f32 v27, v27, v23
    v_accvgpr_write_b32 a36, v24
    v_accvgpr_write_b32 a37, v25
    v_accvgpr_write_b32 a38, v26
    v_accvgpr_write_b32 a39, v27
    v_accvgpr_read_b32 v24, a40
    v_accvgpr_read_b32 v25, a41
    v_accvgpr_read_b32 v26, a42
    v_accvgpr_read_b32 v27, a43
    v_mul_f32 v24, v24, v23
    v_mul_f32 v25, v25, v23
    v_mul_f32 v26, v26, v23
    v_mul_f32 v27, v27, v23
    v_accvgpr_write_b32 a40, v24
    v_accvgpr_write_b32 a41, v25
    v_accvgpr_write_b32 a42, v26
    v_accvgpr_write_b32 a43, v27
    v_accvgpr_read_b32 v24, a44
    v_accvgpr_read_b32 v25, a45
    v_accvgpr_read_b32 v26, a46
    v_accvgpr_read_b32 v27, a47
    v_mul_f32 v24, v24, v23
    v_mul_f32 v25, v25, v23
    v_mul_f32 v26, v26, v23
    v_mul_f32 v27, v27, v23
    v_accvgpr_write_b32 a44, v24
    v_accvgpr_write_b32 a45, v25
    v_accvgpr_write_b32 a46, v26
    v_accvgpr_write_b32 a47, v27
    v_accvgpr_read_b32 v24, a48
    v_accvgpr_read_b32 v25, a49
    v_accvgpr_read_b32 v26, a50
    v_accvgpr_read_b32 v27, a51
    v_mul_f32 v24, v24, v23
    v_mul_f32 v25, v25, v23
    v_mul_f32 v26, v26, v23
    v_mul_f32 v27, v27, v23
    v_accvgpr_write_b32 a48, v24
    v_accvgpr_write_b32 a49, v25
    v_accvgpr_write_b32 a50, v26
    v_accvgpr_write_b32 a51, v27
    v_accvgpr_read_b32 v24, a52
    v_accvgpr_read_b32 v25, a53
    v_accvgpr_read_b32 v26, a54
    v_accvgpr_read_b32 v27, a55
    v_mul_f32 v24, v24, v23
    v_mul_f32 v25, v25, v23
    v_mul_f32 v26, v26, v23
    v_mul_f32 v27, v27, v23
    v_accvgpr_write_b32 a52, v24
    v_accvgpr_write_b32 a53, v25
    v_accvgpr_write_b32 a54, v26
    v_accvgpr_write_b32 a55, v27
    v_accvgpr_read_b32 v24, a56
    v_accvgpr_read_b32 v25, a57
    v_accvgpr_read_b32 v26, a58
    v_accvgpr_read_b32 v27, a59
    v_mul_f32 v24, v24, v23
    v_mul_f32 v25, v25, v23
    v_mul_f32 v26, v26, v23
    v_mul_f32 v27, v27, v23
    v_accvgpr_write_b32 a56, v24
    v_accvgpr_write_b32 a57, v25
    v_accvgpr_write_b32 a58, v26
    v_accvgpr_write_b32 a59, v27
    v_accvgpr_read_b32 v24, a60
    v_accvgpr_read_b32 v25, a61
    v_accvgpr_read_b32 v26, a62
    v_accvgpr_read_b32 v27, a63
    v_mul_f32 v24, v24, v23
    v_mul_f32 v25, v25, v23
    v_mul_f32 v26, v26, v23
    v_mul_f32 v27, v27, v23
    v_accvgpr_write_b32 a60, v24
    v_accvgpr_write_b32 a61, v25
    v_accvgpr_write_b32 a62, v26
    v_accvgpr_write_b32 a63, v27
    v_exp_f32 v24, v40
    v_exp_f32 v25, v41
    s_nop 0
    v_cvt_pk_bf16_f32 v116, v24, v25
    v_exp_f32 v26, v42
    v_exp_f32 v27, v43
    s_nop 0
    v_cvt_pk_bf16_f32 v117, v26, v27
    v_exp_f32 v24, v44
    v_exp_f32 v25, v45
    s_nop 0
    v_cvt_pk_bf16_f32 v118, v24, v25
    v_exp_f32 v26, v46
    v_exp_f32 v27, v47
    s_nop 0
    v_cvt_pk_bf16_f32 v119, v26, v27
    v_add_f32 v82, v80, v81
    s_nop 1
    v_mfma_f32_16x16x32_bf16 v[84:87], v[14:17], v[112:115], v[80:83]
    v_mfma_f32_16x16x32_bf16 v[84:87], v[18:21], v[116:119], v[84:87]
    s_nop 7
    s_cmp_eq_u32 s67, 0
    s_cbranch_scc1 L_ret0
    s_cmp_eq_u32 s67, 4
    s_cbranch_scc1 L_ret4
    s_cmp_eq_u32 s67, 8
    s_cbranch_scc1 L_ret8
    s_cmp_eq_u32 s67, 12
    s_cbranch_scc1 L_ret12
    s_cmp_eq_u32 s67, 16
    s_cbranch_scc1 L_ret16
    s_cmp_eq_u32 s67, 20
    s_cbranch_scc1 L_ret20
    s_cmp_eq_u32 s67, 24
    s_cbranch_scc1 L_ret24
    s_cmp_eq_u32 s67, 28
    s_cbranch_scc1 L_ret28
    s_cmp_eq_u32 s67, 32
    s_cbranch_scc1 L_ret32
    s_cmp_eq_u32 s67, 36
    s_cbranch_scc1 L_ret36
    s_cmp_eq_u32 s67, 40
    s_cbranch_scc1 L_ret40
    s_cmp_eq_u32 s67, 44
    s_cbranch_scc1 L_ret44
    s_cmp_eq_u32 s67, 48
    s_cbranch_scc1 L_ret48
    s_cmp_eq_u32 s67, 52
    s_cbranch_scc1 L_ret52
    s_cmp_eq_u32 s67, 56
    s_cbranch_scc1 L_ret56
    s_branch L_ret60
L_rare11:
    s_nop 7
    v_max3_f32 v22, v48, v49, v50
    v_max3_f32 v22, v22, v51, v52
    v_max3_f32 v22, v22, v53, v54
    v_max_f32 v22, v22, v55
    v_mov_b32 v23, v22
    s_nop 1
    v_permlane32_swap_b32 v22, v23
    v_max_f32 v22, v22, v23
    v_mov_b32 v23, v22
    s_nop 1
    v_permlane16_swap_b32 v22, v23
    v_max_f32 v22, v22, v23
    v_max_f32 v22, 0, v22
    v_exp_f32_e64 v23, -v22
    v_sub_f32 v48, v48, v22
    v_sub_f32 v49, v49, v22
    v_sub_f32 v50, v50, v22
    v_sub_f32 v51, v51, v22
    v_sub_f32 v52, v52, v22
    v_sub_f32 v53, v53, v22
    v_sub_f32 v54, v54, v22
    v_sub_f32 v55, v55, v22
    v_sub_f32 v72, v72, v22
    v_sub_f32 v73, v73, v22
    v_sub_f32 v74, v74, v22
    v_sub_f32 v75, v75, v22
    v_mul_f32 v88, v88, v23
    v_accvgpr_read_b32 v24, a64
    v_accvgpr_read_b32 v25, a65
    v_accvgpr_read_b32 v26, a66
    v_accvgpr_read_b32 v27, a67
    v_mul_f32 v24, v24, v23
    v_mul_f32 v25, v25, v23
    v_mul_f32 v26, v26, v23
    v_mul_f32 v27, v27, v23
    v_accvgpr_write_b32 a64, v24
    v_accvgpr_write_b32 a65, v25
    v_accvgpr_write_b32 a66, v26
    v_accvgpr_write_b32 a67, v27
    v_accvgpr_read_b32 v24, a68
    v_accvgpr_read_b32 v25, a69
    v_accvgpr_read_b32 v26, a70
    v_accvgpr_read_b32 v27, a71
    v_mul_f32 v24, v24, v23
    v_mul_f32 v25, v25, v23
    v_mul_f32 v26, v26, v23
    v_mul_f32 v27, v27, v23
    v_accvgpr_write_b32 a68, v24
    v_accvgpr_write_b32 a69, v25
    v_accvgpr_write_b32 a70, v26
    v_accvgpr_write_b32 a71, v27
    v_accvgpr_read_b32 v24, a72
    v_accvgpr_read_b32 v25, a73
    v_accvgpr_read_b32 v26, a74
    v_accvgpr_read_b32 v27, a75
    v_mul_f32 v24, v24, v23
    v_mul_f32 v25, v25, v23
    v_mul_f32 v26, v26, v23
    v_mul_f32 v27, v27, v23
    v_accvgpr_write_b32 a72, v24
    v_accvgpr_write_b32 a73, v25
    v_accvgpr_write_b32 a74, v26
    v_accvgpr_write_b32 a75, v27
    v_accvgpr_read_b32 v24, a76
    v_accvgpr_read_b32 v25, a77
    v_accvgpr_read_b32 v26, a78
    v_accvgpr_read_b32 v27, a79
    v_mul_f32 v24, v24, v23
    v_mul_f32 v25, v25, v23
    v_mul_f32 v26, v26, v23
    v_mul_f32 v27, v27, v23
    v_accvgpr_write_b32 a76, v24
    v_accvgpr_write_b32 a77, v25
    v_accvgpr_write_b32 a78, v26
    v_accvgpr_write_b32 a79, v27
    v_accvgpr_read_b32 v24, a80
    v_accvgpr_read_b32 v25, a81
    v_accvgpr_read_b32 v26, a82
    v_accvgpr_read_b32 v27, a83
    v_mul_f32 v24, v24, v23
    v_mul_f32 v25, v25, v23
    v_mul_f32 v26, v26, v23
    v_mul_f32 v27, v27, v23
    v_accvgpr_write_b32 a80, v24
    v_accvgpr_write_b32 a81, v25
    v_accvgpr_write_b32 a82, v26
    v_accvgpr_write_b32 a83, v27
    v_accvgpr_read_b32 v24, a84
    v_accvgpr_read_b32 v25, a85
    v_accvgpr_read_b32 v26, a86
    v_accvgpr_read_b32 v27, a87
    v_mul_f32 v24, v24, v23
    v_mul_f32 v25, v25, v23
    v_mul_f32 v26, v26, v23
    v_mul_f32 v27, v27, v23
    v_accvgpr_write_b32 a84, v24
    v_accvgpr_write_b32 a85, v25
    v_accvgpr_write_b32 a86, v26
    v_accvgpr_write_b32 a87, v27
    v_accvgpr_read_b32 v24, a88
    v_accvgpr_read_b32 v25, a89
    v_accvgpr_read_b32 v26, a90
    v_accvgpr_read_b32 v27, a91
    v_mul_f32 v24, v24, v23
    v_mul_f32 v25, v25, v23
    v_mul_f32 v26, v26, v23
    v_mul_f32 v27, v27, v23
    v_accvgpr_write_b32 a88, v24
    v_accvgpr_write_b32 a89, v25
    v_accvgpr_write_b32 a90, v26
    v_accvgpr_write_b32 a91, v27
    v_accvgpr_read_b32 v24, a92
    v_accvgpr_read_b32 v25, a93
    v_accvgpr_read_b32 v26, a94
    v_accvgpr_read_b32 v27, a95
    v_mul_f32 v24, v24, v23
    v_mul_f32 v25, v25, v23
    v_mul_f32 v26, v26, v23
    v_mul_f32 v27, v27, v23
    v_accvgpr_write_b32 a92, v24
    v_accvgpr_write_b32 a93, v25
    v_accvgpr_write_b32 a94, v26
    v_accvgpr_write_b32 a95, v27
    v_exp_f32 v24, v48
    v_exp_f32 v25, v49
    s_nop 0
    v_cvt_pk_bf16_f32 v120, v24, v25
    v_exp_f32 v26, v50
    v_exp_f32 v27, v51
    s_nop 0
    v_cvt_pk_bf16_f32 v121, v26, v27
    v_exp_f32 v24, v52
    v_exp_f32 v25, v53
    s_nop 0
    v_cvt_pk_bf16_f32 v122, v24, v25
    v_exp_f32 v26, v54
    v_exp_f32 v27, v55
    s_nop 0
    v_cvt_pk_bf16_f32 v123, v26, v27
    v_max3_f32 v22, v56, v57, v58
    v_max3_f32 v22, v22, v59, v60
    v_max3_f32 v22, v22, v61, v62
    v_max_f32 v22, v22, v63
    v_mov_b32 v23, v22
    s_nop 1
    v_permlane32_swap_b32 v22, v23
    v_max_f32 v22, v22, v23
    v_mov_b32 v23, v22
    s_nop 1
    v_permlane16_swap_b32 v22, v23
    v_max_f32 v22, v22, v23
    v_max_f32 v22, 0, v22
    v_exp_f32_e64 v23, -v22
    v_sub_f32 v56, v56, v22
    v_sub_f32 v57, v57, v22
    v_sub_f32 v58, v58, v22
    v_sub_f32 v59, v59, v22
    v_sub_f32 v60, v60, v22
    v_sub_f32 v61, v61, v22
    v_sub_f32 v62, v62, v22
    v_sub_f32 v63, v63, v22
    v_sub_f32 v76, v76, v22
    v_sub_f32 v77, v77, v22
    v_sub_f32 v78, v78, v22
    v_sub_f32 v79, v79, v22
    v_mul_f32 v89, v89, v23
    v_accvgpr_read_b32 v24, a96
    v_accvgpr_read_b32 v25, a97
    v_accvgpr_read_b32 v26, a98
    v_accvgpr_read_b32 v27, a99
    v_mul_f32 v24, v24, v23
    v_mul_f32 v25, v25, v23
    v_mul_f32 v26, v26, v23
    v_mul_f32 v27, v27, v23
    v_accvgpr_write_b32 a96, v24
    v_accvgpr_write_b32 a97, v25
    v_accvgpr_write_b32 a98, v26
    v_accvgpr_write_b32 a99, v27
    v_accvgpr_read_b32 v24, a100
    v_accvgpr_read_b32 v25, a101
    v_accvgpr_read_b32 v26, a102
    v_accvgpr_read_b32 v27, a103
    v_mul_f32 v24, v24, v23
    v_mul_f32 v25, v25, v23
    v_mul_f32 v26, v26, v23
    v_mul_f32 v27, v27, v23
    v_accvgpr_write_b32 a100, v24
    v_accvgpr_write_b32 a101, v25
    v_accvgpr_write_b32 a102, v26
    v_accvgpr_write_b32 a103, v27
    v_accvgpr_read_b32 v24, a104
    v_accvgpr_read_b32 v25, a105
    v_accvgpr_read_b32 v26, a106
    v_accvgpr_read_b32 v27, a107
    v_mul_f32 v24, v24, v23
    v_mul_f32 v25, v25, v23
    v_mul_f32 v26, v26, v23
    v_mul_f32 v27, v27, v23
    v_accvgpr_write_b32 a104, v24
    v_accvgpr_write_b32 a105, v25
    v_accvgpr_write_b32 a106, v26
    v_accvgpr_write_b32 a107, v27
    v_accvgpr_read_b32 v24, a108
    v_accvgpr_read_b32 v25, a109
    v_accvgpr_read_b32 v26, a110
    v_accvgpr_read_b32 v27, a111
    v_mul_f32 v24, v24, v23
    v_mul_f32 v25, v25, v23
    v_mul_f32 v26, v26, v23
    v_mul_f32 v27, v27, v23
    v_accvgpr_write_b32 a108, v24
    v_accvgpr_write_b32 a109, v25
    v_accvgpr_write_b32 a110, v26
    v_accvgpr_write_b32 a111, v27
    v_accvgpr_read_b32 v24, a112
    v_accvgpr_read_b32 v25, a113
    v_accvgpr_read_b32 v26, a114
    v_accvgpr_read_b32 v27, a115
    v_mul_f32 v24, v24, v23
    v_mul_f32 v25, v25, v23
    v_mul_f32 v26, v26, v23
    v_mul_f32 v27, v27, v23
    v_accvgpr_write_b32 a112, v24
    v_accvgpr_write_b32 a113, v25
    v_accvgpr_write_b32 a114, v26
    v_accvgpr_write_b32 a115, v27
    v_accvgpr_read_b32 v24, a116
    v_accvgpr_read_b32 v25, a117
    v_accvgpr_read_b32 v26, a118
    v_accvgpr_read_b32 v27, a119
    v_mul_f32 v24, v24, v23
    v_mul_f32 v25, v25, v23
    v_mul_f32 v26, v26, v23
    v_mul_f32 v27, v27, v23
    v_accvgpr_write_b32 a116, v24
    v_accvgpr_write_b32 a117, v25
    v_accvgpr_write_b32 a118, v26
    v_accvgpr_write_b32 a119, v27
    v_accvgpr_read_b32 v24, a120
    v_accvgpr_read_b32 v25, a121
    v_accvgpr_read_b32 v26, a122
    v_accvgpr_read_b32 v27, a123
    v_mul_f32 v24, v24, v23
    v_mul_f32 v25, v25, v23
    v_mul_f32 v26, v26, v23
    v_mul_f32 v27, v27, v23
    v_accvgpr_write_b32 a120, v24
    v_accvgpr_write_b32 a121, v25
    v_accvgpr_write_b32 a122, v26
    v_accvgpr_write_b32 a123, v27
    v_accvgpr_read_b32 v24, a124
    v_accvgpr_read_b32 v25, a125
    v_accvgpr_read_b32 v26, a126
    v_accvgpr_read_b32 v27, a127
    v_mul_f32 v24, v24, v23
    v_mul_f32 v25, v25, v23
    v_mul_f32 v26, v26, v23
    v_mul_f32 v27, v27, v23
    v_accvgpr_write_b32 a124, v24
    v_accvgpr_write_b32 a125, v25
    v_accvgpr_write_b32 a126, v26
    v_accvgpr_write_b32 a127, v27
    v_exp_f32 v24, v56
    v_exp_f32 v25, v57
    s_nop 0
    v_cvt_pk_bf16_f32 v124, v24, v25
    v_exp_f32 v26, v58
    v_exp_f32 v27, v59
    s_nop 0
    v_cvt_pk_bf16_f32 v125, v26, v27
    v_exp_f32 v24, v60
    v_exp_f32 v25, v61
    s_nop 0
    v_cvt_pk_bf16_f32 v126, v24, v25
    v_exp_f32 v26, v62
    v_exp_f32 v27, v63
    s_nop 0
    v_cvt_pk_bf16_f32 v127, v26, v27
    v_add_f32 v90, v88, v89
    s_nop 1
    v_mfma_f32_16x16x32_bf16 v[92:95], v[14:17], v[120:123], v[88:91]
    v_mfma_f32_16x16x32_bf16 v[92:95], v[18:21], v[124:127], v[92:95]
    s_nop 7
    s_cmp_eq_u32 s67, 1
    s_cbranch_scc1 L_ret1
    s_cmp_eq_u32 s67, 5
    s_cbranch_scc1 L_ret5
    s_cmp_eq_u32 s67, 9
    s_cbranch_scc1 L_ret9
    s_cmp_eq_u32 s67, 13
    s_cbranch_scc1 L_ret13
    s_cmp_eq_u32 s67, 17
    s_cbranch_scc1 L_ret17
    s_cmp_eq_u32 s67, 21
    s_cbranch_scc1 L_ret21
    s_cmp_eq_u32 s67, 25
    s_cbranch_scc1 L_ret25
    s_cmp_eq_u32 s67, 29
    s_cbranch_scc1 L_ret29
    s_cmp_eq_u32 s67, 33
    s_cbranch_scc1 L_ret33
    s_cmp_eq_u32 s67, 37
    s_cbranch_scc1 L_ret37
    s_cmp_eq_u32 s67, 41
    s_cbranch_scc1 L_ret41
    s_cmp_eq_u32 s67, 45
    s_cbranch_scc1 L_ret45
    s_cmp_eq_u32 s67, 49
    s_cbranch_scc1 L_ret49
    s_cmp_eq_u32 s67, 53
    s_cbranch_scc1 L_ret53
    s_cmp_eq_u32 s67, 57
    s_cbranch_scc1 L_ret57
    s_branch L_ret61
L_rare00:
    s_nop 7
    v_max3_f32 v22, v32, v33, v34
    v_max3_f32 v22, v22, v35, v36
    v_max3_f32 v22, v22, v37, v38
    v_max_f32 v22, v22, v39
    v_mov_b32 v23, v22
    s_nop 1
    v_permlane32_swap_b32 v22, v23
    v_max_f32 v22, v22, v23
    v_mov_b32 v23, v22
    s_nop 1
    v_permlane16_swap_b32 v22, v23
    v_max_f32 v22, v22, v23
    v_max_f32 v22, 0, v22
    v_exp_f32_e64 v23, -v22
    v_sub_f32 v32, v32, v22
    v_sub_f32 v33, v33, v22
    v_sub_f32 v34, v34, v22
    v_sub_f32 v35, v35, v22
    v_sub_f32 v36, v36, v22
    v_sub_f32 v37, v37, v22
    v_sub_f32 v38, v38, v22
    v_sub_f32 v39, v39, v22
    v_sub_f32 v64, v64, v22
    v_sub_f32 v65, v65, v22
    v_sub_f32 v66, v66, v22
    v_sub_f32 v67, v67, v22
    v_mul_f32 v84, v84, v23
    v_accvgpr_read_b32 v24, a0
    v_accvgpr_read_b32 v25, a1
    v_accvgpr_read_b32 v26, a2
    v_accvgpr_read_b32 v27, a3
    v_mul_f32 v24, v24, v23
    v_mul_f32 v25, v25, v23
    v_mul_f32 v26, v26, v23
    v_mul_f32 v27, v27, v23
    v_accvgpr_write_b32 a0, v24
    v_accvgpr_write_b32 a1, v25
    v_accvgpr_write_b32 a2, v26
    v_accvgpr_write_b32 a3, v27
    v_accvgpr_read_b32 v24, a4
    v_accvgpr_read_b32 v25, a5
    v_accvgpr_read_b32 v26, a6
    v_accvgpr_read_b32 v27, a7
    v_mul_f32 v24, v24, v23
    v_mul_f32 v25, v25, v23
    v_mul_f32 v26, v26, v23
    v_mul_f32 v27, v27, v23
    v_accvgpr_write_b32 a4, v24
    v_accvgpr_write_b32 a5, v25
    v_accvgpr_write_b32 a6, v26
    v_accvgpr_write_b32 a7, v27
    v_accvgpr_read_b32 v24, a8
    v_accvgpr_read_b32 v25, a9
    v_accvgpr_read_b32 v26, a10
    v_accvgpr_read_b32 v27, a11
    v_mul_f32 v24, v24, v23
    v_mul_f32 v25, v25, v23
    v_mul_f32 v26, v26, v23
    v_mul_f32 v27, v27, v23
    v_accvgpr_write_b32 a8, v24
    v_accvgpr_write_b32 a9, v25
    v_accvgpr_write_b32 a10, v26
    v_accvgpr_write_b32 a11, v27
    v_accvgpr_read_b32 v24, a12
    v_accvgpr_read_b32 v25, a13
    v_accvgpr_read_b32 v26, a14
    v_accvgpr_read_b32 v27, a15
    v_mul_f32 v24, v24, v23
    v_mul_f32 v25, v25, v23
    v_mul_f32 v26, v26, v23
    v_mul_f32 v27, v27, v23
    v_accvgpr_write_b32 a12, v24
    v_accvgpr_write_b32 a13, v25
    v_accvgpr_write_b32 a14, v26
    v_accvgpr_write_b32 a15, v27
    v_accvgpr_read_b32 v24, a16
    v_accvgpr_read_b32 v25, a17
    v_accvgpr_read_b32 v26, a18
    v_accvgpr_read_b32 v27, a19
    v_mul_f32 v24, v24, v23
    v_mul_f32 v25, v25, v23
    v_mul_f32 v26, v26, v23
    v_mul_f32 v27, v27, v23
    v_accvgpr_write_b32 a16, v24
    v_accvgpr_write_b32 a17, v25
    v_accvgpr_write_b32 a18, v26
    v_accvgpr_write_b32 a19, v27
    v_accvgpr_read_b32 v24, a20
    v_accvgpr_read_b32 v25, a21
    v_accvgpr_read_b32 v26, a22
    v_accvgpr_read_b32 v27, a23
    v_mul_f32 v24, v24, v23
    v_mul_f32 v25, v25, v23
    v_mul_f32 v26, v26, v23
    v_mul_f32 v27, v27, v23
    v_accvgpr_write_b32 a20, v24
    v_accvgpr_write_b32 a21, v25
    v_accvgpr_write_b32 a22, v26
    v_accvgpr_write_b32 a23, v27
    v_accvgpr_read_b32 v24, a24
    v_accvgpr_read_b32 v25, a25
    v_accvgpr_read_b32 v26, a26
    v_accvgpr_read_b32 v27, a27
    v_mul_f32 v24, v24, v23
    v_mul_f32 v25, v25, v23
    v_mul_f32 v26, v26, v23
    v_mul_f32 v27, v27, v23
    v_accvgpr_write_b32 a24, v24
    v_accvgpr_write_b32 a25, v25
    v_accvgpr_write_b32 a26, v26
    v_accvgpr_write_b32 a27, v27
    v_accvgpr_read_b32 v24, a28
    v_accvgpr_read_b32 v25, a29
    v_accvgpr_read_b32 v26, a30
    v_accvgpr_read_b32 v27, a31
    v_mul_f32 v24, v24, v23
    v_mul_f32 v25, v25, v23
    v_mul_f32 v26, v26, v23
    v_mul_f32 v27, v27, v23
    v_accvgpr_write_b32 a28, v24
    v_accvgpr_write_b32 a29, v25
    v_accvgpr_write_b32 a30, v26
    v_accvgpr_write_b32 a31, v27
    v_exp_f32 v24, v32
    v_exp_f32 v25, v33
    s_nop 0
    v_cvt_pk_bf16_f32 v96, v24, v25
    v_exp_f32 v26, v34
    v_exp_f32 v27, v35
    s_nop 0
    v_cvt_pk_bf16_f32 v97, v26, v27
    v_exp_f32 v24, v36
    v_exp_f32 v25, v37
    s_nop 0
    v_cvt_pk_bf16_f32 v98, v24, v25
    v_exp_f32 v26, v38
    v_exp_f32 v27, v39
    s_nop 0
    v_cvt_pk_bf16_f32 v99, v26, v27
    v_max3_f32 v22, v40, v41, v42
    v_max3_f32 v22, v22, v43, v44
    v_max3_f32 v22, v22, v45, v46
    v_max_f32 v22, v22, v47
    v_mov_b32 v23, v22
    s_nop 1
    v_permlane32_swap_b32 v22, v23
    v_max_f32 v22, v22, v23
    v_mov_b32 v23, v22
    s_nop 1
    v_permlane16_swap_b32 v22, v23
    v_max_f32 v22, v22, v23
    v_max_f32 v22, 0, v22
    v_exp_f32_e64 v23, -v22
    v_sub_f32 v40, v40, v22
    v_sub_f32 v41, v41, v22
    v_sub_f32 v42, v42, v22
    v_sub_f32 v43, v43, v22
    v_sub_f32 v44, v44, v22
    v_sub_f32 v45, v45, v22
    v_sub_f32 v46, v46, v22
    v_sub_f32 v47, v47, v22
    v_sub_f32 v68, v68, v22
    v_sub_f32 v69, v69, v22
    v_sub_f32 v70, v70, v22
    v_sub_f32 v71, v71, v22
    v_mul_f32 v85, v85, v23
    v_accvgpr_read_b32 v24, a32
    v_accvgpr_read_b32 v25, a33
    v_accvgpr_read_b32 v26, a34
    v_accvgpr_read_b32 v27, a35
    v_mul_f32 v24, v24, v23
    v_mul_f32 v25, v25, v23
    v_mul_f32 v26, v26, v23
    v_mul_f32 v27, v27, v23
    v_accvgpr_write_b32 a32, v24
    v_accvgpr_write_b32 a33, v25
    v_accvgpr_write_b32 a34, v26
    v_accvgpr_write_b32 a35, v27
    v_accvgpr_read_b32 v24, a36
    v_accvgpr_read_b32 v25, a37
    v_accvgpr_read_b32 v26, a38
    v_accvgpr_read_b32 v27, a39
    v_mul_f32 v24, v24, v23
    v_mul_f32 v25, v25, v23
    v_mul_f32 v26, v26, v23
    v_mul_f32 v27, v27, v23
    v_accvgpr_write_b32 a36, v24
    v_accvgpr_write_b32 a37, v25
    v_accvgpr_write_b32 a38, v26
    v_accvgpr_write_b32 a39, v27
    v_accvgpr_read_b32 v24, a40
    v_accvgpr_read_b32 v25, a41
    v_accvgpr_read_b32 v26, a42
    v_accvgpr_read_b32 v27, a43
    v_mul_f32 v24, v24, v23
    v_mul_f32 v25, v25, v23
    v_mul_f32 v26, v26, v23
    v_mul_f32 v27, v27, v23
    v_accvgpr_write_b32 a40, v24
    v_accvgpr_write_b32 a41, v25
    v_accvgpr_write_b32 a42, v26
    v_accvgpr_write_b32 a43, v27
    v_accvgpr_read_b32 v24, a44
    v_accvgpr_read_b32 v25, a45
    v_accvgpr_read_b32 v26, a46
    v_accvgpr_read_b32 v27, a47
    v_mul_f32 v24, v24, v23
    v_mul_f32 v25, v25, v23
    v_mul_f32 v26, v26, v23
    v_mul_f32 v27, v27, v23
    v_accvgpr_write_b32 a44, v24
    v_accvgpr_write_b32 a45, v25
    v_accvgpr_write_b32 a46, v26
    v_accvgpr_write_b32 a47, v27
    v_accvgpr_read_b32 v24, a48
    v_accvgpr_read_b32 v25, a49
    v_accvgpr_read_b32 v26, a50
    v_accvgpr_read_b32 v27, a51
    v_mul_f32 v24, v24, v23
    v_mul_f32 v25, v25, v23
    v_mul_f32 v26, v26, v23
    v_mul_f32 v27, v27, v23
    v_accvgpr_write_b32 a48, v24
    v_accvgpr_write_b32 a49, v25
    v_accvgpr_write_b32 a50, v26
    v_accvgpr_write_b32 a51, v27
    v_accvgpr_read_b32 v24, a52
    v_accvgpr_read_b32 v25, a53
    v_accvgpr_read_b32 v26, a54
    v_accvgpr_read_b32 v27, a55
    v_mul_f32 v24, v24, v23
    v_mul_f32 v25, v25, v23
    v_mul_f32 v26, v26, v23
    v_mul_f32 v27, v27, v23
    v_accvgpr_write_b32 a52, v24
    v_accvgpr_write_b32 a53, v25
    v_accvgpr_write_b32 a54, v26
    v_accvgpr_write_b32 a55, v27
    v_accvgpr_read_b32 v24, a56
    v_accvgpr_read_b32 v25, a57
    v_accvgpr_read_b32 v26, a58
    v_accvgpr_read_b32 v27, a59
    v_mul_f32 v24, v24, v23
    v_mul_f32 v25, v25, v23
    v_mul_f32 v26, v26, v23
    v_mul_f32 v27, v27, v23
    v_accvgpr_write_b32 a56, v24
    v_accvgpr_write_b32 a57, v25
    v_accvgpr_write_b32 a58, v26
    v_accvgpr_write_b32 a59, v27
    v_accvgpr_read_b32 v24, a60
    v_accvgpr_read_b32 v25, a61
    v_accvgpr_read_b32 v26, a62
    v_accvgpr_read_b32 v27, a63
    v_mul_f32 v24, v24, v23
    v_mul_f32 v25, v25, v23
    v_mul_f32 v26, v26, v23
    v_mul_f32 v27, v27, v23
    v_accvgpr_write_b32 a60, v24
    v_accvgpr_write_b32 a61, v25
    v_accvgpr_write_b32 a62, v26
    v_accvgpr_write_b32 a63, v27
    v_exp_f32 v24, v40
    v_exp_f32 v25, v41
    s_nop 0
    v_cvt_pk_bf16_f32 v100, v24, v25
    v_exp_f32 v26, v42
    v_exp_f32 v27, v43
    s_nop 0
    v_cvt_pk_bf16_f32 v101, v26, v27
    v_exp_f32 v24, v44
    v_exp_f32 v25, v45
    s_nop 0
    v_cvt_pk_bf16_f32 v102, v24, v25
    v_exp_f32 v26, v46
    v_exp_f32 v27, v47
    s_nop 0
    v_cvt_pk_bf16_f32 v103, v26, v27
    v_add_f32 v86, v84, v85
    s_nop 1
    v_mfma_f32_16x16x32_bf16 v[80:83], v[14:17], v[96:99], v[84:87]
    v_mfma_f32_16x16x32_bf16 v[80:83], v[18:21], v[100:103], v[80:83]
    s_nop 7
    s_cmp_eq_u32 s67, 2
    s_cbranch_scc1 L_ret2
    s_cmp_eq_u32 s67, 6
    s_cbranch_scc1 L_ret6
    s_cmp_eq_u32 s67, 10
    s_cbranch_scc1 L_ret10
    s_cmp_eq_u32 s67, 14
    s_cbranch_scc1 L_ret14
    s_cmp_eq_u32 s67, 18
    s_cbranch_scc1 L_ret18
    s_cmp_eq_u32 s67, 22
    s_cbranch_scc1 L_ret22
    s_cmp_eq_u32 s67, 26
    s_cbranch_scc1 L_ret26
    s_cmp_eq_u32 s67, 30
    s_cbranch_scc1 L_ret30
    s_cmp_eq_u32 s67, 34
    s_cbranch_scc1 L_ret34
    s_cmp_eq_u32 s67, 38
    s_cbranch_scc1 L_ret38
    s_cmp_eq_u32 s67, 42
    s_cbranch_scc1 L_ret42
    s_cmp_eq_u32 s67, 46
    s_cbranch_scc1 L_ret46
    s_cmp_eq_u32 s67, 50
    s_cbranch_scc1 L_ret50
    s_cmp_eq_u32 s67, 54
    s_cbranch_scc1 L_ret54
    s_branch L_ret58
L_rare10:
    s_nop 7
    v_max3_f32 v22, v48, v49, v50
    v_max3_f32 v22, v22, v51, v52
    v_max3_f32 v22, v22, v53, v54
    v_max_f32 v22, v22, v55
    v_mov_b32 v23, v22
    s_nop 1
    v_permlane32_swap_b32 v22, v23
    v_max_f32 v22, v22, v23
    v_mov_b32 v23, v22
    s_nop 1
    v_permlane16_swap_b32 v22, v23
    v_max_f32 v22, v22, v23
    v_max_f32 v22, 0, v22
    v_exp_f32_e64 v23, -v22
    v_sub_f32 v48, v48, v22
    v_sub_f32 v49, v49, v22
    v_sub_f32 v50, v50, v22
    v_sub_f32 v51, v51, v22
    v_sub_f32 v52, v52, v22
    v_sub_f32 v53, v53, v22
    v_sub_f32 v54, v54, v22
    v_sub_f32 v55, v55, v22
    v_sub_f32 v72, v72, v22
    v_sub_f32 v73, v73, v22
    v_sub_f32 v74, v74, v22
    v_sub_f32 v75, v75, v22
    v_mul_f32 v92, v92, v23
    v_accvgpr_read_b32 v24, a64
    v_accvgpr_read_b32 v25, a65
    v_accvgpr_read_b32 v26, a66
    v_accvgpr_read_b32 v27, a67
    v_mul_f32 v24, v24, v23
    v_mul_f32 v25, v25, v23
    v_mul_f32 v26, v26, v23
    v_mul_f32 v27, v27, v23
    v_accvgpr_write_b32 a64, v24
    v_accvgpr_write_b32 a65, v25
    v_accvgpr_write_b32 a66, v26
    v_accvgpr_write_b32 a67, v27
    v_accvgpr_read_b32 v24, a68
    v_accvgpr_read_b32 v25, a69
    v_accvgpr_read_b32 v26, a70
    v_accvgpr_read_b32 v27, a71
    v_mul_f32 v24, v24, v23
    v_mul_f32 v25, v25, v23
    v_mul_f32 v26, v26, v23
    v_mul_f32 v27, v27, v23
    v_accvgpr_write_b32 a68, v24
    v_accvgpr_write_b32 a69, v25
    v_accvgpr_write_b32 a70, v26
    v_accvgpr_write_b32 a71, v27
    v_accvgpr_read_b32 v24, a72
    v_accvgpr_read_b32 v25, a73
    v_accvgpr_read_b32 v26, a74
    v_accvgpr_read_b32 v27, a75
    v_mul_f32 v24, v24, v23
    v_mul_f32 v25, v25, v23
    v_mul_f32 v26, v26, v23
    v_mul_f32 v27, v27, v23
    v_accvgpr_write_b32 a72, v24
    v_accvgpr_write_b32 a73, v25
    v_accvgpr_write_b32 a74, v26
    v_accvgpr_write_b32 a75, v27
    v_accvgpr_read_b32 v24, a76
    v_accvgpr_read_b32 v25, a77
    v_accvgpr_read_b32 v26, a78
    v_accvgpr_read_b32 v27, a79
    v_mul_f32 v24, v24, v23
    v_mul_f32 v25, v25, v23
    v_mul_f32 v26, v26, v23
    v_mul_f32 v27, v27, v23
    v_accvgpr_write_b32 a76, v24
    v_accvgpr_write_b32 a77, v25
    v_accvgpr_write_b32 a78, v26
    v_accvgpr_write_b32 a79, v27
    v_accvgpr_read_b32 v24, a80
    v_accvgpr_read_b32 v25, a81
    v_accvgpr_read_b32 v26, a82
    v_accvgpr_read_b32 v27, a83
    v_mul_f32 v24, v24, v23
    v_mul_f32 v25, v25, v23
    v_mul_f32 v26, v26, v23
    v_mul_f32 v27, v27, v23
    v_accvgpr_write_b32 a80, v24
    v_accvgpr_write_b32 a81, v25
    v_accvgpr_write_b32 a82, v26
    v_accvgpr_write_b32 a83, v27
    v_accvgpr_read_b32 v24, a84
    v_accvgpr_read_b32 v25, a85
    v_accvgpr_read_b32 v26, a86
    v_accvgpr_read_b32 v27, a87
    v_mul_f32 v24, v24, v23
    v_mul_f32 v25, v25, v23
    v_mul_f32 v26, v26, v23
    v_mul_f32 v27, v27, v23
    v_accvgpr_write_b32 a84, v24
    v_accvgpr_write_b32 a85, v25
    v_accvgpr_write_b32 a86, v26
    v_accvgpr_write_b32 a87, v27
    v_accvgpr_read_b32 v24, a88
    v_accvgpr_read_b32 v25, a89
    v_accvgpr_read_b32 v26, a90
    v_accvgpr_read_b32 v27, a91
    v_mul_f32 v24, v24, v23
    v_mul_f32 v25, v25, v23
    v_mul_f32 v26, v26, v23
    v_mul_f32 v27, v27, v23
    v_accvgpr_write_b32 a88, v24
    v_accvgpr_write_b32 a89, v25
    v_accvgpr_write_b32 a90, v26
    v_accvgpr_write_b32 a91, v27
    v_accvgpr_read_b32 v24, a92
    v_accvgpr_read_b32 v25, a93
    v_accvgpr_read_b32 v26, a94
    v_accvgpr_read_b32 v27, a95
    v_mul_f32 v24, v24, v23
    v_mul_f32 v25, v25, v23
    v_mul_f32 v26, v26, v23
    v_mul_f32 v27, v27, v23
    v_accvgpr_write_b32 a92, v24
    v_accvgpr_write_b32 a93, v25
    v_accvgpr_write_b32 a94, v26
    v_accvgpr_write_b32 a95, v27
    v_exp_f32 v24, v48
    v_exp_f32 v25, v49
    s_nop 0
    v_cvt_pk_bf16_f32 v104, v24, v25
    v_exp_f32 v26, v50
    v_exp_f32 v27, v51
    s_nop 0
    v_cvt_pk_bf16_f32 v105, v26, v27
    v_exp_f32 v24, v52
    v_exp_f32 v25, v53
    s_nop 0
    v_cvt_pk_bf16_f32 v106, v24, v25
    v_exp_f32 v26, v54
    v_exp_f32 v27, v55
    s_nop 0
    v_cvt_pk_bf16_f32 v107, v26, v27
    v_max3_f32 v22, v56, v57, v58
    v_max3_f32 v22, v22, v59, v60
    v_max3_f32 v22, v22, v61, v62
    v_max_f32 v22, v22, v63
    v_mov_b32 v23, v22
    s_nop 1
    v_permlane32_swap_b32 v22, v23
    v_max_f32 v22, v22, v23
    v_mov_b32 v23, v22
    s_nop 1
    v_permlane16_swap_b32 v22, v23
    v_max_f32 v22, v22, v23
    v_max_f32 v22, 0, v22
    v_exp_f32_e64 v23, -v22
    v_sub_f32 v56, v56, v22
    v_sub_f32 v57, v57, v22
    v_sub_f32 v58, v58, v22
    v_sub_f32 v59, v59, v22
    v_sub_f32 v60, v60, v22
    v_sub_f32 v61, v61, v22
    v_sub_f32 v62, v62, v22
    v_sub_f32 v63, v63, v22
    v_sub_f32 v76, v76, v22
    v_sub_f32 v77, v77, v22
    v_sub_f32 v78, v78, v22
    v_sub_f32 v79, v79, v22
    v_mul_f32 v93, v93, v23
    v_accvgpr_read_b32 v24, a96
    v_accvgpr_read_b32 v25, a97
    v_accvgpr_read_b32 v26, a98
    v_accvgpr_read_b32 v27, a99
    v_mul_f32 v24, v24, v23
    v_mul_f32 v25, v25, v23
    v_mul_f32 v26, v26, v23
    v_mul_f32 v27, v27, v23
    v_accvgpr_write_b32 a96, v24
    v_accvgpr_write_b32 a97, v25
    v_accvgpr_write_b32 a98, v26
    v_accvgpr_write_b32 a99, v27
    v_accvgpr_read_b32 v24, a100
    v_accvgpr_read_b32 v25, a101
    v_accvgpr_read_b32 v26, a102
    v_accvgpr_read_b32 v27, a103
    v_mul_f32 v24, v24, v23
    v_mul_f32 v25, v25, v23
    v_mul_f32 v26, v26, v23
    v_mul_f32 v27, v27, v23
    v_accvgpr_write_b32 a100, v24
    v_accvgpr_write_b32 a101, v25
    v_accvgpr_write_b32 a102, v26
    v_accvgpr_write_b32 a103, v27
    v_accvgpr_read_b32 v24, a104
    v_accvgpr_read_b32 v25, a105
    v_accvgpr_read_b32 v26, a106
    v_accvgpr_read_b32 v27, a107
    v_mul_f32 v24, v24, v23
    v_mul_f32 v25, v25, v23
    v_mul_f32 v26, v26, v23
    v_mul_f32 v27, v27, v23
    v_accvgpr_write_b32 a104, v24
    v_accvgpr_write_b32 a105, v25
    v_accvgpr_write_b32 a106, v26
    v_accvgpr_write_b32 a107, v27
    v_accvgpr_read_b32 v24, a108
    v_accvgpr_read_b32 v25, a109
    v_accvgpr_read_b32 v26, a110
    v_accvgpr_read_b32 v27, a111
    v_mul_f32 v24, v24, v23
    v_mul_f32 v25, v25, v23
    v_mul_f32 v26, v26, v23
    v_mul_f32 v27, v27, v23
    v_accvgpr_write_b32 a108, v24
    v_accvgpr_write_b32 a109, v25
    v_accvgpr_write_b32 a110, v26
    v_accvgpr_write_b32 a111, v27
    v_accvgpr_read_b32 v24, a112
    v_accvgpr_read_b32 v25, a113
    v_accvgpr_read_b32 v26, a114
    v_accvgpr_read_b32 v27, a115
    v_mul_f32 v24, v24, v23
    v_mul_f32 v25, v25, v23
    v_mul_f32 v26, v26, v23
    v_mul_f32 v27, v27, v23
    v_accvgpr_write_b32 a112, v24
    v_accvgpr_write_b32 a113, v25
    v_accvgpr_write_b32 a114, v26
    v_accvgpr_write_b32 a115, v27
    v_accvgpr_read_b32 v24, a116
    v_accvgpr_read_b32 v25, a117
    v_accvgpr_read_b32 v26, a118
    v_accvgpr_read_b32 v27, a119
    v_mul_f32 v24, v24, v23
    v_mul_f32 v25, v25, v23
    v_mul_f32 v26, v26, v23
    v_mul_f32 v27, v27, v23
    v_accvgpr_write_b32 a116, v24
    v_accvgpr_write_b32 a117, v25
    v_accvgpr_write_b32 a118, v26
    v_accvgpr_write_b32 a119, v27
    v_accvgpr_read_b32 v24, a120
    v_accvgpr_read_b32 v25, a121
    v_accvgpr_read_b32 v26, a122
    v_accvgpr_read_b32 v27, a123
    v_mul_f32 v24, v24, v23
    v_mul_f32 v25, v25, v23
    v_mul_f32 v26, v26, v23
    v_mul_f32 v27, v27, v23
    v_accvgpr_write_b32 a120, v24
    v_accvgpr_write_b32 a121, v25
    v_accvgpr_write_b32 a122, v26
    v_accvgpr_write_b32 a123, v27
    v_accvgpr_read_b32 v24, a124
    v_accvgpr_read_b32 v25, a125
    v_accvgpr_read_b32 v26, a126
    v_accvgpr_read_b32 v27, a127
    v_mul_f32 v24, v24, v23
    v_mul_f32 v25, v25, v23
    v_mul_f32 v26, v26, v23
    v_mul_f32 v27, v27, v23
    v_accvgpr_write_b32 a124, v24
    v_accvgpr_write_b32 a125, v25
    v_accvgpr_write_b32 a126, v26
    v_accvgpr_write_b32 a127, v27
    v_exp_f32 v24, v56
    v_exp_f32 v25, v57
    s_nop 0
    v_cvt_pk_bf16_f32 v108, v24, v25
    v_exp_f32 v26, v58
    v_exp_f32 v27, v59
    s_nop 0
    v_cvt_pk_bf16_f32 v109, v26, v27
    v_exp_f32 v24, v60
    v_exp_f32 v25, v61
    s_nop 0
    v_cvt_pk_bf16_f32 v110, v24, v25
    v_exp_f32 v26, v62
    v_exp_f32 v27, v63
    s_nop 0
    v_cvt_pk_bf16_f32 v111, v26, v27
    v_add_f32 v94, v92, v93
    s_nop 1
    v_mfma_f32_16x16x32_bf16 v[88:91], v[14:17], v[104:107], v[92:95]
    v_mfma_f32_16x16x32_bf16 v[88:91], v[18:21], v[108:111], v[88:91]
    s_nop 7
    s_cmp_eq_u32 s67, 3
    s_cbranch_scc1 L_ret3
    s_cmp_eq_u32 s67, 7
    s_cbranch_scc1 L_ret7
    s_cmp_eq_u32 s67, 11
    s_cbranch_scc1 L_ret11
    s_cmp_eq_u32 s67, 15
    s_cbranch_scc1 L_ret15
    s_cmp_eq_u32 s67, 19
    s_cbranch_scc1 L_ret19
    s_cmp_eq_u32 s67, 23
    s_cbranch_scc1 L_ret23
    s_cmp_eq_u32 s67, 27
    s_cbranch_scc1 L_ret27
    s_cmp_eq_u32 s67, 31
    s_cbranch_scc1 L_ret31
    s_cmp_eq_u32 s67, 35
    s_cbranch_scc1 L_ret35
    s_cmp_eq_u32 s67, 39
    s_cbranch_scc1 L_ret39
    s_cmp_eq_u32 s67, 43
    s_cbranch_scc1 L_ret43
    s_cmp_eq_u32 s67, 47
    s_cbranch_scc1 L_ret47
    s_cmp_eq_u32 s67, 51
    s_cbranch_scc1 L_ret51
    s_cmp_eq_u32 s67, 55
    s_cbranch_scc1 L_ret55
    s_branch L_ret59
.section .rodata,"a"
.p2align 6

.amdhsa_kernel standalone__kv_cache_quant_pre_rope_vs_post_rope__prompt_kernel
  .amdhsa_next_free_vgpr 512
  .amdhsa_next_free_sgpr 100
  .amdhsa_accum_offset 256
  .amdhsa_group_segment_fixed_size 0
  .amdhsa_kernarg_size 112
  .amdhsa_user_sgpr_count 2
  .amdhsa_user_sgpr_kernarg_segment_ptr 1
  .amdhsa_system_sgpr_workgroup_id_x 1
  .amdhsa_float_denorm_mode_32 3
  .amdhsa_float_denorm_mode_16_64 3
.end_amdhsa_kernel
```
